```python
import torch

def _softmax(x, axis=-1):
    return torch.softmax(x, dim=axis)
def _gelu(x):
    return torch.nn.functional.gelu(x, approximate="tanh")
def _silu(x):
    return torch.nn.functional.silu(x)
def _sigmoid(x):
    return torch.sigmoid(x)
def _layernorm(x, axis=-1, eps=1e-5):
    m = x.mean(dim=axis, keepdim=True)
    v = x.var(dim=axis, keepdim=True, unbiased=False)
    return (x - m) / torch.sqrt(v + eps)
def _scatter_add(tgt, idx, src, axis=0):
    return tgt.clone().index_add_(axis, idx, src)
def _segment_sum(src, seg, n):
    out = torch.zeros((n,) + src.shape[1:], dtype=src.dtype)
    return out.index_add_(0, seg, src)
def _pad(x, pw):
    flat = tuple(v for pair in reversed(pw) for v in pair)
    return torch.nn.functional.pad(x, flat)

kernel_name = 'interleave_layers__sliding_block__linear_attn_block__prompt'

def setup_inputs():

    _w = (lambda a: (lambda t: t.to(torch.bfloat16) if t.is_floating_point() else t)(torch.as_tensor(a)))
    def _A_setup():
        B, S, D = 1, 2048, 512
        return {
            "x": _w((lambda *s: torch.randn(*s, dtype=torch.bfloat16) * 0.05)(B, S, D)),
            "wqkv": _w((lambda *s: torch.randn(*s, dtype=torch.bfloat16) * 0.1)(D, 3 * D)),
            "wo": _w((lambda *s: torch.randn(*s, dtype=torch.bfloat16) * 0.1)(D, D)),
        }
    _A_in = _A_setup()

    def _B_setup():
        B, S, D = 1, 2048, 512
        return {
            "x": _w((lambda *s: torch.randn(*s, dtype=torch.bfloat16) * 0.05)(B, S, D)),
            "wqkv": _w((lambda *s: torch.randn(*s, dtype=torch.bfloat16) * 1.6)(D, 3 * D)),
            "wo": _w((lambda *s: torch.randn(*s, dtype=torch.bfloat16) * 0.1)(D, D)),
        }
    _B_in = _B_setup()

    return {
        "A_x": _A_in["x"],
        "A_wqkv": _A_in["wqkv"],
        "A_wo": _A_in["wo"],
        "B_x": _B_in["x"],
        "B_wqkv": _B_in["wqkv"],
        "B_wo": _B_in["wo"],
    }

def reference(A_x, A_wqkv, A_wo, B_x, B_wqkv, B_wo):
    def _A_ref(x, wqkv, wo):
        B, S, D = x.shape
        H = 32; Dh = D // H; W = 256
        qkv = (lambda x, *d: x.permute(*d))((x @ wqkv).reshape(B, S, 3, H, Dh), 2, 0, 3, 1, 4)
        q, k, v = qkv[0], qkv[1], qkv[2]
        scores = torch.einsum("bhqd,bhkd->bhqk", q, k) * (Dh ** -0.5)
        idx = torch.arange(S)
        mask = (idx[:, None] - idx[None, :] >= 0) & (idx[:, None] - idx[None, :] < W)
        scores = torch.where(mask[None, None], scores, -1e9)
        p = _softmax(scores, axis=-1)
        o = torch.einsum("bhqk,bhkd->bhqd", p, v)
        return (lambda x, *d: x.permute(*d))(o, 0, 2, 1, 3).reshape(B, S, D) @ wo

    def _B_ref(x, wqkv, wo):
        B, S, D = x.shape
        H = 32; Dh = D // H
        qkv = (lambda x, *d: x.permute(*d))((x @ wqkv).reshape(B, S, 3, H, Dh), 2, 0, 3, 1, 4)
        q, k, v = qkv[0], qkv[1], qkv[2]
        phi = lambda t: torch.where(t > 0, t + 1, torch.exp(t)) + 1e-6
        pq, pk = phi(q), phi(k)
        kv = torch.einsum("bhsd,bhse->bhde", pk, v)
        z = torch.einsum("bhsd->bhd", pk)
        num = torch.einsum("bhqd,bhde->bhqe", pq, kv)
        den = torch.einsum("bhqd,bhd->bhq", pq, z)[..., None] + 1e-6
        o = num / den
        return (lambda x, *d: x.permute(*d))(o, 0, 2, 1, 3).reshape(B, S, D) @ wo

    x = A_x
    x = x + _A_ref(_layernorm(x, axis=-1), A_wqkv, A_wo)
    x = x + _B_ref(_layernorm(x, axis=-1), B_wqkv, B_wo)
    x = x + _A_ref(_layernorm(x, axis=-1), A_wqkv, A_wo)
    x = x + _B_ref(_layernorm(x, axis=-1), B_wqkv, B_wo)
    return x
```

```asm
; @launch kernel=interleave_layers__sliding_block__linear_attn_block__prompt_kernel grid=(256,1,1) block=(256,1,1) lds=163840
.amdgcn_target "amdgcn-amd-amdhsa--gfx950"
.text
.p2align 8
.globl interleave_layers__sliding_block__linear_attn_block__prompt_kernel
.type interleave_layers__sliding_block__linear_attn_block__prompt_kernel,@function
interleave_layers__sliding_block__linear_attn_block__prompt_kernel:
    s_cmp_ge_u32 s2, 256
    s_cbranch_scc1 main_done
    s_load_dwordx2 s[20:21], s[0:1], 0
    s_load_dwordx2 s[48:49], s[0:1], 8
    v_lshrrev_b32 v2, 6, v0
    v_and_b32 v1, 63, v0
    v_readfirstlane_b32 s12, v2
    v_lshlrev_b32 v2, 4, v1
    s_getpc_b64 s[8:9]
pc_anchor:
    s_lshr_b32 s11, s2, 3
    s_lshl_b32 s66, s11, 2
    s_add_u32 s66, s66, s12
    s_lshl_b32 s66, s66, 10
    s_min_u32 s66, s66, main_done-pc_anchor-1024
    s_add_u32 s8, s8, s66
    s_addc_u32 s9, s9, 0
    global_load_dwordx4 v[100:103], v2, s[8:9]
    s_load_dwordx8 s[32:39], s[0:1], 0
    s_load_dwordx8 s[40:47], s[0:1], 32
    s_load_dwordx2 s[16:17], s[0:1], 64
    s_memrealtime s[96:97]
    s_and_b32 s11, s11, 7
    s_lshr_b32 s28, s2, 6
    s_and_b32 s10, s2, 7
    s_lshl_b32 s10, s10, 2
    s_add_u32 s10, s10, s28
    s_mov_b32 s22, 0x200000
    s_mov_b32 s23, 0x20000
    s_mov_b32 s50, 0x180000
    s_mov_b32 s51, 0x20000
    s_lshl_b32 s13, s11, 2
    s_add_u32 s13, s13, s12
    s_lshl_b32 s82, s12, 14
    s_lshl_b32 s81, s10, 16
    s_lshl_b32 s31, s13, 11
    s_add_u32 s31, s31, s81
    s_add_u32 s81, s81, s82
    v_lshlrev_b32 v227, 7, v1
    v_lshrrev_b32 v12, 2, v1
    v_lshrrev_b32 v13, 4, v1
    v_sub_u32 v13, 0, v13
    v_xor_b32 v13, v13, v1
    v_and_b32 v13, 3, v13
    v_lshlrev_b32 v12, 10, v12
    v_lshl_add_u32 v6, v13, 4, v12
    v_lshrrev_b32 v12, 3, v1
    v_mul_u32_u24 v142, 3072, v12
    v_bfe_u32 v13, v1, 4, 1
    v_lshlrev_b32 v13, 1, v13
    v_and_b32 v14, 7, v1
    v_xor_b32 v13, v13, v14
    v_lshl_add_u32 v142, v13, 4, v142
    v_xor_b32 v143, 64, v142
    s_and_b32 s52, s12, 1
    s_mul_i32 s52, s52, 98304
    s_lshr_b32 s53, s12, 1
    s_lshl_b32 s53, s53, 10
    s_add_u32 s52, s52, s53
    s_lshl_b32 s53, s11, 7
    s_add_u32 s52, s52, s53
    s_add_u32 s52, s52, 1024
    s_lshl_b32 s54, s12, 12
    s_add_u32 s54, s54, 65536
    s_mov_b32 s30, s28
    s_mul_i32 s4, s28, 393216
    s_lshl_b32 s74, s28, 12
    s_waitcnt lgkmcnt(0)
    s_add_u32 s28, s52, s4
    s_add_u32 m0, s54, 0
    s_add_u32 s64, s28, 0x0
    buffer_load_dwordx4 v142, s[48:51], s64 offen lds
    s_add_u32 m0, s54, 1024
    s_add_u32 s65, s28, 0x6000
    buffer_load_dwordx4 v143, s[48:51], s65 offen lds
    s_add_u32 m0, s54, 2048
    s_add_u32 s66, s28, 0xc000
    buffer_load_dwordx4 v142, s[48:51], s66 offen lds
    s_add_u32 m0, s54, 3072
    s_add_u32 s67, s28, 0x12000
    buffer_load_dwordx4 v143, s[48:51], s67 offen lds
    s_add_u32 s88, s82, s74
    s_lshr_b32 s86, s74, 4
    s_add_u32 s86, s86, s81
    s_add_u32 m0, s88, 0
    s_nop 0
    buffer_load_dwordx4 v6, s[20:23], s86 offen offset:0 lds
    s_add_u32 m0, s88, 960
    s_nop 0
    buffer_load_dwordx4 v6, s[20:23], s86 offen offset:64 lds
    s_add_u32 m0, s88, 1920
    s_nop 0
    buffer_load_dwordx4 v6, s[20:23], s86 offen offset:128 lds
    s_add_u32 m0, s88, 2880
    s_nop 0
    buffer_load_dwordx4 v6, s[20:23], s86 offen offset:192 lds
    s_add_u32 s28, s52, s4
    s_add_u32 m0, s54, 16384
    s_add_u32 s68, s28, 0x30000
    buffer_load_dwordx4 v142, s[48:51], s68 offen lds
    s_add_u32 m0, s54, 17408
    s_add_u32 s69, s28, 0x36000
    buffer_load_dwordx4 v143, s[48:51], s69 offen lds
    s_add_u32 m0, s54, 18432
    s_add_u32 s70, s28, 0x3c000
    buffer_load_dwordx4 v142, s[48:51], s70 offen lds
    s_add_u32 m0, s54, 19456
    s_add_u32 s71, s28, 0x42000
    buffer_load_dwordx4 v143, s[48:51], s71 offen lds
    s_mov_b32 s18, 0x1240000
    s_mov_b32 s19, 0x20000
    s_and_b32 s3, s10, 3
    s_lshl_b32 s3, s3, 3
    s_add_u32 s3, s3, s11
    s_mov_b32 s24, s46
    s_mov_b32 s25, s47
    s_mov_b32 s26, 0x100
    s_mov_b32 s27, 0x20000
    s_add_u32 s31, s2, s12
    s_cmp_lg_u32 s31, 0
    s_cbranch_scc1 no_tag
    s_lshl_b32 s31, s96, 5
    s_or_b32 s31, s31, 0x80000000
    v_mov_b32 v11, s31
    s_mov_b64 exec, 1
    buffer_store_dword v11, v1, s[24:27], 0 offen sc1
    s_mov_b64 exec, -1
no_tag:
    s_add_u32 s31, s30, 1
    s_and_b32 s31, s31, 3
    s_mul_i32 s5, s31, 393216
    s_lshl_b32 s75, s31, 12
    s_add_u32 s31, s30, 2
    s_and_b32 s31, s31, 3
    s_mul_i32 s6, s31, 393216
    s_lshl_b32 s76, s31, 12
    s_add_u32 s31, s30, 3
    s_and_b32 s31, s31, 3
    s_mul_i32 s7, s31, 393216
    s_lshl_b32 s77, s31, 12
    s_mul_i32 s31, s12, 98304
    s_add_u32 s53, s53, s31
    s_lshr_b32 s61, s10, 2
    v_lshrrev_b32 v12, 3, v1
    v_and_b32 v13, 7, v1
    s_cmp_ge_u32 s3, 24
    s_cselect_b32 s63, 24, 0
    s_sub_u32 s63, s3, s63
    s_cmp_ge_u32 s63, 12
    s_cselect_b32 s56, s40, s34
    s_cselect_b32 s57, s41, s35
    s_cselect_b32 s60, 12, 0
    s_cselect_b32 s62, 0x180000, 0
    s_mov_b32 s58, 0x180000
    s_mov_b32 s59, 0x20000
    s_sub_u32 s60, s63, s60
    s_lshr_b32 s89, s60, 2
    s_and_b32 s60, s60, 3
    s_lshl_b32 s60, s60, 2
    s_add_u32 s60, s60, s12
    s_mul_i32 s55, s60, 98304
    s_lshl_b32 s31, s89, 10
    s_add_u32 s55, s55, s31
    s_lshl_b32 s31, s61, 7
    s_add_u32 s55, s55, s31
    s_mul_i32 s78, s61, 196608
    s_add_u32 s78, s78, s62
    s_lshl_b32 s63, s60, 1
    s_add_u32 s63, s63, s89
    s_sub_u32 s63, s63, 1
    s_add_u32 s31, s60, 32
    s_cmp_eq_u32 s89, 0
    s_cselect_b32 s63, s31, s63
    s_lshl_b32 s63, s63, 10
    s_add_u32 s78, s78, s63
    s_mov_b32 s79, 49152
    s_mov_b32 s60, 24576
    s_sub_u32 s31, s3, 4
    s_cmp_lt_u32 s31, 20
    s_cselect_b32 s78, s78, 0x7fff0000
    s_cselect_b32 s55, s55, 0x7fff0000
    v_mul_u32_u24 v12, 3072, v12
    v_lshl_add_u32 v227, v13, 4, v12
    s_and_b32 s63, s3, 3
    s_lshl_b32 s31, s61, 2
    s_add_u32 s63, s63, s31
    s_mul_i32 s90, s63, 1152
    s_mul_i32 s31, s12, 36864
    s_add_u32 s90, s90, s31
    s_add_u32 s90, s90, 0x420000
    s_lshl_b32 s63, s63, 10
    s_lshl_b32 s31, s12, 15
    s_add_u32 s63, s63, s31
    s_add_u32 s63, s63, 0x440000
    s_cmp_ge_u32 s12, 2
    s_cselect_b32 s90, s63, s90
    s_lshl_b32 s29, s10, 5
    s_add_u32 s29, s29, s13
    s_lshl_b32 s29, s29, 7
    s_add_u32 s29, s29, 0x400000
    s_mul_i32 s80, s13, 49152
    s_lshl_b32 s83, s10, 14
    s_lshl_b32 s84, s12, 10
    s_add_u32 s83, s83, s84
    s_lshl_b32 s84, s13, 6
    s_lshl_b32 s85, s10, 1
    s_add_u32 s84, s84, s85
    s_lshl_b32 s84, s84, 10
    s_lshl_b32 s85, s10, 6
    s_add_u32 s85, s85, s13
    s_lshl_b32 s85, s85, 10
    s_mov_b32 s92, 0x3fb8aa3b
    s_mov_b32 s93, 0x3fb8aa3b
    s_mov_b32 s94, 0x358637bd
    s_lshl_b32 s91, s10, 16
    s_lshl_b32 s31, s11, 11
    s_add_u32 s91, s91, s31
    s_lshl_b32 s95, s10, 14
    s_lshr_b32 s31, s11, 1
    s_lshl_b32 s31, s31, 12
    s_add_u32 s95, s95, s31
    s_and_b32 s31, s11, 1
    s_lshl_b32 s31, s31, 3
    s_add_u32 s95, s95, s31
    s_mov_b32 s14, 0x3eb8aa3b
    s_mov_b32 s15, 0x3eb8aa3b
    v_and_b32 v12, 15, v1
    v_lshrrev_b32 v13, 2, v12
    v_sub_u32 v13, 0, v13
    v_lshrrev_b32 v14, 4, v1
    v_xor_b32 v13, v13, v14
    v_and_b32 v13, 3, v13
    v_lshl_add_u32 v3, v12, 2, v13
    v_lshlrev_b32 v3, 4, v3
    v_add_u32 v228, s74, v3
    v_add_u32 v229, s75, v3
    v_add_u32 v230, s76, v3
    v_add_u32 v231, s77, v3
    v_lshrrev_b32 v12, 4, v1
    v_bfe_u32 v13, v1, 2, 2
    v_lshl_add_u32 v12, v12, 3, v13
    v_lshlrev_b32 v12, 7, v12
    v_bfe_u32 v13, v1, 3, 2
    v_xor_b32 v13, s12, v13
    v_lshl_add_u32 v12, v13, 5, v12
    v_and_b32 v13, 3, v1
    v_lshl_add_u32 v12, v13, 3, v12
    v_add_u32 v140, 65536, v12
    v_add_u32 v141, 131072, v12
    v_mov_b32 v136, 0x3f803f80
    v_mov_b32 v137, v136
    v_mov_b32 v138, v136
    v_mov_b32 v139, v136
    v_and_b32 v16, 31, v1
    v_lshrrev_b32 v17, 5, v1
    v_lshlrev_b32 v17, 2, v17
    v_sub_u32 v16, v16, v17
    v_mov_b32 v17, 0xffff
    v_mov_b32 v18, 0xffff0000
    v_cmp_le_i32 s[62:63], 0, v16
    v_cmp_le_i32 s[100:101], 1, v16
    s_nop 0
    v_cndmask_b32 v8, 0, v17, s[62:63]
    v_cndmask_b32 v19, 0, v18, s[100:101]
    v_or_b32 v8, v8, v19
    v_cmp_le_i32 s[62:63], 2, v16
    v_cmp_le_i32 s[100:101], 3, v16
    s_nop 0
    v_cndmask_b32 v9, 0, v17, s[62:63]
    v_cndmask_b32 v19, 0, v18, s[100:101]
    v_or_b32 v9, v9, v19
    v_cmp_le_i32 s[62:63], 8, v16
    v_cmp_le_i32 s[100:101], 9, v16
    s_nop 0
    v_cndmask_b32 v10, 0, v17, s[62:63]
    v_cndmask_b32 v19, 0, v18, s[100:101]
    v_or_b32 v10, v10, v19
    v_cmp_le_i32 s[62:63], 10, v16
    v_cmp_le_i32 s[100:101], 11, v16
    s_nop 0
    v_cndmask_b32 v11, 0, v17, s[62:63]
    v_cndmask_b32 v19, 0, v18, s[100:101]
    v_or_b32 v11, v11, v19
    v_cmp_le_i32 s[62:63], 16, v16
    v_cmp_le_i32 s[100:101], 17, v16
    s_nop 0
    v_cndmask_b32 v12, 0, v17, s[62:63]
    v_cndmask_b32 v19, 0, v18, s[100:101]
    v_or_b32 v12, v12, v19
    v_cmp_le_i32 s[62:63], 18, v16
    v_cmp_le_i32 s[100:101], 19, v16
    s_nop 0
    v_cndmask_b32 v13, 0, v17, s[62:63]
    v_cndmask_b32 v19, 0, v18, s[100:101]
    v_or_b32 v13, v13, v19
    v_cmp_le_i32 s[62:63], 24, v16
    v_cmp_le_i32 s[100:101], 25, v16
    s_nop 0
    v_cndmask_b32 v14, 0, v17, s[62:63]
    v_cndmask_b32 v19, 0, v18, s[100:101]
    v_or_b32 v14, v14, v19
    v_cmp_le_i32 s[62:63], 26, v16
    v_cmp_le_i32 s[100:101], 27, v16
    s_nop 0
    v_cndmask_b32 v15, 0, v17, s[62:63]
    v_cndmask_b32 v19, 0, v18, s[100:101]
    v_or_b32 v15, v15, v19
    s_add_u32 s88, s82, s75
    s_lshr_b32 s86, s75, 4
    s_add_u32 s86, s86, s81
    s_add_u32 m0, s88, 0
    s_nop 0
    buffer_load_dwordx4 v6, s[20:23], s86 offen offset:0 lds
    s_add_u32 m0, s88, 960
    s_nop 0
    buffer_load_dwordx4 v6, s[20:23], s86 offen offset:64 lds
    s_add_u32 m0, s88, 1920
    s_nop 0
    buffer_load_dwordx4 v6, s[20:23], s86 offen offset:128 lds
    s_add_u32 m0, s88, 2880
    s_nop 0
    buffer_load_dwordx4 v6, s[20:23], s86 offen offset:192 lds
    s_waitcnt vmcnt(8) lgkmcnt(0)
    s_barrier
    ds_read_b64_tr_b16 a[0:1], v140 offset:0
    ds_read_b64_tr_b16 a[2:3], v140 offset:512
    ds_read_b64_tr_b16 a[8:9], v140 offset:4096
    ds_read_b64_tr_b16 a[10:11], v140 offset:4608
    ds_read_b64_tr_b16 a[4:5], v140 offset:8192
    ds_read_b64_tr_b16 a[6:7], v140 offset:8704
    ds_read_b64_tr_b16 a[12:13], v140 offset:12288
    ds_read_b64_tr_b16 a[14:15], v140 offset:12800
    ds_read_b128 v[16:19], v228 offset:0
    ds_read_b128 v[20:23], v228 offset:16384
    ds_read_b128 v[24:27], v228 offset:32768
    ds_read_b128 v[28:31], v228 offset:49152
    ds_read_b128 v[32:35], v228 offset:1024
    ds_read_b128 v[36:39], v228 offset:17408
    ds_read_b128 v[40:43], v228 offset:33792
    ds_read_b128 v[44:47], v228 offset:50176
    v_add_u32 v96, s82, v228
    ds_read_b128 v[160:163], v96 offset:0
    ds_read_b128 v[164:167], v96 offset:1024
    ds_read_b128 v[168:171], v96 offset:2048
    ds_read_b128 v[172:175], v96 offset:3072
    s_add_u32 s28, s52, s5
    s_add_u32 m0, s54, 32768
    s_add_u32 s64, s28, 0x0
    buffer_load_dwordx4 v142, s[48:51], s64 offen lds
    s_add_u32 m0, s54, 33792
    s_add_u32 s65, s28, 0x6000
    buffer_load_dwordx4 v143, s[48:51], s65 offen lds
    s_add_u32 m0, s54, 34816
    s_add_u32 s66, s28, 0xc000
    buffer_load_dwordx4 v142, s[48:51], s66 offen lds
    s_add_u32 m0, s54, 35840
    s_add_u32 s67, s28, 0x12000
    buffer_load_dwordx4 v143, s[48:51], s67 offen lds
    s_add_u32 s88, s82, s76
    s_lshr_b32 s86, s76, 4
    s_add_u32 s86, s86, s81
    s_add_u32 m0, s88, 0
    s_nop 0
    buffer_load_dwordx4 v6, s[20:23], s86 offen offset:0 lds
    s_add_u32 m0, s88, 960
    s_nop 0
    buffer_load_dwordx4 v6, s[20:23], s86 offen offset:64 lds
    s_add_u32 m0, s88, 1920
    s_nop 0
    buffer_load_dwordx4 v6, s[20:23], s86 offen offset:128 lds
    s_add_u32 m0, s88, 2880
    s_nop 0
    buffer_load_dwordx4 v6, s[20:23], s86 offen offset:192 lds
    s_add_u32 s28, s52, s5
    s_add_u32 m0, s54, 49152
    s_add_u32 s68, s28, 0x30000
    buffer_load_dwordx4 v142, s[48:51], s68 offen lds
    s_add_u32 m0, s54, 50176
    s_add_u32 s69, s28, 0x36000
    buffer_load_dwordx4 v143, s[48:51], s69 offen lds
    s_add_u32 m0, s54, 51200
    s_add_u32 s70, s28, 0x3c000
    buffer_load_dwordx4 v142, s[48:51], s70 offen lds
    s_add_u32 m0, s54, 52224
    s_add_u32 s71, s28, 0x42000
    buffer_load_dwordx4 v143, s[48:51], s71 offen lds
    s_add_u32 s88, s82, s77
    s_lshr_b32 s86, s77, 4
    s_add_u32 s86, s86, s81
    s_add_u32 m0, s88, 0
    s_nop 0
    buffer_load_dwordx4 v6, s[20:23], s86 offen offset:0 lds
    s_add_u32 m0, s88, 960
    s_nop 0
    buffer_load_dwordx4 v6, s[20:23], s86 offen offset:64 lds
    s_add_u32 m0, s88, 1920
    s_nop 0
    buffer_load_dwordx4 v6, s[20:23], s86 offen offset:128 lds
    s_add_u32 m0, s88, 2880
    s_nop 0
    buffer_load_dwordx4 v6, s[20:23], s86 offen offset:192 lds
    s_add_u32 s28, s52, s6
    s_add_u32 m0, s54, 65536
    s_add_u32 s64, s28, 0x0
    buffer_load_dwordx4 v142, s[48:51], s64 offen lds
    s_add_u32 m0, s54, 66560
    s_add_u32 s65, s28, 0x6000
    buffer_load_dwordx4 v143, s[48:51], s65 offen lds
    s_add_u32 m0, s54, 67584
    s_add_u32 s66, s28, 0xc000
    buffer_load_dwordx4 v142, s[48:51], s66 offen lds
    s_add_u32 m0, s54, 68608
    s_add_u32 s67, s28, 0x12000
    buffer_load_dwordx4 v143, s[48:51], s67 offen lds
    s_waitcnt vmcnt(20) lgkmcnt(0)
    s_barrier
    v_mfma_f32_16x16x32_bf16 v[48:51], a[0:3], v[16:19], 0
    ds_read_b64_tr_b16 a[16:17], v140 offset:16384
    ds_read_b64_tr_b16 a[18:19], v140 offset:16896
    v_mfma_f32_16x16x32_bf16 v[64:67], v[16:19], a[4:7], 0
    ds_read_b64_tr_b16 a[24:25], v140 offset:20480
    v_mfma_f32_16x16x32_bf16 v[52:55], a[0:3], v[20:23], 0
    ds_read_b64_tr_b16 a[26:27], v140 offset:20992
    v_mfma_f32_16x16x32_bf16 v[68:71], v[20:23], a[4:7], 0
    ds_read_b64_tr_b16 a[20:21], v140 offset:24576
    ds_read_b64_tr_b16 a[22:23], v140 offset:25088
    v_mfma_f32_16x16x32_bf16 v[56:59], a[0:3], v[24:27], 0
    ds_read_b64_tr_b16 a[28:29], v140 offset:28672
    v_mfma_f32_16x16x32_bf16 v[72:75], v[24:27], a[4:7], 0
    ds_read_b64_tr_b16 a[30:31], v140 offset:29184
    v_mfma_f32_16x16x32_bf16 v[60:63], a[0:3], v[28:31], 0
    ds_read_b128 v[192:195], v228 offset:2048
    ds_read_b128 v[196:199], v228 offset:18432
    v_mfma_f32_16x16x32_bf16 v[76:79], v[28:31], a[4:7], 0
    ds_read_b128 v[200:203], v228 offset:34816
    v_mfma_f32_16x16x32_bf16 v[100:103], a[0:3], v[136:139], 0
    ds_read_b128 v[204:207], v228 offset:51200
    v_mfma_f32_16x16x32_bf16 v[104:107], v[136:139], a[4:7], 0
    ds_read_b128 v[208:211], v228 offset:3072
    ds_read_b128 v[212:215], v228 offset:19456
    v_mfma_f32_16x16x32_bf16 v[48:51], a[8:11], v[32:35], v[48:51]
    ds_read_b128 v[216:219], v228 offset:35840
    v_mfma_f32_16x16x32_bf16 v[64:67], v[32:35], a[12:15], v[64:67]
    ds_read_b128 v[220:223], v228 offset:52224
    v_mfma_f32_16x16x32_bf16 v[52:55], a[8:11], v[36:39], v[52:55]
    v_add_u32 v96, s82, v229
    ds_read_b128 v[176:179], v96 offset:0
    v_mfma_f32_16x16x32_bf16 v[68:71], v[36:39], a[12:15], v[68:71]
    ds_read_b128 v[180:183], v96 offset:1024
    v_mfma_f32_16x16x32_bf16 v[56:59], a[8:11], v[40:43], v[56:59]
    ds_read_b128 v[184:187], v96 offset:2048
    v_mfma_f32_16x16x32_bf16 v[72:75], v[40:43], a[12:15], v[72:75]
    ds_read_b128 v[188:191], v96 offset:3072
    v_mfma_f32_16x16x32_bf16 v[60:63], a[8:11], v[44:47], v[60:63]
    s_add_u32 s28, s52, s6
    s_add_u32 m0, s54, 0
    s_add_u32 s68, s28, 0x30000
    buffer_load_dwordx4 v142, s[48:51], s68 offen lds
    v_mfma_f32_16x16x32_bf16 v[76:79], v[44:47], a[12:15], v[76:79]
    v_mfma_f32_16x16x32_bf16 v[100:103], a[8:11], v[136:139], v[100:103]
    s_add_u32 m0, s54, 1024
    s_add_u32 s69, s28, 0x36000
    buffer_load_dwordx4 v143, s[48:51], s69 offen lds
    v_mfma_f32_16x16x32_bf16 v[104:107], v[136:139], a[12:15], v[104:107]
    v_mfma_f32_16x16x32_bf16 v[112:115], v[160:163], v[160:163], 0
    s_add_u32 m0, s54, 2048
    s_add_u32 s70, s28, 0x3c000
    buffer_load_dwordx4 v142, s[48:51], s70 offen lds
    v_mfma_f32_16x16x32_bf16 v[116:119], v[136:139], v[160:163], 0
    v_mfma_f32_16x16x32_bf16 v[112:115], v[164:167], v[164:167], v[112:115]
    v_mfma_f32_16x16x32_bf16 v[116:119], v[136:139], v[164:167], v[116:119]
    s_add_u32 m0, s54, 3072
    s_add_u32 s71, s28, 0x42000
    buffer_load_dwordx4 v143, s[48:51], s71 offen lds
    v_mfma_f32_16x16x32_bf16 v[112:115], v[168:171], v[168:171], v[112:115]
    v_mfma_f32_16x16x32_bf16 v[116:119], v[136:139], v[168:171], v[116:119]
    s_and_b32 s30, s10, 3
    s_lshl_b32 s30, s30, 5
    s_add_u32 s30, s30, s13
    s_lshr_b32 s28, s10, 2
    s_lshl_b32 s28, s28, 7
    s_mul_i32 s31, s30, 12288
    s_add_u32 s31, s31, s28
    s_add_u32 s40, s40, s31
    s_addc_u32 s41, s41, 0
    s_lshl_b32 s30, s2, 2
    s_add_u32 s30, s30, s12
    s_lshl_b32 s31, s30, 9
    s_add_u32 s36, s36, s31
    s_addc_u32 s37, s37, 0
    s_add_u32 s42, s42, s31
    s_addc_u32 s43, s43, 0
    v_lshlrev_b32 v226, 10, v1
    s_mov_b64 exec, 0xfff
    global_load_dword v224, v226, s[40:41]
    s_mov_b64 exec, 0xf
    v_lshlrev_b32 v226, 7, v1
    global_load_dword v224, v226, s[42:43]
    global_load_dword v224, v226, s[36:37]
    s_mov_b64 exec, 1
    buffer_load_dword v224, v226, s[16:19], s29 offen
    s_lshl_b32 s31, s10, 3
    s_add_u32 s31, s31, s11
    s_lshl_b32 s31, s31, 7
    s_add_u32 s31, s31, 0x438000
    buffer_load_dword v224, v226, s[16:19], s31 offen
    s_lshl_b32 s31, s10, 8
    s_add_u32 s31, s31, 0x440000
    s_mov_b64 exec, 3
    buffer_load_dword v224, v226, s[16:19], s31 offen
    s_mov_b64 exec, -1
    v_mfma_f32_16x16x32_bf16 v[112:115], v[172:175], v[172:175], v[112:115]
    v_mfma_f32_16x16x32_bf16 v[116:119], v[136:139], v[172:175], v[116:119]
    s_waitcnt vmcnt(22) lgkmcnt(0)
    s_barrier
    v_mfma_f32_16x16x32_bf16 v[48:51], a[16:19], v[192:195], v[48:51]
    ds_read_b64_tr_b16 a[32:33], v140 offset:32768
    ds_read_b64_tr_b16 a[34:35], v140 offset:33280
    v_mfma_f32_16x16x32_bf16 v[64:67], v[192:195], a[20:23], v[64:67]
    ds_read_b64_tr_b16 a[40:41], v140 offset:36864
    v_mfma_f32_16x16x32_bf16 v[52:55], a[16:19], v[196:199], v[52:55]
    ds_read_b64_tr_b16 a[42:43], v140 offset:37376
    v_mfma_f32_16x16x32_bf16 v[68:71], v[196:199], a[20:23], v[68:71]
    ds_read_b64_tr_b16 a[36:37], v140 offset:40960
    ds_read_b64_tr_b16 a[38:39], v140 offset:41472
    v_mfma_f32_16x16x32_bf16 v[56:59], a[16:19], v[200:203], v[56:59]
    ds_read_b64_tr_b16 a[44:45], v140 offset:45056
    v_mfma_f32_16x16x32_bf16 v[72:75], v[200:203], a[20:23], v[72:75]
    ds_read_b64_tr_b16 a[46:47], v140 offset:45568
    v_mfma_f32_16x16x32_bf16 v[60:63], a[16:19], v[204:207], v[60:63]
    ds_read_b128 v[16:19], v229 offset:0
    ds_read_b128 v[20:23], v229 offset:16384
    v_mfma_f32_16x16x32_bf16 v[76:79], v[204:207], a[20:23], v[76:79]
    ds_read_b128 v[24:27], v229 offset:32768
    v_mfma_f32_16x16x32_bf16 v[100:103], a[16:19], v[136:139], v[100:103]
    ds_read_b128 v[28:31], v229 offset:49152
    v_mfma_f32_16x16x32_bf16 v[104:107], v[136:139], a[20:23], v[104:107]
    ds_read_b128 v[32:35], v229 offset:1024
    ds_read_b128 v[36:39], v229 offset:17408
    v_mfma_f32_16x16x32_bf16 v[48:51], a[24:27], v[208:211], v[48:51]
    ds_read_b128 v[40:43], v229 offset:33792
    v_mfma_f32_16x16x32_bf16 v[64:67], v[208:211], a[28:31], v[64:67]
    ds_read_b128 v[44:47], v229 offset:50176
    v_mfma_f32_16x16x32_bf16 v[52:55], a[24:27], v[212:215], v[52:55]
    v_add_u32 v96, s82, v230
    ds_read_b128 v[160:163], v96 offset:0
    v_mfma_f32_16x16x32_bf16 v[68:71], v[212:215], a[28:31], v[68:71]
    ds_read_b128 v[164:167], v96 offset:1024
    v_mfma_f32_16x16x32_bf16 v[56:59], a[24:27], v[216:219], v[56:59]
    ds_read_b128 v[168:171], v96 offset:2048
    v_mfma_f32_16x16x32_bf16 v[72:75], v[216:219], a[28:31], v[72:75]
    ds_read_b128 v[172:175], v96 offset:3072
    v_mfma_f32_16x16x32_bf16 v[60:63], a[24:27], v[220:223], v[60:63]
    s_add_u32 s28, s52, s7
    s_add_u32 m0, s54, 16384
    s_add_u32 s64, s28, 0x0
    buffer_load_dwordx4 v142, s[48:51], s64 offen lds
    v_mfma_f32_16x16x32_bf16 v[76:79], v[220:223], a[28:31], v[76:79]
    v_mfma_f32_16x16x32_bf16 v[100:103], a[24:27], v[136:139], v[100:103]
    v_mfma_f32_16x16x32_bf16 v[104:107], v[136:139], a[28:31], v[104:107]
    s_add_u32 m0, s54, 17408
    s_add_u32 s65, s28, 0x6000
    buffer_load_dwordx4 v143, s[48:51], s65 offen lds
    v_mfma_f32_16x16x32_bf16 v[112:115], v[176:179], v[176:179], v[112:115]
    v_mfma_f32_16x16x32_bf16 v[116:119], v[136:139], v[176:179], v[116:119]
    v_mfma_f32_16x16x32_bf16 v[112:115], v[180:183], v[180:183], v[112:115]
    s_add_u32 m0, s54, 18432
    s_add_u32 s66, s28, 0xc000
    buffer_load_dwordx4 v142, s[48:51], s66 offen lds
    v_mfma_f32_16x16x32_bf16 v[116:119], v[136:139], v[180:183], v[116:119]
    v_mfma_f32_16x16x32_bf16 v[112:115], v[184:187], v[184:187], v[112:115]
    v_mfma_f32_16x16x32_bf16 v[116:119], v[136:139], v[184:187], v[116:119]
    s_add_u32 m0, s54, 19456
    s_add_u32 s67, s28, 0x12000
    buffer_load_dwordx4 v143, s[48:51], s67 offen lds
    v_mfma_f32_16x16x32_bf16 v[112:115], v[188:191], v[188:191], v[112:115]
    v_mfma_f32_16x16x32_bf16 v[116:119], v[136:139], v[188:191], v[116:119]
    s_waitcnt vmcnt(18) lgkmcnt(0)
    s_barrier
    v_mfma_f32_16x16x32_bf16 v[48:51], a[32:35], v[16:19], v[48:51]
    ds_read_b64_tr_b16 a[48:49], v140 offset:49152
    ds_read_b64_tr_b16 a[50:51], v140 offset:49664
    v_mfma_f32_16x16x32_bf16 v[64:67], v[16:19], a[36:39], v[64:67]
    ds_read_b64_tr_b16 a[56:57], v140 offset:53248
    v_mfma_f32_16x16x32_bf16 v[52:55], a[32:35], v[20:23], v[52:55]
    ds_read_b64_tr_b16 a[58:59], v140 offset:53760
    v_mfma_f32_16x16x32_bf16 v[68:71], v[20:23], a[36:39], v[68:71]
    ds_read_b64_tr_b16 a[52:53], v140 offset:57344
    ds_read_b64_tr_b16 a[54:55], v140 offset:57856
    v_mfma_f32_16x16x32_bf16 v[56:59], a[32:35], v[24:27], v[56:59]
    ds_read_b64_tr_b16 a[60:61], v140 offset:61440
    v_mfma_f32_16x16x32_bf16 v[72:75], v[24:27], a[36:39], v[72:75]
    ds_read_b64_tr_b16 a[62:63], v140 offset:61952
    v_mfma_f32_16x16x32_bf16 v[60:63], a[32:35], v[28:31], v[60:63]
    ds_read_b128 v[192:195], v229 offset:2048
    ds_read_b128 v[196:199], v229 offset:18432
    v_mfma_f32_16x16x32_bf16 v[76:79], v[28:31], a[36:39], v[76:79]
    ds_read_b128 v[200:203], v229 offset:34816
    v_mfma_f32_16x16x32_bf16 v[100:103], a[32:35], v[136:139], v[100:103]
    ds_read_b128 v[204:207], v229 offset:51200
    v_mfma_f32_16x16x32_bf16 v[104:107], v[136:139], a[36:39], v[104:107]
    ds_read_b128 v[208:211], v229 offset:3072
    ds_read_b128 v[212:215], v229 offset:19456
    v_mfma_f32_16x16x32_bf16 v[48:51], a[40:43], v[32:35], v[48:51]
    ds_read_b128 v[216:219], v229 offset:35840
    v_mfma_f32_16x16x32_bf16 v[64:67], v[32:35], a[44:47], v[64:67]
    ds_read_b128 v[220:223], v229 offset:52224
    v_mfma_f32_16x16x32_bf16 v[52:55], a[40:43], v[36:39], v[52:55]
    v_add_u32 v96, s82, v231
    ds_read_b128 v[176:179], v96 offset:0
    v_mfma_f32_16x16x32_bf16 v[68:71], v[36:39], a[44:47], v[68:71]
    ds_read_b128 v[180:183], v96 offset:1024
    v_mfma_f32_16x16x32_bf16 v[56:59], a[40:43], v[40:43], v[56:59]
    ds_read_b128 v[184:187], v96 offset:2048
    v_mfma_f32_16x16x32_bf16 v[72:75], v[40:43], a[44:47], v[72:75]
    ds_read_b128 v[188:191], v96 offset:3072
    v_mfma_f32_16x16x32_bf16 v[60:63], a[40:43], v[44:47], v[60:63]
    s_add_u32 s28, s52, s7
    s_add_u32 m0, s54, 32768
    s_add_u32 s68, s28, 0x30000
    buffer_load_dwordx4 v142, s[48:51], s68 offen lds
    v_mfma_f32_16x16x32_bf16 v[76:79], v[44:47], a[44:47], v[76:79]
    v_mfma_f32_16x16x32_bf16 v[100:103], a[40:43], v[136:139], v[100:103]
    s_add_u32 m0, s54, 33792
    s_add_u32 s69, s28, 0x36000
    buffer_load_dwordx4 v143, s[48:51], s69 offen lds
    v_mfma_f32_16x16x32_bf16 v[104:107], v[136:139], a[44:47], v[104:107]
    v_mfma_f32_16x16x32_bf16 v[112:115], v[160:163], v[160:163], v[112:115]
    s_add_u32 m0, s54, 34816
    s_add_u32 s70, s28, 0x3c000
    buffer_load_dwordx4 v142, s[48:51], s70 offen lds
    v_mfma_f32_16x16x32_bf16 v[116:119], v[136:139], v[160:163], v[116:119]
    v_mfma_f32_16x16x32_bf16 v[112:115], v[164:167], v[164:167], v[112:115]
    v_mfma_f32_16x16x32_bf16 v[116:119], v[136:139], v[164:167], v[116:119]
    s_add_u32 m0, s54, 35840
    s_add_u32 s71, s28, 0x42000
    buffer_load_dwordx4 v143, s[48:51], s71 offen lds
    v_mfma_f32_16x16x32_bf16 v[112:115], v[168:171], v[168:171], v[112:115]
    v_mfma_f32_16x16x32_bf16 v[116:119], v[136:139], v[168:171], v[116:119]
    v_mov_b32 v226, 0
    buffer_load_dword v225, v226, s[24:27], 0 offen sc1
    v_mfma_f32_16x16x32_bf16 v[112:115], v[172:175], v[172:175], v[112:115]
    v_mfma_f32_16x16x32_bf16 v[116:119], v[136:139], v[172:175], v[116:119]
    s_waitcnt vmcnt(19) lgkmcnt(0)
    s_barrier
    v_mfma_f32_16x16x32_bf16 v[48:51], a[48:51], v[192:195], v[48:51]
    ds_read_b64_tr_b16 a[64:65], v141 offset:0
    v_mfma_f32_16x16x32_bf16 v[64:67], v[192:195], a[52:55], v[64:67]
    ds_read_b64_tr_b16 a[66:67], v141 offset:512
    v_mfma_f32_16x16x32_bf16 v[52:55], a[48:51], v[196:199], v[52:55]
    ds_read_b64_tr_b16 a[72:73], v141 offset:4096
    v_mfma_f32_16x16x32_bf16 v[68:71], v[196:199], a[52:55], v[68:71]
    ds_read_b64_tr_b16 a[74:75], v141 offset:4608
    v_mfma_f32_16x16x32_bf16 v[56:59], a[48:51], v[200:203], v[56:59]
    ds_read_b64_tr_b16 a[68:69], v141 offset:8192
    v_mfma_f32_16x16x32_bf16 v[72:75], v[200:203], a[52:55], v[72:75]
    ds_read_b64_tr_b16 a[70:71], v141 offset:8704
    v_mfma_f32_16x16x32_bf16 v[60:63], a[48:51], v[204:207], v[60:63]
    ds_read_b64_tr_b16 a[76:77], v141 offset:12288
    v_mfma_f32_16x16x32_bf16 v[76:79], v[204:207], a[52:55], v[76:79]
    ds_read_b64_tr_b16 a[78:79], v141 offset:12800
    v_mfma_f32_16x16x32_bf16 v[100:103], a[48:51], v[136:139], v[100:103]
    ds_read_b128 v[16:19], v230 offset:0
    v_mfma_f32_16x16x32_bf16 v[104:107], v[136:139], a[52:55], v[104:107]
    ds_read_b128 v[20:23], v230 offset:16384
    v_mfma_f32_16x16x32_bf16 v[48:51], a[56:59], v[208:211], v[48:51]
    ds_read_b128 v[24:27], v230 offset:32768
    v_mfma_f32_16x16x32_bf16 v[64:67], v[208:211], a[60:63], v[64:67]
    ds_read_b128 v[28:31], v230 offset:49152
    v_mfma_f32_16x16x32_bf16 v[52:55], a[56:59], v[212:215], v[52:55]
    ds_read_b128 v[32:35], v230 offset:1024
    v_mfma_f32_16x16x32_bf16 v[68:71], v[212:215], a[60:63], v[68:71]
    ds_read_b128 v[36:39], v230 offset:17408
    v_mfma_f32_16x16x32_bf16 v[56:59], a[56:59], v[216:219], v[56:59]
    ds_read_b128 v[40:43], v230 offset:33792
    v_mfma_f32_16x16x32_bf16 v[72:75], v[216:219], a[60:63], v[72:75]
    ds_read_b128 v[44:47], v230 offset:50176
    v_mfma_f32_16x16x32_bf16 v[60:63], a[56:59], v[220:223], v[60:63]
    s_add_u32 s28, s53, s4
    s_add_u32 m0, s54, 49152
    s_add_u32 s64, s28, 0x0
    buffer_load_dwordx4 v142, s[48:51], s64 offen lds
    v_mfma_f32_16x16x32_bf16 v[76:79], v[220:223], a[60:63], v[76:79]
    v_mfma_f32_16x16x32_bf16 v[100:103], a[56:59], v[136:139], v[100:103]
    v_mfma_f32_16x16x32_bf16 v[104:107], v[136:139], a[60:63], v[104:107]
    s_add_u32 m0, s54, 50176
    s_add_u32 s65, s28, 0x6000
    buffer_load_dwordx4 v143, s[48:51], s65 offen lds
    v_mfma_f32_16x16x32_bf16 v[112:115], v[176:179], v[176:179], v[112:115]
    v_mfma_f32_16x16x32_bf16 v[116:119], v[136:139], v[176:179], v[116:119]
    v_mfma_f32_16x16x32_bf16 v[112:115], v[180:183], v[180:183], v[112:115]
    s_add_u32 m0, s54, 51200
    s_add_u32 s66, s28, 0xc000
    buffer_load_dwordx4 v142, s[48:51], s66 offen lds
    v_mfma_f32_16x16x32_bf16 v[116:119], v[136:139], v[180:183], v[116:119]
    v_mfma_f32_16x16x32_bf16 v[112:115], v[184:187], v[184:187], v[112:115]
    v_mfma_f32_16x16x32_bf16 v[116:119], v[136:139], v[184:187], v[116:119]
    s_add_u32 m0, s54, 52224
    s_add_u32 s67, s28, 0x12000
    buffer_load_dwordx4 v143, s[48:51], s67 offen lds
    v_mfma_f32_16x16x32_bf16 v[112:115], v[188:191], v[188:191], v[112:115]
    v_mfma_f32_16x16x32_bf16 v[116:119], v[136:139], v[188:191], v[116:119]
    s_waitcnt vmcnt(19) lgkmcnt(0)
    s_barrier
    s_mov_b32 s62, 0x22222222
    s_mov_b32 s63, 0x22222222
    s_nop 2
    v_cndmask_b32 v97, v112, v113, s[62:63]
    s_mov_b32 s62, 0x44444444
    s_mov_b32 s63, 0x44444444
    v_cndmask_b32 v97, v97, v114, s[62:63]
    s_mov_b32 s62, 0x88888888
    s_mov_b32 s63, 0x88888888
    v_cndmask_b32 v97, v97, v115, s[62:63]
    v_mov_b32 v96, v116
    v_mul_f32 v96, 0x3b000000, v96
    v_mul_f32 v97, 0x3b000000, v97
    v_fma_f32 v97, -v96, v96, v97
    v_max_f32 v97, 0, v97
    v_add_f32 v97, 0x3727c5ac, v97
    v_rsq_f32 v97, v97
    v_lshrrev_b32 v98, 6, v0
    v_and_b32 v99, 15, v1
    v_lshl_add_u32 v98, v98, 4, v99
    v_lshlrev_b32 v98, 2, v98
    v_add_u32 v98, 161792, v98
    s_mov_b32 exec_lo, 0xf0000f
    s_mov_b32 exec_hi, 0xf0000f00
    ds_write2_b32 v98, v97, v96 offset1:64
    s_mov_b64 exec, -1
    v_mfma_f32_16x16x32_bf16 v[48:51], a[64:67], v[16:19], v[48:51]
    ds_read_b64_tr_b16 a[80:81], v140 offset:0
    ds_read_b64_tr_b16 a[82:83], v140 offset:512
    v_mfma_f32_16x16x32_bf16 v[64:67], v[16:19], a[68:71], v[64:67]
    ds_read_b64_tr_b16 a[88:89], v140 offset:4096
    v_mfma_f32_16x16x32_bf16 v[52:55], a[64:67], v[20:23], v[52:55]
    ds_read_b64_tr_b16 a[90:91], v140 offset:4608
    v_mfma_f32_16x16x32_bf16 v[68:71], v[20:23], a[68:71], v[68:71]
    ds_read_b64_tr_b16 a[84:85], v140 offset:8192
    ds_read_b64_tr_b16 a[86:87], v140 offset:8704
    v_mfma_f32_16x16x32_bf16 v[56:59], a[64:67], v[24:27], v[56:59]
    ds_read_b64_tr_b16 a[92:93], v140 offset:12288
    v_mfma_f32_16x16x32_bf16 v[72:75], v[24:27], a[68:71], v[72:75]
    ds_read_b64_tr_b16 a[94:95], v140 offset:12800
    v_mfma_f32_16x16x32_bf16 v[60:63], a[64:67], v[28:31], v[60:63]
    ds_read_b128 v[192:195], v230 offset:2048
    ds_read_b128 v[196:199], v230 offset:18432
    v_mfma_f32_16x16x32_bf16 v[76:79], v[28:31], a[68:71], v[76:79]
    ds_read_b128 v[200:203], v230 offset:34816
    v_mfma_f32_16x16x32_bf16 v[100:103], a[64:67], v[136:139], v[100:103]
    ds_read_b128 v[204:207], v230 offset:51200
    v_mfma_f32_16x16x32_bf16 v[104:107], v[136:139], a[68:71], v[104:107]
    ds_read_b128 v[144:147], v230 offset:3072
    ds_read_b128 v[148:151], v230 offset:19456
    v_mfma_f32_16x16x32_bf16 v[48:51], a[72:75], v[32:35], v[48:51]
    ds_read_b128 v[152:155], v230 offset:35840
    v_mfma_f32_16x16x32_bf16 v[64:67], v[32:35], a[76:79], v[64:67]
    ds_read_b128 v[156:159], v230 offset:52224
    v_mfma_f32_16x16x32_bf16 v[52:55], a[72:75], v[36:39], v[52:55]
    s_add_u32 s28, s53, s5
    s_add_u32 m0, s54, 65536
    s_add_u32 s68, s28, 0x0
    buffer_load_dwordx4 v142, s[48:51], s68 offen lds
    v_mfma_f32_16x16x32_bf16 v[68:71], v[36:39], a[76:79], v[68:71]
    v_mfma_f32_16x16x32_bf16 v[56:59], a[72:75], v[40:43], v[56:59]
    s_add_u32 m0, s54, 66560
    s_add_u32 s69, s28, 0x6000
    buffer_load_dwordx4 v143, s[48:51], s69 offen lds
    v_mfma_f32_16x16x32_bf16 v[72:75], v[40:43], a[76:79], v[72:75]
    v_mfma_f32_16x16x32_bf16 v[60:63], a[72:75], v[44:47], v[60:63]
    s_add_u32 m0, s54, 67584
    s_add_u32 s70, s28, 0xc000
    buffer_load_dwordx4 v142, s[48:51], s70 offen lds
    v_mfma_f32_16x16x32_bf16 v[76:79], v[44:47], a[76:79], v[76:79]
    v_mfma_f32_16x16x32_bf16 v[100:103], a[72:75], v[136:139], v[100:103]
    s_add_u32 m0, s54, 68608
    s_add_u32 s71, s28, 0x12000
    buffer_load_dwordx4 v143, s[48:51], s71 offen lds
    v_mfma_f32_16x16x32_bf16 v[104:107], v[136:139], a[76:79], v[104:107]
    s_waitcnt vmcnt(13) lgkmcnt(0)
    s_barrier
    v_mfma_f32_16x16x32_bf16 v[48:51], a[80:83], v[192:195], v[48:51]
    ds_read_b64_tr_b16 a[96:97], v140 offset:16384
    ds_read_b64_tr_b16 a[98:99], v140 offset:16896
    v_mfma_f32_16x16x32_bf16 v[64:67], v[192:195], a[84:87], v[64:67]
    ds_read_b64_tr_b16 a[104:105], v140 offset:20480
    v_mfma_f32_16x16x32_bf16 v[52:55], a[80:83], v[196:199], v[52:55]
    ds_read_b64_tr_b16 a[106:107], v140 offset:20992
    v_mfma_f32_16x16x32_bf16 v[68:71], v[196:199], a[84:87], v[68:71]
    ds_read_b64_tr_b16 a[100:101], v140 offset:24576
    ds_read_b64_tr_b16 a[102:103], v140 offset:25088
    v_mfma_f32_16x16x32_bf16 v[56:59], a[80:83], v[200:203], v[56:59]
    ds_read_b64_tr_b16 a[108:109], v140 offset:28672
    v_mfma_f32_16x16x32_bf16 v[72:75], v[200:203], a[84:87], v[72:75]
    ds_read_b64_tr_b16 a[110:111], v140 offset:29184
    v_mfma_f32_16x16x32_bf16 v[60:63], a[80:83], v[204:207], v[60:63]
    ds_read_b128 v[160:163], v231 offset:0
    ds_read_b128 v[164:167], v231 offset:16384
    v_mfma_f32_16x16x32_bf16 v[76:79], v[204:207], a[84:87], v[76:79]
    ds_read_b128 v[168:171], v231 offset:32768
    v_mfma_f32_16x16x32_bf16 v[100:103], a[80:83], v[136:139], v[100:103]
    ds_read_b128 v[172:175], v231 offset:49152
    v_mfma_f32_16x16x32_bf16 v[104:107], v[136:139], a[84:87], v[104:107]
    ds_read_b128 v[176:179], v231 offset:1024
    ds_read_b128 v[180:183], v231 offset:17408
    v_mfma_f32_16x16x32_bf16 v[48:51], a[88:91], v[144:147], v[48:51]
    ds_read_b128 v[184:187], v231 offset:33792
    v_mfma_f32_16x16x32_bf16 v[64:67], v[144:147], a[92:95], v[64:67]
    ds_read_b128 v[188:191], v231 offset:50176
    v_mfma_f32_16x16x32_bf16 v[52:55], a[88:91], v[148:151], v[52:55]
    s_add_u32 s28, s53, s6
    s_add_u32 m0, s54, 0
    s_add_u32 s64, s28, 0x0
    buffer_load_dwordx4 v142, s[48:51], s64 offen lds
    v_mfma_f32_16x16x32_bf16 v[68:71], v[148:151], a[92:95], v[68:71]
    v_mfma_f32_16x16x32_bf16 v[56:59], a[88:91], v[152:155], v[56:59]
    s_add_u32 m0, s54, 1024
    s_add_u32 s65, s28, 0x6000
    buffer_load_dwordx4 v143, s[48:51], s65 offen lds
    v_mfma_f32_16x16x32_bf16 v[72:75], v[152:155], a[92:95], v[72:75]
    v_mfma_f32_16x16x32_bf16 v[60:63], a[88:91], v[156:159], v[60:63]
    s_add_u32 m0, s54, 2048
    s_add_u32 s66, s28, 0xc000
    buffer_load_dwordx4 v142, s[48:51], s66 offen lds
    v_mfma_f32_16x16x32_bf16 v[76:79], v[156:159], a[92:95], v[76:79]
    v_mfma_f32_16x16x32_bf16 v[100:103], a[88:91], v[136:139], v[100:103]
    s_add_u32 m0, s54, 3072
    s_add_u32 s67, s28, 0x12000
    buffer_load_dwordx4 v143, s[48:51], s67 offen lds
    v_mfma_f32_16x16x32_bf16 v[104:107], v[136:139], a[92:95], v[104:107]
    s_waitcnt vmcnt(13) lgkmcnt(0)
    s_barrier
    v_mfma_f32_16x16x32_bf16 v[48:51], a[96:99], v[160:163], v[48:51]
    ds_read_b64_tr_b16 a[112:113], v140 offset:32768
    ds_read_b64_tr_b16 a[114:115], v140 offset:33280
    v_mfma_f32_16x16x32_bf16 v[64:67], v[160:163], a[100:103], v[64:67]
    ds_read_b64_tr_b16 a[120:121], v140 offset:36864
    v_mfma_f32_16x16x32_bf16 v[52:55], a[96:99], v[164:167], v[52:55]
    ds_read_b64_tr_b16 a[122:123], v140 offset:37376
    v_mfma_f32_16x16x32_bf16 v[68:71], v[164:167], a[100:103], v[68:71]
    ds_read_b64_tr_b16 a[116:117], v140 offset:40960
    ds_read_b64_tr_b16 a[118:119], v140 offset:41472
    v_mfma_f32_16x16x32_bf16 v[56:59], a[96:99], v[168:171], v[56:59]
    ds_read_b64_tr_b16 a[124:125], v140 offset:45056
    v_mfma_f32_16x16x32_bf16 v[72:75], v[168:171], a[100:103], v[72:75]
    ds_read_b64_tr_b16 a[126:127], v140 offset:45568
    v_mfma_f32_16x16x32_bf16 v[60:63], a[96:99], v[172:175], v[60:63]
    ds_read_b128 v[192:195], v231 offset:2048
    ds_read_b128 v[196:199], v231 offset:18432
    v_mfma_f32_16x16x32_bf16 v[76:79], v[172:175], a[100:103], v[76:79]
    ds_read_b128 v[200:203], v231 offset:34816
    v_mfma_f32_16x16x32_bf16 v[100:103], a[96:99], v[136:139], v[100:103]
    ds_read_b128 v[204:207], v231 offset:51200
    v_mfma_f32_16x16x32_bf16 v[104:107], v[136:139], a[100:103], v[104:107]
    ds_read_b128 v[208:211], v231 offset:3072
    ds_read_b128 v[212:215], v231 offset:19456
    v_mfma_f32_16x16x32_bf16 v[48:51], a[104:107], v[176:179], v[48:51]
    ds_read_b128 v[216:219], v231 offset:35840
    v_mfma_f32_16x16x32_bf16 v[64:67], v[176:179], a[108:111], v[64:67]
    ds_read_b128 v[220:223], v231 offset:52224
    v_mfma_f32_16x16x32_bf16 v[52:55], a[104:107], v[180:183], v[52:55]
    s_add_u32 s28, s53, s7
    s_add_u32 m0, s54, 16384
    s_add_u32 s68, s28, 0x0
    buffer_load_dwordx4 v142, s[48:51], s68 offen lds
    v_mfma_f32_16x16x32_bf16 v[68:71], v[180:183], a[108:111], v[68:71]
    v_mfma_f32_16x16x32_bf16 v[56:59], a[104:107], v[184:187], v[56:59]
    s_add_u32 m0, s54, 17408
    s_add_u32 s69, s28, 0x6000
    buffer_load_dwordx4 v143, s[48:51], s69 offen lds
    v_mfma_f32_16x16x32_bf16 v[72:75], v[184:187], a[108:111], v[72:75]
    v_mfma_f32_16x16x32_bf16 v[60:63], a[104:107], v[188:191], v[60:63]
    s_add_u32 m0, s54, 18432
    s_add_u32 s70, s28, 0xc000
    buffer_load_dwordx4 v142, s[48:51], s70 offen lds
    v_mfma_f32_16x16x32_bf16 v[76:79], v[188:191], a[108:111], v[76:79]
    v_mfma_f32_16x16x32_bf16 v[100:103], a[104:107], v[136:139], v[100:103]
    s_add_u32 m0, s54, 19456
    s_add_u32 s71, s28, 0x12000
    buffer_load_dwordx4 v143, s[48:51], s71 offen lds
    v_mfma_f32_16x16x32_bf16 v[104:107], v[136:139], a[108:111], v[104:107]
    s_waitcnt lgkmcnt(0)
    s_barrier
    v_lshrrev_b32 v248, 4, v1
    v_lshlrev_b32 v248, 4, v248
    v_add_u32 v248, 161792, v248
    v_and_b32 v249, 15, v1
    v_lshlrev_b32 v249, 2, v249
    v_add_u32 v249, 161792, v249
    ds_read2_b32 v[128:129], v249 offset0:0 offset1:64
    ds_read2_b32 v[130:131], v249 offset0:16 offset1:80
    ds_read2_b32 v[132:133], v249 offset0:32 offset1:96
    ds_read2_b32 v[134:135], v249 offset0:48 offset1:112
    ds_read_b128 v[112:115], v248 offset:0
    ds_read_b128 v[116:119], v248 offset:64
    ds_read_b128 v[120:123], v248 offset:128
    ds_read_b128 v[124:127], v248 offset:192
    ds_read_b128 v[16:19], v248 offset:256
    ds_read_b128 v[20:23], v248 offset:320
    ds_read_b128 v[24:27], v248 offset:384
    ds_read_b128 v[28:31], v248 offset:448
    s_mul_i32 s31, s12, 192
    v_add_u32 v248, s31, v248
    v_add_u32 v249, s31, v249
    v_mfma_f32_16x16x32_bf16 v[48:51], a[112:115], v[192:195], v[48:51]
    v_mfma_f32_16x16x32_bf16 v[64:67], v[192:195], a[116:119], v[64:67]
    v_mfma_f32_16x16x32_bf16 v[52:55], a[112:115], v[196:199], v[52:55]
    v_mfma_f32_16x16x32_bf16 v[68:71], v[196:199], a[116:119], v[68:71]
    v_mfma_f32_16x16x32_bf16 v[56:59], a[112:115], v[200:203], v[56:59]
    v_mfma_f32_16x16x32_bf16 v[72:75], v[200:203], a[116:119], v[72:75]
    v_mfma_f32_16x16x32_bf16 v[60:63], a[112:115], v[204:207], v[60:63]
    v_mfma_f32_16x16x32_bf16 v[76:79], v[204:207], a[116:119], v[76:79]
    v_mfma_f32_16x16x32_bf16 v[100:103], a[112:115], v[136:139], v[100:103]
    v_mfma_f32_16x16x32_bf16 v[104:107], v[136:139], a[116:119], v[104:107]
    v_mfma_f32_16x16x32_bf16 v[48:51], a[120:123], v[208:211], v[48:51]
    v_mfma_f32_16x16x32_bf16 v[64:67], v[208:211], a[124:127], v[64:67]
    v_mfma_f32_16x16x32_bf16 v[52:55], a[120:123], v[212:215], v[52:55]
    s_add_u32 m0, s54, 32768
    s_nop 0
    buffer_load_dwordx4 v227, s[56:59], s55 offen lds
    s_add_u32 s55, s55, s60
    v_mfma_f32_16x16x32_bf16 v[68:71], v[212:215], a[124:127], v[68:71]
    v_mfma_f32_16x16x32_bf16 v[56:59], a[120:123], v[216:219], v[56:59]
    s_add_u32 m0, s54, 33792
    s_nop 0
    buffer_load_dwordx4 v227, s[56:59], s55 offen lds
    s_add_u32 s55, s55, s60
    v_mfma_f32_16x16x32_bf16 v[72:75], v[216:219], a[124:127], v[72:75]
    v_mfma_f32_16x16x32_bf16 v[60:63], a[120:123], v[220:223], v[60:63]
    s_add_u32 m0, s54, 34816
    s_nop 0
    buffer_load_dwordx4 v227, s[56:59], s55 offen lds
    s_add_u32 s55, s55, s60
    v_mfma_f32_16x16x32_bf16 v[76:79], v[220:223], a[124:127], v[76:79]
    v_mfma_f32_16x16x32_bf16 v[100:103], a[120:123], v[136:139], v[100:103]
    s_add_u32 m0, s54, 35840
    s_nop 0
    buffer_load_dwordx4 v227, s[56:59], s55 offen lds
    s_add_u32 s55, s55, s60
    v_mfma_f32_16x16x32_bf16 v[104:107], v[136:139], a[124:127], v[104:107]
    s_waitcnt lgkmcnt(0)
    s_nop 1
    v_pk_fma_f32 v[48:49], v[100:101], v[128:129], v[48:49] op_sel:[0,1,0] op_sel_hi:[1,1,1] neg_lo:[1,0,0] neg_hi:[1,0,0]
    v_pk_fma_f32 v[50:51], v[102:103], v[128:129], v[50:51] op_sel:[0,1,0] op_sel_hi:[1,1,1] neg_lo:[1,0,0] neg_hi:[1,0,0]
    v_pk_fma_f32 v[52:53], v[100:101], v[130:131], v[52:53] op_sel:[0,1,0] op_sel_hi:[1,1,1] neg_lo:[1,0,0] neg_hi:[1,0,0]
    v_pk_fma_f32 v[54:55], v[102:103], v[130:131], v[54:55] op_sel:[0,1,0] op_sel_hi:[1,1,1] neg_lo:[1,0,0] neg_hi:[1,0,0]
    v_pk_fma_f32 v[56:57], v[100:101], v[132:133], v[56:57] op_sel:[0,1,0] op_sel_hi:[1,1,1] neg_lo:[1,0,0] neg_hi:[1,0,0]
    v_pk_fma_f32 v[58:59], v[102:103], v[132:133], v[58:59] op_sel:[0,1,0] op_sel_hi:[1,1,1] neg_lo:[1,0,0] neg_hi:[1,0,0]
    v_pk_fma_f32 v[60:61], v[100:101], v[134:135], v[60:61] op_sel:[0,1,0] op_sel_hi:[1,1,1] neg_lo:[1,0,0] neg_hi:[1,0,0]
    v_pk_fma_f32 v[62:63], v[102:103], v[134:135], v[62:63] op_sel:[0,1,0] op_sel_hi:[1,1,1] neg_lo:[1,0,0] neg_hi:[1,0,0]
    v_pk_mul_f32 v[48:49], v[48:49], v[128:129] op_sel_hi:[1,0]
    v_pk_mul_f32 v[50:51], v[50:51], v[128:129] op_sel_hi:[1,0]
    v_pk_mul_f32 v[52:53], v[52:53], v[130:131] op_sel_hi:[1,0]
    v_pk_mul_f32 v[54:55], v[54:55], v[130:131] op_sel_hi:[1,0]
    v_pk_mul_f32 v[56:57], v[56:57], v[132:133] op_sel_hi:[1,0]
    v_pk_mul_f32 v[58:59], v[58:59], v[132:133] op_sel_hi:[1,0]
    v_pk_mul_f32 v[60:61], v[60:61], v[134:135] op_sel_hi:[1,0]
    v_pk_mul_f32 v[62:63], v[62:63], v[134:135] op_sel_hi:[1,0]
    v_cvt_pk_bf16_f32 v240, v48, v49
    v_cvt_pk_bf16_f32 v241, v50, v51
    v_cvt_pk_bf16_f32 v242, v52, v53
    v_cvt_pk_bf16_f32 v243, v54, v55
    v_cvt_pk_bf16_f32 v244, v56, v57
    v_cvt_pk_bf16_f32 v245, v58, v59
    v_cvt_pk_bf16_f32 v246, v60, v61
    v_cvt_pk_bf16_f32 v247, v62, v63
    v_permlane16_swap_b32 v240, v242
    v_permlane16_swap_b32 v241, v243
    v_permlane16_swap_b32 v244, v246
    v_permlane16_swap_b32 v245, v247
    s_add_u32 s64, s84, 0x500000
    buffer_store_dwordx4 v[240:243], v2, s[16:19], s64 offen offset:0 sc1
    buffer_store_dwordx4 v[244:247], v2, s[16:19], s64 offen offset:1024 sc1
    s_waitcnt lgkmcnt(0)
    v_pk_fma_f32 v[64:65], v[16:17], v[104:105], v[64:65] op_sel_hi:[1,0,1] neg_lo:[1,0,0] neg_hi:[1,0,0]
    v_pk_fma_f32 v[66:67], v[18:19], v[104:105], v[66:67] op_sel_hi:[1,0,1] neg_lo:[1,0,0] neg_hi:[1,0,0]
    v_pk_fma_f32 v[68:69], v[20:21], v[104:105], v[68:69] op_sel_hi:[1,0,1] neg_lo:[1,0,0] neg_hi:[1,0,0]
    v_pk_fma_f32 v[70:71], v[22:23], v[104:105], v[70:71] op_sel_hi:[1,0,1] neg_lo:[1,0,0] neg_hi:[1,0,0]
    v_pk_fma_f32 v[72:73], v[24:25], v[104:105], v[72:73] op_sel_hi:[1,0,1] neg_lo:[1,0,0] neg_hi:[1,0,0]
    v_pk_fma_f32 v[74:75], v[26:27], v[104:105], v[74:75] op_sel_hi:[1,0,1] neg_lo:[1,0,0] neg_hi:[1,0,0]
    v_pk_fma_f32 v[76:77], v[28:29], v[104:105], v[76:77] op_sel_hi:[1,0,1] neg_lo:[1,0,0] neg_hi:[1,0,0]
    v_pk_fma_f32 v[78:79], v[30:31], v[104:105], v[78:79] op_sel_hi:[1,0,1] neg_lo:[1,0,0] neg_hi:[1,0,0]
    v_pk_mul_f32 v[64:65], v[64:65], v[112:113]
    v_pk_mul_f32 v[66:67], v[66:67], v[114:115]
    v_pk_mul_f32 v[68:69], v[68:69], v[116:117]
    v_pk_mul_f32 v[70:71], v[70:71], v[118:119]
    v_pk_mul_f32 v[72:73], v[72:73], v[120:121]
    v_pk_mul_f32 v[74:75], v[74:75], v[122:123]
    v_pk_mul_f32 v[76:77], v[76:77], v[124:125]
    v_pk_mul_f32 v[78:79], v[78:79], v[126:127]
    v_cvt_pk_bf16_f32 v232, v64, v65
    v_cvt_pk_bf16_f32 v233, v66, v67
    v_cvt_pk_bf16_f32 v234, v68, v69
    v_cvt_pk_bf16_f32 v235, v70, v71
    v_cvt_pk_bf16_f32 v236, v72, v73
    v_cvt_pk_bf16_f32 v237, v74, v75
    v_cvt_pk_bf16_f32 v238, v76, v77
    v_cvt_pk_bf16_f32 v239, v78, v79
    v_permlane16_swap_b32 v232, v234
    v_permlane16_swap_b32 v233, v235
    v_permlane16_swap_b32 v236, v238
    v_permlane16_swap_b32 v237, v239
    v_permlane32_swap_b32 v232, v234
    v_permlane32_swap_b32 v233, v235
    v_permlane32_swap_b32 v236, v238
    v_permlane32_swap_b32 v237, v239
    s_add_u32 s65, s84, 0x700000
    buffer_store_dwordx4 v[232:235], v2, s[16:19], s65 offen offset:0 sc1
    buffer_store_dwordx4 v[236:239], v2, s[16:19], s65 offen offset:1024 sc1
    ds_write_b128 v248, v[100:103] offset:576
    ds_write_b32 v249, v104 offset:640
    s_waitcnt vmcnt(24)
    s_load_dwordx2 s[20:21], s[0:1], 16
    s_mov_b32 s30, 0
tag_loop:
    v_readfirstlane_b32 s72, v225
    s_nop 0
    s_cmp_lg_u32 s72, 0
    s_cbranch_scc1 tag_ok
    s_add_u32 s30, s30, 1
    s_cmp_gt_u32 s30, 0x8000
    s_cbranch_scc1 tag_ok
    buffer_load_dword v225, v226, s[24:27], 0 offen sc1
    s_waitcnt vmcnt(0)
    s_branch tag_loop
tag_ok:
    s_xor_b32 s73, s72, 0x5bd1e995
    s_mov_b32 s24, s44
    s_mov_b32 s25, s45
    s_mov_b32 s26, 0x200000
    s_mov_b32 s27, 0x20000
    s_getreg_b32 s97, hwreg(HW_REG_XCC_ID)
    s_and_b32 s97, s97, 15
    s_cmp_lg_u32 s12, 0
    s_cbranch_scc1 no_xt
    s_lshl_b32 s31, s10, 3
    s_add_u32 s31, s31, s11
    s_lshl_b32 s31, s31, 7
    s_add_u32 s31, s31, 0x438000
    s_add_u32 s30, s72, s97
    v_mov_b32 v4, s30
    v_mov_b32 v5, s73
    s_mov_b64 exec, 1
    buffer_store_dwordx2 v[4:5], v1, s[16:19], s31 offen sc1
    s_mov_b64 exec, -1
no_xt:
    s_waitcnt vmcnt(8) lgkmcnt(0)
    s_barrier
    s_lshr_b32 s28, s2, 6
    s_sub_u32 s30, 0, s28
    s_and_b32 s30, s30, 3
    s_add_u32 s30, s30, 3
    s_sub_u32 s31, s30, 5
    s_cmp_ge_u32 s30, 5
    s_cselect_b32 s30, s31, s30
    s_lshl_b32 s30, s30, 14
    v_add_u32 v141, s30, v140
    ds_read_b64_tr_b16 a[192:193], v141 offset:0
    ds_read_b64_tr_b16 a[194:195], v141 offset:512
    ds_read_b64_tr_b16 a[196:197], v141 offset:4096
    ds_read_b64_tr_b16 a[198:199], v141 offset:4608
    ds_read_b64_tr_b16 a[200:201], v141 offset:8192
    ds_read_b64_tr_b16 a[202:203], v141 offset:8704
    ds_read_b64_tr_b16 a[204:205], v141 offset:12288
    ds_read_b64_tr_b16 a[206:207], v141 offset:12800
    s_sub_u32 s30, 1, s28
    s_and_b32 s30, s30, 3
    s_add_u32 s30, s30, 3
    s_sub_u32 s31, s30, 5
    s_cmp_ge_u32 s30, 5
    s_cselect_b32 s30, s31, s30
    s_lshl_b32 s30, s30, 14
    v_add_u32 v141, s30, v140
    ds_read_b64_tr_b16 a[208:209], v141 offset:0
    ds_read_b64_tr_b16 a[210:211], v141 offset:512
    ds_read_b64_tr_b16 a[212:213], v141 offset:4096
    ds_read_b64_tr_b16 a[214:215], v141 offset:4608
    ds_read_b64_tr_b16 a[216:217], v141 offset:8192
    ds_read_b64_tr_b16 a[218:219], v141 offset:8704
    ds_read_b64_tr_b16 a[220:221], v141 offset:12288
    ds_read_b64_tr_b16 a[222:223], v141 offset:12800
    s_sub_u32 s30, 2, s28
    s_and_b32 s30, s30, 3
    s_add_u32 s30, s30, 3
    s_sub_u32 s31, s30, 5
    s_cmp_ge_u32 s30, 5
    s_cselect_b32 s30, s31, s30
    s_lshl_b32 s30, s30, 14
    v_add_u32 v141, s30, v140
    ds_read_b64_tr_b16 a[224:225], v141 offset:0
    ds_read_b64_tr_b16 a[226:227], v141 offset:512
    ds_read_b64_tr_b16 a[228:229], v141 offset:4096
    ds_read_b64_tr_b16 a[230:231], v141 offset:4608
    ds_read_b64_tr_b16 a[232:233], v141 offset:8192
    ds_read_b64_tr_b16 a[234:235], v141 offset:8704
    ds_read_b64_tr_b16 a[236:237], v141 offset:12288
    ds_read_b64_tr_b16 a[238:239], v141 offset:12800
    s_sub_u32 s30, 3, s28
    s_and_b32 s30, s30, 3
    s_add_u32 s30, s30, 3
    s_sub_u32 s31, s30, 5
    s_cmp_ge_u32 s30, 5
    s_cselect_b32 s30, s31, s30
    s_lshl_b32 s30, s30, 14
    v_add_u32 v141, s30, v140
    ds_read_b64_tr_b16 a[240:241], v141 offset:0
    ds_read_b64_tr_b16 a[242:243], v141 offset:512
    ds_read_b64_tr_b16 a[244:245], v141 offset:4096
    ds_read_b64_tr_b16 a[246:247], v141 offset:4608
    ds_read_b64_tr_b16 a[248:249], v141 offset:8192
    ds_read_b64_tr_b16 a[250:251], v141 offset:8704
    ds_read_b64_tr_b16 a[252:253], v141 offset:12288
    ds_read_b64_tr_b16 a[254:255], v141 offset:12800
    ds_read_b128 v[16:19], v3 offset:0
    ds_read_b128 v[20:23], v3 offset:16384
    ds_read_b128 v[24:27], v3 offset:32768
    ds_read_b128 v[28:31], v3 offset:49152
    ds_read_b128 v[32:35], v3 offset:1024
    ds_read_b128 v[36:39], v3 offset:17408
    ds_read_b128 v[40:43], v3 offset:33792
    ds_read_b128 v[44:47], v3 offset:50176
    ds_read_b128 v[48:51], v3 offset:2048
    ds_read_b128 v[52:55], v3 offset:18432
    ds_read_b128 v[56:59], v3 offset:34816
    ds_read_b128 v[60:63], v3 offset:51200
    v_lshlrev_b32 v6, 12, v1
    v_sub_u32 v6, s29, v6
    v_subrev_u32 v6, 4096, v6
    s_min_u32 s31, s10, 4
    s_bfm_b64 s[100:101], s31, 0
    v_mov_b32 v140, s29
    s_mov_b64 s[74:75], 0x10
    v_cndmask_b32 v6, v6, v140, s[74:75]
    s_cmp_eq_u32 s100, 0
    s_cselect_b32 s100, 0x10, s100
    s_waitcnt lgkmcnt(8)
    v_mfma_f32_16x16x32_bf16 v[80:83], a[192:195], v[16:19], 0
    ds_read_b128 v[64:67], v3 offset:3072
    v_mfma_f32_16x16x32_bf16 v[84:87], a[192:195], v[20:23], 0
    ds_read_b128 v[68:71], v3 offset:19456
    v_mfma_f32_16x16x32_bf16 v[88:91], a[192:195], v[24:27], 0
    ds_read_b128 v[72:75], v3 offset:35840
    v_mfma_f32_16x16x32_bf16 v[92:95], a[192:195], v[28:31], 0
    ds_read_b128 v[76:79], v3 offset:52224
    v_mfma_f32_16x16x32_bf16 v[108:111], a[192:195], v[136:139], 0
    s_waitcnt vmcnt(4)
    v_lshrrev_b32 v96, 4, v1
    v_bfe_u32 v97, v1, 2, 2
    v_lshl_add_u32 v96, v96, 3, v97
    v_lshlrev_b32 v96, 7, v96
    v_and_b32 v97, 3, v1
    v_lshl_add_u32 v96, v97, 3, v96
    v_add_u32 v96, s54, v96
    ds_read_b64_tr_b16 a[128:129], v96 offset:32768
    ds_read_b64_tr_b16 a[130:131], v96 offset:33280
    ds_read_b64_tr_b16 a[132:133], v96 offset:32800
    ds_read_b64_tr_b16 a[134:135], v96 offset:33312
    ds_read_b64_tr_b16 a[136:137], v96 offset:32832
    ds_read_b64_tr_b16 a[138:139], v96 offset:33344
    ds_read_b64_tr_b16 a[140:141], v96 offset:32864
    ds_read_b64_tr_b16 a[142:143], v96 offset:33376
    s_waitcnt lgkmcnt(0)
    s_lshr_b32 s31, s3, 2
    s_cmp_lg_u32 s31, 6
    s_cbranch_scc1 pk2_join
    v_accvgpr_write_b32 a144, 0
    v_accvgpr_write_b32 a145, 0
    v_accvgpr_write_b32 a146, 0
    v_accvgpr_write_b32 a147, 0
    buffer_store_dwordx4 a[144:147], v2, s[16:19], s90 offen sc1
    s_cmp_ge_u32 s12, 2
    s_cbranch_scc1 pk2_join
    s_mov_b64 exec, 0xff
    buffer_store_dwordx4 a[144:147], v2, s[16:19], s90 offen offset:1024 sc1
    s_mov_b64 exec, -1
pk2_join:
    buffer_store_dwordx4 a[128:131], v2, s[16:19], s78 offen sc1
    s_add_u32 s78, s78, s79
    buffer_store_dwordx4 a[132:135], v2, s[16:19], s78 offen sc1
    s_add_u32 s78, s78, s79
    buffer_store_dwordx4 a[136:139], v2, s[16:19], s78 offen sc1
    s_add_u32 s78, s78, s79
    buffer_store_dwordx4 a[140:143], v2, s[16:19], s78 offen sc1
    s_mov_b32 s89, 0
    s_barrier
    s_mov_b32 s22, 0x80000
    v_lshrrev_b32 v96, 3, v1
    v_lshlrev_b32 v96, 10, v96
    v_bfe_u32 v97, v1, 4, 2
    v_lshlrev_b32 v97, 1, v97
    v_and_b32 v98, 7, v1
    v_xor_b32 v97, v97, v98
    v_lshl_add_u32 v96, v97, 4, v96
    s_lshl_b32 s88, s12, 17
    s_lshl_b32 s31, s11, 7
    s_add_u32 s88, s88, s31
    s_waitcnt lgkmcnt(8)
    v_mfma_f32_16x16x32_bf16 v[80:83], a[196:199], v[32:35], v[80:83]
    ds_read_b128 v[16:19], v3 offset:4096
    v_mfma_f32_16x16x32_bf16 v[84:87], a[196:199], v[36:39], v[84:87]
    ds_read_b128 v[20:23], v3 offset:20480
    v_mfma_f32_16x16x32_bf16 v[88:91], a[196:199], v[40:43], v[88:91]
    ds_read_b128 v[24:27], v3 offset:36864
    v_mfma_f32_16x16x32_bf16 v[92:95], a[196:199], v[44:47], v[92:95]
    ds_read_b128 v[28:31], v3 offset:53248
    v_mfma_f32_16x16x32_bf16 v[108:111], a[196:199], v[136:139], v[108:111]
    s_add_u32 m0, s82, 65536
    s_add_u32 s90, s88, 0
    buffer_load_dwordx4 v96, s[20:23], s90 offen lds
    s_waitcnt lgkmcnt(8)
    v_mfma_f32_16x16x32_bf16 v[80:83], a[200:203], v[48:51], v[80:83]
    ds_read_b128 v[32:35], v3 offset:5120
    v_mfma_f32_16x16x32_bf16 v[84:87], a[200:203], v[52:55], v[84:87]
    ds_read_b128 v[36:39], v3 offset:21504
    v_mfma_f32_16x16x32_bf16 v[88:91], a[200:203], v[56:59], v[88:91]
    ds_read_b128 v[40:43], v3 offset:37888
    v_mfma_f32_16x16x32_bf16 v[92:95], a[200:203], v[60:63], v[92:95]
    ds_read_b128 v[44:47], v3 offset:54272
    v_mfma_f32_16x16x32_bf16 v[108:111], a[200:203], v[136:139], v[108:111]
    s_add_u32 m0, s82, 66560
    s_add_u32 s90, s88, 8192
    buffer_load_dwordx4 v96, s[20:23], s90 offen lds
    s_waitcnt lgkmcnt(8)
    v_mfma_f32_16x16x32_bf16 v[80:83], a[204:207], v[64:67], v[80:83]
    ds_read_b128 v[48:51], v3 offset:6144
    v_mfma_f32_16x16x32_bf16 v[84:87], a[204:207], v[68:71], v[84:87]
    ds_read_b128 v[52:55], v3 offset:22528
    v_mfma_f32_16x16x32_bf16 v[88:91], a[204:207], v[72:75], v[88:91]
    ds_read_b128 v[56:59], v3 offset:38912
    v_mfma_f32_16x16x32_bf16 v[92:95], a[204:207], v[76:79], v[92:95]
    ds_read_b128 v[60:63], v3 offset:55296
    v_mfma_f32_16x16x32_bf16 v[108:111], a[204:207], v[136:139], v[108:111]
    s_add_u32 m0, s82, 67584
    s_add_u32 s90, s88, 16384
    buffer_load_dwordx4 v96, s[20:23], s90 offen lds
    s_waitcnt lgkmcnt(8)
    v_mfma_f32_16x16x32_bf16 v[80:83], a[208:211], v[16:19], v[80:83]
    ds_read_b128 v[64:67], v3 offset:7168
    v_mfma_f32_16x16x32_bf16 v[84:87], a[208:211], v[20:23], v[84:87]
    ds_read_b128 v[68:71], v3 offset:23552
    v_mfma_f32_16x16x32_bf16 v[88:91], a[208:211], v[24:27], v[88:91]
    ds_read_b128 v[72:75], v3 offset:39936
    v_mfma_f32_16x16x32_bf16 v[92:95], a[208:211], v[28:31], v[92:95]
    ds_read_b128 v[76:79], v3 offset:56320
    v_mfma_f32_16x16x32_bf16 v[108:111], a[208:211], v[136:139], v[108:111]
    s_add_u32 m0, s82, 68608
    s_add_u32 s90, s88, 24576
    buffer_load_dwordx4 v96, s[20:23], s90 offen lds
    s_waitcnt lgkmcnt(8)
    v_mfma_f32_16x16x32_bf16 v[80:83], a[212:215], v[32:35], v[80:83]
    ds_read_b128 v[16:19], v3 offset:8192
    v_mfma_f32_16x16x32_bf16 v[84:87], a[212:215], v[36:39], v[84:87]
    ds_read_b128 v[20:23], v3 offset:24576
    v_mfma_f32_16x16x32_bf16 v[88:91], a[212:215], v[40:43], v[88:91]
    ds_read_b128 v[24:27], v3 offset:40960
    v_mfma_f32_16x16x32_bf16 v[92:95], a[212:215], v[44:47], v[92:95]
    ds_read_b128 v[28:31], v3 offset:57344
    v_mfma_f32_16x16x32_bf16 v[108:111], a[212:215], v[136:139], v[108:111]
    s_add_u32 m0, s82, 69632
    s_add_u32 s90, s88, 32768
    buffer_load_dwordx4 v96, s[20:23], s90 offen lds
    s_waitcnt lgkmcnt(8)
    v_mfma_f32_16x16x32_bf16 v[80:83], a[216:219], v[48:51], v[80:83]
    ds_read_b128 v[32:35], v3 offset:9216
    v_mfma_f32_16x16x32_bf16 v[84:87], a[216:219], v[52:55], v[84:87]
    ds_read_b128 v[36:39], v3 offset:25600
    v_mfma_f32_16x16x32_bf16 v[88:91], a[216:219], v[56:59], v[88:91]
    ds_read_b128 v[40:43], v3 offset:41984
    v_mfma_f32_16x16x32_bf16 v[92:95], a[216:219], v[60:63], v[92:95]
    ds_read_b128 v[44:47], v3 offset:58368
    v_mfma_f32_16x16x32_bf16 v[108:111], a[216:219], v[136:139], v[108:111]
    s_add_u32 m0, s82, 70656
    s_add_u32 s90, s88, 40960
    buffer_load_dwordx4 v96, s[20:23], s90 offen lds
    s_waitcnt lgkmcnt(8)
    v_mfma_f32_16x16x32_bf16 v[80:83], a[220:223], v[64:67], v[80:83]
    ds_read_b128 v[48:51], v3 offset:10240
    v_mfma_f32_16x16x32_bf16 v[84:87], a[220:223], v[68:71], v[84:87]
    ds_read_b128 v[52:55], v3 offset:26624
    v_mfma_f32_16x16x32_bf16 v[88:91], a[220:223], v[72:75], v[88:91]
    ds_read_b128 v[56:59], v3 offset:43008
    v_mfma_f32_16x16x32_bf16 v[92:95], a[220:223], v[76:79], v[92:95]
    ds_read_b128 v[60:63], v3 offset:59392
    v_mfma_f32_16x16x32_bf16 v[108:111], a[220:223], v[136:139], v[108:111]
    s_add_u32 m0, s82, 71680
    s_add_u32 s90, s88, 49152
    buffer_load_dwordx4 v96, s[20:23], s90 offen lds
    s_waitcnt lgkmcnt(8)
    v_mfma_f32_16x16x32_bf16 v[80:83], a[224:227], v[16:19], v[80:83]
    ds_read_b128 v[64:67], v3 offset:11264
    v_mfma_f32_16x16x32_bf16 v[84:87], a[224:227], v[20:23], v[84:87]
    ds_read_b128 v[68:71], v3 offset:27648
    v_mfma_f32_16x16x32_bf16 v[88:91], a[224:227], v[24:27], v[88:91]
    ds_read_b128 v[72:75], v3 offset:44032
    v_mfma_f32_16x16x32_bf16 v[92:95], a[224:227], v[28:31], v[92:95]
    ds_read_b128 v[76:79], v3 offset:60416
    v_mfma_f32_16x16x32_bf16 v[108:111], a[224:227], v[136:139], v[108:111]
    s_add_u32 m0, s82, 72704
    s_add_u32 s90, s88, 57344
    buffer_load_dwordx4 v96, s[20:23], s90 offen lds
    s_waitcnt lgkmcnt(8)
    v_mfma_f32_16x16x32_bf16 v[80:83], a[228:231], v[32:35], v[80:83]
    ds_read_b128 v[16:19], v3 offset:12288
    v_mfma_f32_16x16x32_bf16 v[84:87], a[228:231], v[36:39], v[84:87]
    ds_read_b128 v[20:23], v3 offset:28672
    v_mfma_f32_16x16x32_bf16 v[88:91], a[228:231], v[40:43], v[88:91]
    ds_read_b128 v[24:27], v3 offset:45056
    v_mfma_f32_16x16x32_bf16 v[92:95], a[228:231], v[44:47], v[92:95]
    ds_read_b128 v[28:31], v3 offset:61440
    v_mfma_f32_16x16x32_bf16 v[108:111], a[228:231], v[136:139], v[108:111]
    s_waitcnt lgkmcnt(8)
    v_mfma_f32_16x16x32_bf16 v[80:83], a[232:235], v[48:51], v[80:83]
    ds_read_b128 v[32:35], v3 offset:13312
    v_mfma_f32_16x16x32_bf16 v[84:87], a[232:235], v[52:55], v[84:87]
    ds_read_b128 v[36:39], v3 offset:29696
    v_mfma_f32_16x16x32_bf16 v[88:91], a[232:235], v[56:59], v[88:91]
    ds_read_b128 v[40:43], v3 offset:46080
    v_mfma_f32_16x16x32_bf16 v[92:95], a[232:235], v[60:63], v[92:95]
    ds_read_b128 v[44:47], v3 offset:62464
    v_mfma_f32_16x16x32_bf16 v[108:111], a[232:235], v[136:139], v[108:111]
    s_waitcnt vmcnt(8)
    s_add_u32 s30, s72, 2
    v_mov_b32 v4, s30
    v_mov_b32 v5, s73
    s_mov_b64 exec, 1
    buffer_store_dwordx2 v[4:5], v1, s[16:19], s29 offen sc1
    s_mov_b64 exec, -1
    s_waitcnt lgkmcnt(8)
    v_mfma_f32_16x16x32_bf16 v[80:83], a[236:239], v[64:67], v[80:83]
    ds_read_b128 v[48:51], v3 offset:14336
    v_mfma_f32_16x16x32_bf16 v[84:87], a[236:239], v[68:71], v[84:87]
    ds_read_b128 v[52:55], v3 offset:30720
    v_mfma_f32_16x16x32_bf16 v[88:91], a[236:239], v[72:75], v[88:91]
    ds_read_b128 v[56:59], v3 offset:47104
    v_mfma_f32_16x16x32_bf16 v[92:95], a[236:239], v[76:79], v[92:95]
    ds_read_b128 v[60:63], v3 offset:63488
    v_mfma_f32_16x16x32_bf16 v[108:111], a[236:239], v[136:139], v[108:111]
    s_waitcnt lgkmcnt(8)
    v_mfma_f32_16x16x32_bf16 v[80:83], a[240:243], v[16:19], v[80:83]
    ds_read_b128 v[64:67], v3 offset:15360
    v_mfma_f32_16x16x32_bf16 v[84:87], a[240:243], v[20:23], v[84:87]
    ds_read_b128 v[68:71], v3 offset:31744
    v_mfma_f32_16x16x32_bf16 v[88:91], a[240:243], v[24:27], v[88:91]
    ds_read_b128 v[72:75], v3 offset:48128
    v_mfma_f32_16x16x32_bf16 v[92:95], a[240:243], v[28:31], v[92:95]
    ds_read_b128 v[76:79], v3 offset:64512
    v_mfma_f32_16x16x32_bf16 v[108:111], a[240:243], v[136:139], v[108:111]
    s_waitcnt lgkmcnt(8)
    v_mfma_f32_16x16x32_bf16 v[80:83], a[244:247], v[32:35], v[80:83]
    v_mfma_f32_16x16x32_bf16 v[84:87], a[244:247], v[36:39], v[84:87]
    v_mfma_f32_16x16x32_bf16 v[88:91], a[244:247], v[40:43], v[88:91]
    v_mfma_f32_16x16x32_bf16 v[92:95], a[244:247], v[44:47], v[92:95]
    v_mfma_f32_16x16x32_bf16 v[108:111], a[244:247], v[136:139], v[108:111]
    s_waitcnt lgkmcnt(4)
    v_mfma_f32_16x16x32_bf16 v[80:83], a[248:251], v[48:51], v[80:83]
    v_mfma_f32_16x16x32_bf16 v[84:87], a[248:251], v[52:55], v[84:87]
    v_mfma_f32_16x16x32_bf16 v[88:91], a[248:251], v[56:59], v[88:91]
    v_mfma_f32_16x16x32_bf16 v[92:95], a[248:251], v[60:63], v[92:95]
    v_mfma_f32_16x16x32_bf16 v[108:111], a[248:251], v[136:139], v[108:111]
    s_waitcnt lgkmcnt(0)
    v_mfma_f32_16x16x32_bf16 v[80:83], a[252:255], v[64:67], v[80:83]
    v_mfma_f32_16x16x32_bf16 v[84:87], a[252:255], v[68:71], v[84:87]
    v_mfma_f32_16x16x32_bf16 v[88:91], a[252:255], v[72:75], v[88:91]
    v_mfma_f32_16x16x32_bf16 v[92:95], a[252:255], v[76:79], v[92:95]
    v_mfma_f32_16x16x32_bf16 v[108:111], a[252:255], v[136:139], v[108:111]
    s_mov_b64 exec, s[100:101]
    buffer_load_dwordx2 v[142:143], v6, s[16:19], 0 offen sc1
    s_mov_b64 exec, -1
    s_barrier
    s_load_dwordx2 s[78:79], s[0:1], 40
    s_nop 2
    ds_write_b128 v248, v[108:111] offset:512
    v_pk_fma_f32 v[80:81], v[108:109], v[128:129], v[80:81] op_sel:[0,1,0] op_sel_hi:[1,1,1] neg_lo:[1,0,0] neg_hi:[1,0,0]
    v_pk_fma_f32 v[82:83], v[110:111], v[128:129], v[82:83] op_sel:[0,1,0] op_sel_hi:[1,1,1] neg_lo:[1,0,0] neg_hi:[1,0,0]
    v_pk_fma_f32 v[84:85], v[108:109], v[130:131], v[84:85] op_sel:[0,1,0] op_sel_hi:[1,1,1] neg_lo:[1,0,0] neg_hi:[1,0,0]
    v_pk_fma_f32 v[86:87], v[110:111], v[130:131], v[86:87] op_sel:[0,1,0] op_sel_hi:[1,1,1] neg_lo:[1,0,0] neg_hi:[1,0,0]
    v_pk_fma_f32 v[88:89], v[108:109], v[132:133], v[88:89] op_sel:[0,1,0] op_sel_hi:[1,1,1] neg_lo:[1,0,0] neg_hi:[1,0,0]
    v_pk_fma_f32 v[90:91], v[110:111], v[132:133], v[90:91] op_sel:[0,1,0] op_sel_hi:[1,1,1] neg_lo:[1,0,0] neg_hi:[1,0,0]
    v_pk_fma_f32 v[92:93], v[108:109], v[134:135], v[92:93] op_sel:[0,1,0] op_sel_hi:[1,1,1] neg_lo:[1,0,0] neg_hi:[1,0,0]
    v_pk_fma_f32 v[94:95], v[110:111], v[134:135], v[94:95] op_sel:[0,1,0] op_sel_hi:[1,1,1] neg_lo:[1,0,0] neg_hi:[1,0,0]
    v_pk_mul_f32 v[80:81], v[80:81], v[128:129] op_sel_hi:[1,0]
    v_pk_mul_f32 v[82:83], v[82:83], v[128:129] op_sel_hi:[1,0]
    v_pk_mul_f32 v[84:85], v[84:85], v[130:131] op_sel_hi:[1,0]
    v_pk_mul_f32 v[86:87], v[86:87], v[130:131] op_sel_hi:[1,0]
    v_pk_mul_f32 v[88:89], v[88:89], v[132:133] op_sel_hi:[1,0]
    v_pk_mul_f32 v[90:91], v[90:91], v[132:133] op_sel_hi:[1,0]
    v_pk_mul_f32 v[92:93], v[92:93], v[134:135] op_sel_hi:[1,0]
    v_pk_mul_f32 v[94:95], v[94:95], v[134:135] op_sel_hi:[1,0]
    v_cvt_pk_bf16_f32 v248, v80, v81
    v_cvt_pk_bf16_f32 v249, v82, v83
    v_cvt_pk_bf16_f32 v250, v84, v85
    v_cvt_pk_bf16_f32 v251, v86, v87
    v_cvt_pk_bf16_f32 v252, v88, v89
    v_cvt_pk_bf16_f32 v253, v90, v91
    v_cvt_pk_bf16_f32 v254, v92, v93
    v_cvt_pk_bf16_f32 v255, v94, v95
    v_permlane16_swap_b32 v248, v250
    v_permlane16_swap_b32 v249, v251
    v_permlane16_swap_b32 v252, v254
    v_permlane16_swap_b32 v253, v255
    v_mov_b32 v16, 0x3f803f80
    v_mov_b32 v224, v16
    v_mov_b32 v225, v16
    v_mov_b32 v226, v16
    v_mov_b32 v227, v16
    v_mov_b32 v228, v16
    v_mov_b32 v229, v16
    v_mov_b32 v230, v16
    v_mov_b32 v231, v16
    v_permlane16_swap_b32 v232, v224
    v_permlane16_swap_b32 v233, v225
    v_permlane16_swap_b32 v234, v226
    v_permlane16_swap_b32 v235, v227
    v_permlane16_swap_b32 v236, v228
    v_permlane16_swap_b32 v237, v229
    v_permlane16_swap_b32 v238, v230
    v_permlane16_swap_b32 v239, v231
    s_cmp_ge_u32 s10, 4
    s_cselect_b32 s4, 0, 0xf149f2ca
    s_cselect_b32 s31, 0x3f803f80, 0
    v_mov_b32 v21, s31
    v_accvgpr_write_b32 a128, v21
    v_accvgpr_write_b32 a129, v21
    v_accvgpr_write_b32 a130, v21
    v_accvgpr_write_b32 a131, v21
    v_accvgpr_write_b32 a132, v21
    v_accvgpr_write_b32 a133, v21
    v_accvgpr_write_b32 a134, v21
    v_accvgpr_write_b32 a135, v21
    v_accvgpr_write_b32 a136, v21
    v_accvgpr_write_b32 a137, v21
    v_accvgpr_write_b32 a138, v21
    v_accvgpr_write_b32 a139, v21
    v_accvgpr_write_b32 a140, v21
    v_accvgpr_write_b32 a141, v21
    v_accvgpr_write_b32 a142, v21
    v_accvgpr_write_b32 a143, v21
    s_cmp_ge_u32 s10, 3
    s_cselect_b32 s5, 0, 0xf149f2ca
    s_cselect_b32 s31, 0x3f803f80, 0
    v_mov_b32 v21, s31
    v_accvgpr_write_b32 a144, v21
    v_accvgpr_write_b32 a145, v21
    v_accvgpr_write_b32 a146, v21
    v_accvgpr_write_b32 a147, v21
    v_accvgpr_write_b32 a148, v21
    v_accvgpr_write_b32 a149, v21
    v_accvgpr_write_b32 a150, v21
    v_accvgpr_write_b32 a151, v21
    v_accvgpr_write_b32 a152, v21
    v_accvgpr_write_b32 a153, v21
    v_accvgpr_write_b32 a154, v21
    v_accvgpr_write_b32 a155, v21
    v_accvgpr_write_b32 a156, v21
    v_accvgpr_write_b32 a157, v21
    v_accvgpr_write_b32 a158, v21
    v_accvgpr_write_b32 a159, v21
    s_cmp_ge_u32 s10, 2
    s_cselect_b32 s6, 0, 0xf149f2ca
    s_cselect_b32 s31, 0x3f803f80, 0
    v_mov_b32 v21, s31
    v_accvgpr_write_b32 a160, v21
    v_accvgpr_write_b32 a161, v21
    v_accvgpr_write_b32 a162, v21
    v_accvgpr_write_b32 a163, v21
    v_accvgpr_write_b32 a164, v21
    v_accvgpr_write_b32 a165, v21
    v_accvgpr_write_b32 a166, v21
    v_accvgpr_write_b32 a167, v21
    v_accvgpr_write_b32 a168, v21
    v_accvgpr_write_b32 a169, v21
    v_accvgpr_write_b32 a170, v21
    v_accvgpr_write_b32 a171, v21
    v_accvgpr_write_b32 a172, v21
    v_accvgpr_write_b32 a173, v21
    v_accvgpr_write_b32 a174, v21
    v_accvgpr_write_b32 a175, v21
    s_cmp_ge_u32 s10, 1
    s_cselect_b32 s7, 0, 0xf149f2ca
    s_cselect_b32 s31, 0x3f803f80, 0
    v_mov_b32 v21, s31
    v_accvgpr_write_b32 a176, v21
    v_accvgpr_write_b32 a177, v21
    v_accvgpr_write_b32 a178, v21
    v_accvgpr_write_b32 a179, v21
    v_accvgpr_write_b32 a180, v21
    v_accvgpr_write_b32 a181, v21
    v_accvgpr_write_b32 a182, v21
    v_accvgpr_write_b32 a183, v21
    v_accvgpr_write_b32 a184, v21
    v_accvgpr_write_b32 a185, v21
    v_accvgpr_write_b32 a186, v21
    v_accvgpr_write_b32 a187, v21
    v_accvgpr_write_b32 a188, v21
    v_accvgpr_write_b32 a189, v21
    v_accvgpr_write_b32 a190, v21
    v_accvgpr_write_b32 a191, v21
    s_waitcnt lgkmcnt(0)
    v_and_b32 v3, 15, v1
    v_lshrrev_b32 v23, 5, v1
    v_lshl_add_u32 v3, v23, 5, v3
    v_lshlrev_b32 v3, 4, v3
    s_cmp_lg_u32 s89, 0
    s_cbranch_scc1 kt1
    s_waitcnt vmcnt(0)
    s_mov_b64 exec, s[100:101]
    s_mov_b32 s30, 0
    s_branch poll2_l
poll2:
    buffer_load_dwordx2 v[142:143], v6, s[16:19], 0 offen sc1
poll2_c:
    s_waitcnt vmcnt(0)
poll2_l:
    s_add_u32 s30, s30, 1
    v_subrev_u32 v142, s72, v142
    v_cmp_eq_u32 s[74:75], s73, v143
    v_cmp_gt_u32 s[76:77], 32, v142
    v_cmp_le_u32 vcc, 1, v142
    s_and_b64 s[74:75], s[74:75], s[76:77]
    s_and_b64 vcc, vcc, s[74:75]
    s_cmp_eq_u64 vcc, exec
    s_cbranch_scc1 poll2_x
    s_cmp_gt_u32 s30, 0x8000
    s_cbranch_scc0 poll2
poll2_x:
    s_mov_b64 exec, -1
    s_mov_b32 s89, 1
    s_add_u32 s64, s84, 0x4fe000
    s_cmp_ge_u32 s10, 4
    s_cselect_b32 s64, s64, 0x7fff0000
    s_add_u32 s65, s84, 0x4fe800
    s_cmp_ge_u32 s10, 3
    s_cselect_b32 s65, s65, 0x7fff0000
    s_add_u32 s66, s84, 0x4ff000
    s_cmp_ge_u32 s10, 2
    s_cselect_b32 s66, s66, 0x7fff0000
    s_add_u32 s67, s84, 0x4ff800
    s_cmp_ge_u32 s10, 1
    s_cselect_b32 s67, s67, 0x7fff0000
    buffer_load_dwordx4 v[192:195], v2, s[16:19], s64 offen offset:0 sc1
    buffer_load_dwordx4 v[196:199], v2, s[16:19], s64 offen offset:1024 sc1
    buffer_load_dwordx4 v[200:203], v2, s[16:19], s65 offen offset:0 sc1
    buffer_load_dwordx4 v[204:207], v2, s[16:19], s65 offen offset:1024 sc1
    buffer_load_dwordx4 v[208:211], v2, s[16:19], s66 offen offset:0 sc1
    buffer_load_dwordx4 v[212:215], v2, s[16:19], s66 offen offset:1024 sc1
    buffer_load_dwordx4 v[216:219], v2, s[16:19], s67 offen offset:0 sc1
    buffer_load_dwordx4 v[220:223], v2, s[16:19], s67 offen offset:1024 sc1
kt1:
    s_lshl_b32 s0, s10, 5
    s_add_u32 s0, s0, s13
    s_lshl_b32 s0, s0, 3
    s_add_u32 s0, s0, 0x440000
    s_lshl_b32 s31, s11, 14
    s_add_u32 s31, s31, 0x401800
    v_lshlrev_b32 v40, 7, v1
    v_add_u32 v41, s31, v40
    s_lshl_b32 s31, s12, 9
    v_add_u32 v42, s31, v41
    s_mov_b32 s74, 0
    s_mov_b32 s75, 0xf0000
    v_cndmask_b32 v41, v41, v42, s[74:75]
    s_lshl_b32 s31, s10, 10
    s_add_u32 s31, s31, 0x436600
    v_add_u32 v42, s31, v40
    s_mov_b32 s75, 0xff00000
    v_cndmask_b32 v41, v41, v42, s[74:75]
    v_mov_b32 v46, 2
    v_cndmask_b32 v46, v46, 0, s[74:75]
    s_mov_b32 s22, 0x80000
    s_mov_b32 s23, 0x20000
    v_and_b32 v36, 31, v1
    v_lshrrev_b32 v37, 5, v1
    v_lshlrev_b32 v37, 2, v37
    v_sub_u32 v36, v36, v37
    v_cmp_le_i32 s[32:33], 0, v36
    v_cmp_le_i32 s[34:35], 1, v36
    v_cmp_le_i32 s[36:37], 2, v36
    v_cmp_le_i32 s[38:39], 3, v36
    v_cmp_le_i32 s[40:41], 8, v36
    v_cmp_le_i32 s[42:43], 9, v36
    v_cmp_le_i32 s[44:45], 10, v36
    v_cmp_le_i32 s[46:47], 11, v36
    v_cmp_le_i32 s[48:49], 16, v36
    v_cmp_le_i32 s[50:51], 17, v36
    v_cmp_le_i32 s[52:53], 18, v36
    v_cmp_le_i32 s[54:55], 19, v36
    v_cmp_le_i32 s[56:57], 24, v36
    v_cmp_le_i32 s[58:59], 25, v36
    v_cmp_le_i32 s[60:61], 26, v36
    v_cmp_le_i32 s[62:63], 27, v36
    v_lshrrev_b32 v36, 3, v1
    v_lshlrev_b32 v36, 10, v36
    v_bfe_u32 v37, v1, 4, 2
    v_lshlrev_b32 v37, 1, v37
    v_and_b32 v38, 7, v1
    v_xor_b32 v37, v37, v38
    v_lshl_add_u32 v6, v37, 4, v36
    s_lshl_b32 s89, s12, 17
    s_lshl_b32 s31, s11, 7
    s_add_u32 s89, s89, s31
    v_mfma_f32_32x32x16_bf16 v[176:191], v[240:243], v[248:251], 0
    s_waitcnt vmcnt(7)
    v_mfma_f32_32x32x16_bf16 v[48:63], v[192:195], v[248:251], 0
    s_waitcnt vmcnt(6)
    v_mfma_f32_32x32x16_bf16 v[64:79], v[196:199], v[248:251], 0
    s_waitcnt vmcnt(5)
    v_mfma_f32_32x32x16_bf16 v[80:95], v[200:203], v[248:251], 0
    s_cmp_ge_u32 s10, 4
    s_cbranch_scc1 mg00
    s_nop 11
    v_mov_b32 v48, s4
    v_mov_b32 v49, s4
    v_mov_b32 v50, s4
    v_mov_b32 v51, s4
    v_mov_b32 v52, s4
    v_mov_b32 v53, s4
    v_mov_b32 v54, s4
    v_mov_b32 v55, s4
    v_mov_b32 v56, s4
    v_mov_b32 v57, s4
    v_mov_b32 v58, s4
    v_mov_b32 v59, s4
    v_mov_b32 v60, s4
    v_mov_b32 v61, s4
    v_mov_b32 v62, s4
    v_mov_b32 v63, s4
mg00:
    s_nop 5
    v_cndmask_b32 v48, v48, v176, s[32:33]
    v_cndmask_b32 v49, v49, v177, s[34:35]
    v_cndmask_b32 v50, v50, v178, s[36:37]
    v_cndmask_b32 v51, v51, v179, s[38:39]
    v_cndmask_b32 v52, v52, v180, s[40:41]
    v_cndmask_b32 v53, v53, v181, s[42:43]
    v_cndmask_b32 v54, v54, v182, s[44:45]
    v_cndmask_b32 v55, v55, v183, s[46:47]
    v_cndmask_b32 v56, v56, v184, s[48:49]
    v_cndmask_b32 v57, v57, v185, s[50:51]
    v_cndmask_b32 v58, v58, v186, s[52:53]
    v_cndmask_b32 v59, v59, v187, s[54:55]
    v_cndmask_b32 v60, v60, v188, s[56:57]
    v_cndmask_b32 v61, v61, v189, s[58:59]
    v_cndmask_b32 v62, v62, v190, s[60:61]
    v_cndmask_b32 v63, v63, v191, s[62:63]
    s_waitcnt vmcnt(4)
    v_mfma_f32_32x32x16_bf16 v[96:111], v[204:207], v[248:251], 0
    v_max3_f32 v32, v48, v49, v50
    v_max3_f32 v32, v32, v51, v52
    v_max3_f32 v32, v32, v53, v54
    v_max3_f32 v32, v32, v55, v56
    v_max3_f32 v32, v32, v57, v58
    v_max3_f32 v32, v32, v59, v60
    v_max3_f32 v32, v32, v61, v62
    v_max_f32 v32, v32, v63
    s_waitcnt vmcnt(3)
    v_mfma_f32_32x32x16_bf16 v[112:127], v[208:211], v[248:251], 0
    v_max3_f32 v37, v64, v65, v66
    v_max3_f32 v37, v37, v67, v68
    v_max3_f32 v37, v37, v69, v70
    v_max3_f32 v37, v37, v71, v72
    v_max3_f32 v37, v37, v73, v74
    v_max3_f32 v37, v37, v75, v76
    v_max3_f32 v37, v37, v77, v78
    v_max_f32 v37, v37, v79
    v_add_f32 v37, s4, v37
    v_max_f32 v32, v32, v37
    s_add_u32 s88, s84, 0x6fe000
    s_cmp_ge_u32 s10, 4
    s_cselect_b32 s88, s88, 0x7fff0000
    s_mov_b32 exec_lo, 0xffff
    s_mov_b32 exec_hi, 0xffff
    buffer_load_dwordx4 a[128:131], v3, s[16:19], s88 offen offset:0 sc1
    buffer_load_dwordx4 a[132:135], v3, s[16:19], s88 offen offset:256 sc1
    s_mov_b64 exec, -1
    s_waitcnt vmcnt(4)
    v_mfma_f32_32x32x16_bf16 v[128:143], v[212:215], v[248:251], 0
    v_max3_f32 v36, v80, v81, v82
    v_max3_f32 v36, v36, v83, v84
    v_max3_f32 v36, v36, v85, v86
    v_max3_f32 v36, v36, v87, v88
    v_max3_f32 v36, v36, v89, v90
    v_max3_f32 v36, v36, v91, v92
    v_max3_f32 v36, v36, v93, v94
    v_max_f32 v36, v36, v95
    v_add_f32 v36, s5, v36
    v_max_f32 v32, v32, v36
    s_mov_b32 exec_lo, 0xffff
    s_mov_b32 exec_hi, 0xffff
    buffer_load_dwordx4 a[136:139], v3, s[16:19], s88 offen offset:1024 sc1
    buffer_load_dwordx4 a[140:143], v3, s[16:19], s88 offen offset:1280 sc1
    s_mov_b64 exec, -1
    s_waitcnt vmcnt(5)
    v_mfma_f32_32x32x16_bf16 v[144:159], v[216:219], v[248:251], 0
    v_max3_f32 v37, v96, v97, v98
    v_max3_f32 v37, v37, v99, v100
    v_max3_f32 v37, v37, v101, v102
    v_max3_f32 v37, v37, v103, v104
    v_max3_f32 v37, v37, v105, v106
    v_max3_f32 v37, v37, v107, v108
    v_max3_f32 v37, v37, v109, v110
    v_max_f32 v37, v37, v111
    v_add_f32 v37, s5, v37
    v_max_f32 v32, v32, v37
    s_add_u32 s88, s84, 0x6fe800
    s_cmp_ge_u32 s10, 3
    s_cselect_b32 s88, s88, 0x7fff0000
    s_mov_b32 exec_lo, 0xffff
    s_mov_b32 exec_hi, 0xffff
    buffer_load_dwordx4 a[144:147], v3, s[16:19], s88 offen offset:0 sc1
    buffer_load_dwordx4 a[148:151], v3, s[16:19], s88 offen offset:256 sc1
    s_mov_b64 exec, -1
    s_waitcnt vmcnt(6)
    v_mfma_f32_32x32x16_bf16 v[160:175], v[220:223], v[248:251], 0
    v_max3_f32 v36, v112, v113, v114
    v_max3_f32 v36, v36, v115, v116
    v_max3_f32 v36, v36, v117, v118
    v_max3_f32 v36, v36, v119, v120
    v_max3_f32 v36, v36, v121, v122
    v_max3_f32 v36, v36, v123, v124
    v_max3_f32 v36, v36, v125, v126
    v_max_f32 v36, v36, v127
    v_add_f32 v36, s6, v36
    v_max_f32 v32, v32, v36
    s_mov_b32 exec_lo, 0xffff
    s_mov_b32 exec_hi, 0xffff
    buffer_load_dwordx4 a[152:155], v3, s[16:19], s88 offen offset:1024 sc1
    buffer_load_dwordx4 a[156:159], v3, s[16:19], s88 offen offset:1280 sc1
    s_mov_b64 exec, -1
    v_max3_f32 v37, v128, v129, v130
    v_max3_f32 v37, v37, v131, v132
    v_max3_f32 v37, v37, v133, v134
    v_max3_f32 v37, v37, v135, v136
    v_max3_f32 v37, v37, v137, v138
    v_max3_f32 v37, v37, v139, v140
    v_max3_f32 v37, v37, v141, v142
    v_max_f32 v37, v37, v143
    v_add_f32 v37, s6, v37
    v_max_f32 v32, v32, v37
    s_add_u32 s88, s84, 0x6ff000
    s_cmp_ge_u32 s10, 2
    s_cselect_b32 s88, s88, 0x7fff0000
    s_mov_b32 exec_lo, 0xffff
    s_mov_b32 exec_hi, 0xffff
    buffer_load_dwordx4 a[160:163], v3, s[16:19], s88 offen offset:0 sc1
    buffer_load_dwordx4 a[164:167], v3, s[16:19], s88 offen offset:256 sc1
    s_mov_b64 exec, -1
    v_max3_f32 v36, v144, v145, v146
    v_max3_f32 v36, v36, v147, v148
    v_max3_f32 v36, v36, v149, v150
    v_max3_f32 v36, v36, v151, v152
    v_max3_f32 v36, v36, v153, v154
    v_max3_f32 v36, v36, v155, v156
    v_max3_f32 v36, v36, v157, v158
    v_max_f32 v36, v36, v159
    v_add_f32 v36, s7, v36
    v_max_f32 v32, v32, v36
    s_mov_b32 exec_lo, 0xffff
    s_mov_b32 exec_hi, 0xffff
    buffer_load_dwordx4 a[168:171], v3, s[16:19], s88 offen offset:1024 sc1
    buffer_load_dwordx4 a[172:175], v3, s[16:19], s88 offen offset:1280 sc1
    s_mov_b64 exec, -1
    v_max3_f32 v37, v160, v161, v162
    v_max3_f32 v37, v37, v163, v164
    v_max3_f32 v37, v37, v165, v166
    v_max3_f32 v37, v37, v167, v168
    v_max3_f32 v37, v37, v169, v170
    v_max3_f32 v37, v37, v171, v172
    v_max3_f32 v37, v37, v173, v174
    v_max_f32 v37, v37, v175
    v_add_f32 v37, s7, v37
    v_max_f32 v32, v32, v37
    s_add_u32 s88, s84, 0x6ff800
    s_cmp_ge_u32 s10, 1
    s_cselect_b32 s88, s88, 0x7fff0000
    s_mov_b32 exec_lo, 0xffff
    s_mov_b32 exec_hi, 0xffff
    buffer_load_dwordx4 a[176:179], v3, s[16:19], s88 offen offset:0 sc1
    buffer_load_dwordx4 a[180:183], v3, s[16:19], s88 offen offset:256 sc1
    s_mov_b64 exec, -1
    v_mov_b32 v33, v32
    s_nop 1
    v_permlane32_swap_b32 v32, v33
    v_max_f32 v32, v32, v33
    v_mul_f32 v32, 0xbeb8aa3b, v32
    s_mov_b32 exec_lo, 0xffffffff
    s_mov_b32 exec_hi, 0xfffffff
    buffer_load_dwordx2 v[42:43], v41, s[16:19], 0 offen sc1
    s_mov_b64 exec, -1
    v_pk_fma_f32 v[48:49], v[48:49], s[14:15], v[32:33] op_sel_hi:[1,1,0]
    v_pk_fma_f32 v[50:51], v[50:51], s[14:15], v[32:33] op_sel_hi:[1,1,0]
    v_pk_fma_f32 v[52:53], v[52:53], s[14:15], v[32:33] op_sel_hi:[1,1,0]
    v_pk_fma_f32 v[54:55], v[54:55], s[14:15], v[32:33] op_sel_hi:[1,1,0]
    v_pk_fma_f32 v[56:57], v[56:57], s[14:15], v[32:33] op_sel_hi:[1,1,0]
    v_pk_fma_f32 v[58:59], v[58:59], s[14:15], v[32:33] op_sel_hi:[1,1,0]
    v_pk_fma_f32 v[60:61], v[60:61], s[14:15], v[32:33] op_sel_hi:[1,1,0]
    v_pk_fma_f32 v[62:63], v[62:63], s[14:15], v[32:33] op_sel_hi:[1,1,0]
    v_mfma_f32_32x32x16_bf16 v[176:191], v[244:247], v[252:255], 0
    v_exp_f32 v48, v48
    v_exp_f32 v49, v49
    v_exp_f32 v50, v50
    v_exp_f32 v51, v51
    v_exp_f32 v52, v52
    v_exp_f32 v53, v53
    v_exp_f32 v54, v54
    v_exp_f32 v55, v55
    v_exp_f32 v56, v56
    v_exp_f32 v57, v57
    v_exp_f32 v58, v58
    v_exp_f32 v59, v59
    v_exp_f32 v60, v60
    v_exp_f32 v61, v61
    s_mov_b32 exec_lo, 0xffff
    s_mov_b32 exec_hi, 0xffff
    buffer_load_dwordx4 a[184:187], v3, s[16:19], s88 offen offset:1024 sc1
    buffer_load_dwordx4 a[188:191], v3, s[16:19], s88 offen offset:1280 sc1
    s_mov_b64 exec, -1
    v_exp_f32 v62, v62
    v_exp_f32 v63, v63
    v_cvt_pk_bf16_f32 v48, v48, v49
    v_cvt_pk_bf16_f32 v49, v50, v51
    v_cvt_pk_bf16_f32 v50, v52, v53
    v_cvt_pk_bf16_f32 v51, v54, v55
    v_cvt_pk_bf16_f32 v52, v56, v57
    v_cvt_pk_bf16_f32 v53, v58, v59
    s_add_u32 m0, s82, 73728
    s_add_u32 s90, s89, 65536
    buffer_load_dwordx4 v6, s[20:23], s90 offen lds
    v_cvt_pk_bf16_f32 v54, v60, v61
    v_cvt_pk_bf16_f32 v55, v62, v63
    v_and_b32 v56, v48, v8
    v_and_b32 v57, v49, v9
    v_and_b32 v58, v50, v10
    v_and_b32 v59, v51, v11
    v_and_b32 v60, v52, v12
    v_and_b32 v61, v53, v13
    v_and_b32 v62, v54, v14
    s_add_u32 m0, s82, 74752
    s_add_u32 s90, s89, 73728
    buffer_load_dwordx4 v6, s[20:23], s90 offen lds
    v_and_b32 v63, v55, v15
    v_bfi_b32 v48, v8, 0, v48
    v_bfi_b32 v49, v9, 0, v49
    v_bfi_b32 v50, v10, 0, v50
    v_bfi_b32 v51, v11, 0, v51
    v_bfi_b32 v52, v12, 0, v52
    v_bfi_b32 v53, v13, 0, v53
    v_bfi_b32 v54, v14, 0, v54
    v_bfi_b32 v55, v15, 0, v55
    v_pk_fma_f32 v[64:65], v[64:65], s[14:15], v[32:33] op_sel_hi:[1,1,0]
    v_pk_fma_f32 v[66:67], v[66:67], s[14:15], v[32:33] op_sel_hi:[1,1,0]
    v_pk_fma_f32 v[68:69], v[68:69], s[14:15], v[32:33] op_sel_hi:[1,1,0]
    v_pk_fma_f32 v[70:71], v[70:71], s[14:15], v[32:33] op_sel_hi:[1,1,0]
    v_pk_fma_f32 v[72:73], v[72:73], s[14:15], v[32:33] op_sel_hi:[1,1,0]
    v_pk_fma_f32 v[74:75], v[74:75], s[14:15], v[32:33] op_sel_hi:[1,1,0]
    v_pk_fma_f32 v[76:77], v[76:77], s[14:15], v[32:33] op_sel_hi:[1,1,0]
    v_pk_fma_f32 v[78:79], v[78:79], s[14:15], v[32:33] op_sel_hi:[1,1,0]
    v_mfma_f32_32x32x16_bf16 v[16:31], v[232:235], v[56:59], 0
    v_exp_f32 v64, v64 clamp
    v_exp_f32 v65, v65 clamp
    v_exp_f32 v66, v66 clamp
    v_exp_f32 v67, v67 clamp
    v_mfma_f32_32x32x16_bf16 v[16:31], v[224:227], v[60:63], v[16:31]
    v_exp_f32 v68, v68 clamp
    v_exp_f32 v69, v69 clamp
    v_exp_f32 v70, v70 clamp
    v_exp_f32 v71, v71 clamp
    s_waitcnt vmcnt(17)
    v_mfma_f32_32x32x16_bf16 v[16:31], a[128:131], v[48:51], v[16:31]
    v_exp_f32 v72, v72 clamp
    v_exp_f32 v73, v73 clamp
    v_exp_f32 v74, v74 clamp
    v_exp_f32 v75, v75 clamp
    v_mfma_f32_32x32x16_bf16 v[16:31], a[132:135], v[52:55], v[16:31]
    v_exp_f32 v76, v76 clamp
    v_exp_f32 v77, v77 clamp
    v_exp_f32 v78, v78 clamp
    v_exp_f32 v79, v79 clamp
    v_mfma_f32_32x32x16_bf16 v[48:63], v[196:199], v[252:255], 0
    v_cvt_pk_bf16_f32 v64, v64, v65
    v_cvt_pk_bf16_f32 v65, v66, v67
    v_cvt_pk_bf16_f32 v66, v68, v69
    v_cvt_pk_bf16_f32 v67, v70, v71
    s_add_u32 m0, s82, 75776
    s_add_u32 s90, s89, 81920
    buffer_load_dwordx4 v6, s[20:23], s90 offen lds
    v_cvt_pk_bf16_f32 v68, v72, v73
    s_add_u32 m0, s82, 76800
    s_add_u32 s90, s89, 90112
    buffer_load_dwordx4 v6, s[20:23], s90 offen lds
    v_cvt_pk_bf16_f32 v69, v74, v75
    s_add_u32 m0, s82, 77824
    s_add_u32 s90, s89, 98304
    buffer_load_dwordx4 v6, s[20:23], s90 offen lds
    v_cvt_pk_bf16_f32 v70, v76, v77
    v_cvt_pk_bf16_f32 v71, v78, v79
    s_cmp_ge_u32 s10, 4
    s_cbranch_scc1 mg01
    s_nop 11
    v_mov_b32 v48, s4
    v_mov_b32 v49, s4
    v_mov_b32 v50, s4
    v_mov_b32 v51, s4
    v_mov_b32 v52, s4
    v_mov_b32 v53, s4
    v_mov_b32 v54, s4
    v_mov_b32 v55, s4
    v_mov_b32 v56, s4
    v_mov_b32 v57, s4
    v_mov_b32 v58, s4
    v_mov_b32 v59, s4
    v_mov_b32 v60, s4
    v_mov_b32 v61, s4
    v_mov_b32 v62, s4
    v_mov_b32 v63, s4
mg01:
    v_cndmask_b32 v48, v48, v176, s[32:33]
    v_cndmask_b32 v49, v49, v177, s[34:35]
    v_cndmask_b32 v50, v50, v178, s[36:37]
    v_cndmask_b32 v51, v51, v179, s[38:39]
    v_cndmask_b32 v52, v52, v180, s[40:41]
    v_cndmask_b32 v53, v53, v181, s[42:43]
    v_cndmask_b32 v54, v54, v182, s[44:45]
    v_cndmask_b32 v55, v55, v183, s[46:47]
    v_cndmask_b32 v56, v56, v184, s[48:49]
    v_cndmask_b32 v57, v57, v185, s[50:51]
    v_cndmask_b32 v58, v58, v186, s[52:53]
    v_cndmask_b32 v59, v59, v187, s[54:55]
    v_cndmask_b32 v60, v60, v188, s[56:57]
    v_cndmask_b32 v61, v61, v189, s[58:59]
    v_cndmask_b32 v62, v62, v190, s[60:61]
    v_cndmask_b32 v63, v63, v191, s[62:63]
    v_pk_fma_f32 v[80:81], v[80:81], s[14:15], v[32:33] op_sel_hi:[1,1,0]
    v_pk_fma_f32 v[82:83], v[82:83], s[14:15], v[32:33] op_sel_hi:[1,1,0]
    v_pk_fma_f32 v[84:85], v[84:85], s[14:15], v[32:33] op_sel_hi:[1,1,0]
    v_pk_fma_f32 v[86:87], v[86:87], s[14:15], v[32:33] op_sel_hi:[1,1,0]
    v_pk_fma_f32 v[88:89], v[88:89], s[14:15], v[32:33] op_sel_hi:[1,1,0]
    v_pk_fma_f32 v[90:91], v[90:91], s[14:15], v[32:33] op_sel_hi:[1,1,0]
    v_pk_fma_f32 v[92:93], v[92:93], s[14:15], v[32:33] op_sel_hi:[1,1,0]
    v_pk_fma_f32 v[94:95], v[94:95], s[14:15], v[32:33] op_sel_hi:[1,1,0]
    s_waitcnt vmcnt(18)
    v_mfma_f32_32x32x16_bf16 v[16:31], a[136:139], v[64:67], v[16:31]
    v_exp_f32 v80, v80 clamp
    v_exp_f32 v81, v81 clamp
    v_exp_f32 v82, v82 clamp
    v_exp_f32 v83, v83 clamp
    v_exp_f32 v84, v84 clamp
    v_mfma_f32_32x32x16_bf16 v[16:31], a[140:143], v[68:71], v[16:31]
    v_exp_f32 v85, v85 clamp
    v_exp_f32 v86, v86 clamp
    v_exp_f32 v87, v87 clamp
    v_exp_f32 v88, v88 clamp
    v_exp_f32 v89, v89 clamp
    v_mfma_f32_32x32x16_bf16 v[176:191], v[240:243], v[252:255], 0
    v_exp_f32 v90, v90 clamp
    v_exp_f32 v91, v91 clamp
    v_exp_f32 v92, v92 clamp
    v_exp_f32 v93, v93 clamp
    v_exp_f32 v94, v94 clamp
    v_mfma_f32_32x32x16_bf16 v[64:79], v[200:203], v[252:255], 0
    v_exp_f32 v95, v95 clamp
    v_cvt_pk_bf16_f32 v80, v80, v81
    v_cvt_pk_bf16_f32 v81, v82, v83
    v_cvt_pk_bf16_f32 v82, v84, v85
    v_cvt_pk_bf16_f32 v83, v86, v87
    s_add_u32 m0, s82, 78848
    s_add_u32 s90, s89, 106496
    buffer_load_dwordx4 v6, s[20:23], s90 offen lds
    v_cvt_pk_bf16_f32 v84, v88, v89
    v_cvt_pk_bf16_f32 v85, v90, v91
    v_cvt_pk_bf16_f32 v86, v92, v93
    v_cvt_pk_bf16_f32 v87, v94, v95
    s_add_u32 m0, s82, 79872
    s_add_u32 s90, s89, 114688
    buffer_load_dwordx4 v6, s[20:23], s90 offen lds
    v_max3_f32 v34, v48, v49, v50
    v_max3_f32 v34, v34, v51, v52
    v_max3_f32 v34, v34, v53, v54
    v_max3_f32 v34, v34, v55, v56
    s_add_u32 m0, s82, 80896
    s_add_u32 s90, s89, 122880
    buffer_load_dwordx4 v6, s[20:23], s90 offen lds
    v_max3_f32 v34, v34, v57, v58
    v_max3_f32 v34, v34, v59, v60
    v_max3_f32 v34, v34, v61, v62
    v_max_f32 v34, v34, v63
    s_waitcnt vmcnt(10)
    s_mov_b32 exec_lo, 0xffffffff
    s_mov_b32 exec_hi, 0xfffffff
    s_mov_b32 s30, 0
    s_branch poll3_l
poll3:
    buffer_load_dwordx2 v[42:43], v41, s[16:19], 0 offen sc1
poll3_c:
    s_waitcnt vmcnt(0)
poll3_l:
    s_add_u32 s30, s30, 1
    v_subrev_u32 v42, s72, v42
    v_cmp_eq_u32 s[74:75], s73, v43
    v_cmp_gt_u32 s[76:77], 32, v42
    v_cmp_le_u32 vcc, v46, v42
    s_and_b64 s[74:75], s[74:75], s[76:77]
    s_and_b64 vcc, vcc, s[74:75]
    s_cmp_eq_u64 vcc, exec
    s_cbranch_scc1 poll3_x
    s_cmp_gt_u32 s30, 0x8000
    s_cbranch_scc0 poll3
poll3_x:
    s_mov_b64 exec, -1
    v_cmp_eq_u32 s[74:75], s97, v42
    s_nop 0
    s_and_b32 s75, s75, vcc_hi
    s_and_b32 s75, s75, 0xff00000
    s_cmp_eq_u32 s75, 0xff00000
    s_cselect_b32 s97, 1, 0
    v_and_b32 v40, 15, v1
    v_lshlrev_b32 v40, 7, v40
    v_lshrrev_b32 v41, 4, v1
    v_lshlrev_b32 v41, 21, v41
    v_add_u32 v41, v40, v41
    s_lshl_b32 s31, s10, 14
    s_lshl_b32 s30, s13, 9
    s_add_u32 s31, s31, s30
    s_add_u32 s31, s31, 0xd00000
    s_mov_b64 exec, 0xf
    buffer_load_dword v47, v40, s[16:19], s31 offen
    s_mov_b64 exec, -1
    v_pk_fma_f32 v[96:97], v[96:97], s[14:15], v[32:33] op_sel_hi:[1,1,0]
    v_pk_fma_f32 v[98:99], v[98:99], s[14:15], v[32:33] op_sel_hi:[1,1,0]
    v_pk_fma_f32 v[100:101], v[100:101], s[14:15], v[32:33] op_sel_hi:[1,1,0]
    v_pk_fma_f32 v[102:103], v[102:103], s[14:15], v[32:33] op_sel_hi:[1,1,0]
    v_pk_fma_f32 v[104:105], v[104:105], s[14:15], v[32:33] op_sel_hi:[1,1,0]
    v_pk_fma_f32 v[106:107], v[106:107], s[14:15], v[32:33] op_sel_hi:[1,1,0]
    v_pk_fma_f32 v[108:109], v[108:109], s[14:15], v[32:33] op_sel_hi:[1,1,0]
    v_pk_fma_f32 v[110:111], v[110:111], s[14:15], v[32:33] op_sel_hi:[1,1,0]
    v_mfma_f32_32x32x16_bf16 v[16:31], a[144:147], v[80:83], v[16:31]
    v_exp_f32 v96, v96 clamp
    v_exp_f32 v97, v97 clamp
    v_exp_f32 v98, v98 clamp
    v_exp_f32 v99, v99 clamp
    v_mfma_f32_32x32x16_bf16 v[16:31], a[148:151], v[84:87], v[16:31]
    v_exp_f32 v100, v100 clamp
    v_exp_f32 v101, v101 clamp
    v_exp_f32 v102, v102 clamp
    v_exp_f32 v103, v103 clamp
    v_exp_f32 v104, v104 clamp
    v_mfma_f32_32x32x16_bf16 v[80:95], v[204:207], v[252:255], 0
    v_exp_f32 v105, v105 clamp
    v_exp_f32 v106, v106 clamp
    v_exp_f32 v107, v107 clamp
    v_exp_f32 v108, v108 clamp
    v_exp_f32 v109, v109 clamp
    s_add_u32 s87, s80, 0x180000
    buffer_load_dwordx4 a[0:3], v2, s[16:19], s87 offen offset:0 sc1
    v_exp_f32 v110, v110 clamp
    v_exp_f32 v111, v111 clamp
    v_cvt_pk_bf16_f32 v96, v96, v97
    v_cvt_pk_bf16_f32 v97, v98, v99
    v_cvt_pk_bf16_f32 v98, v100, v101
    v_cvt_pk_bf16_f32 v99, v102, v103
    v_cvt_pk_bf16_f32 v100, v104, v105
    v_cvt_pk_bf16_f32 v101, v106, v107
    v_cvt_pk_bf16_f32 v102, v108, v109
    buffer_load_dwordx4 a[4:7], v2, s[16:19], s87 offen offset:1024 sc1
    v_cvt_pk_bf16_f32 v103, v110, v111
    v_max3_f32 v34, v34, v176, v177
    v_max3_f32 v34, v34, v178, v179
    v_max3_f32 v34, v34, v180, v181
    v_max3_f32 v34, v34, v182, v183
    v_max3_f32 v34, v34, v184, v185
    v_max3_f32 v34, v34, v186, v187
    v_max3_f32 v34, v34, v188, v189
    v_max3_f32 v34, v34, v190, v191
    buffer_load_dwordx4 a[8:11], v2, s[16:19], s87 offen offset:2048 sc1
    v_max3_f32 v37, v64, v65, v66
    v_max3_f32 v37, v37, v67, v68
    v_max3_f32 v37, v37, v69, v70
    v_max3_f32 v37, v37, v71, v72
    v_max3_f32 v37, v37, v73, v74
    v_max3_f32 v37, v37, v75, v76
    v_max3_f32 v37, v37, v77, v78
    v_max_f32 v37, v37, v79
    v_add_f32 v37, s5, v37
    v_max_f32 v34, v34, v37
    v_pk_fma_f32 v[112:113], v[112:113], s[14:15], v[32:33] op_sel_hi:[1,1,0]
    v_pk_fma_f32 v[114:115], v[114:115], s[14:15], v[32:33] op_sel_hi:[1,1,0]
    v_pk_fma_f32 v[116:117], v[116:117], s[14:15], v[32:33] op_sel_hi:[1,1,0]
    v_pk_fma_f32 v[118:119], v[118:119], s[14:15], v[32:33] op_sel_hi:[1,1,0]
    v_pk_fma_f32 v[120:121], v[120:121], s[14:15], v[32:33] op_sel_hi:[1,1,0]
    v_pk_fma_f32 v[122:123], v[122:123], s[14:15], v[32:33] op_sel_hi:[1,1,0]
    v_pk_fma_f32 v[124:125], v[124:125], s[14:15], v[32:33] op_sel_hi:[1,1,0]
    v_pk_fma_f32 v[126:127], v[126:127], s[14:15], v[32:33] op_sel_hi:[1,1,0]
    v_mfma_f32_32x32x16_bf16 v[16:31], a[152:155], v[96:99], v[16:31]
    v_exp_f32 v112, v112 clamp
    v_exp_f32 v113, v113 clamp
    v_exp_f32 v114, v114 clamp
    v_exp_f32 v115, v115 clamp
    v_mfma_f32_32x32x16_bf16 v[16:31], a[156:159], v[100:103], v[16:31]
    v_exp_f32 v116, v116 clamp
    v_exp_f32 v117, v117 clamp
    v_exp_f32 v118, v118 clamp
    v_exp_f32 v119, v119 clamp
    v_exp_f32 v120, v120 clamp
    v_mfma_f32_32x32x16_bf16 v[96:111], v[208:211], v[252:255], 0
    v_exp_f32 v121, v121 clamp
    v_exp_f32 v122, v122 clamp
    v_exp_f32 v123, v123 clamp
    v_exp_f32 v124, v124 clamp
    v_exp_f32 v125, v125 clamp
    buffer_load_dwordx4 a[12:15], v2, s[16:19], s87 offen offset:3072 sc1
    v_exp_f32 v126, v126 clamp
    v_exp_f32 v127, v127 clamp
    v_cvt_pk_bf16_f32 v112, v112, v113
    v_cvt_pk_bf16_f32 v113, v114, v115
    v_cvt_pk_bf16_f32 v114, v116, v117
    v_cvt_pk_bf16_f32 v115, v118, v119
    s_add_u32 s87, s80, 0x181000
    buffer_load_dwordx4 a[16:19], v2, s[16:19], s87 offen offset:0 sc1
    v_cvt_pk_bf16_f32 v116, v120, v121
    v_cvt_pk_bf16_f32 v117, v122, v123
    v_cvt_pk_bf16_f32 v118, v124, v125
    v_cvt_pk_bf16_f32 v119, v126, v127
    v_max3_f32 v36, v80, v81, v82
    v_max3_f32 v36, v36, v83, v84
    v_max3_f32 v36, v36, v85, v86
    buffer_load_dwordx4 a[20:23], v2, s[16:19], s87 offen offset:1024 sc1
    v_max3_f32 v36, v36, v87, v88
    v_max3_f32 v36, v36, v89, v90
    v_max3_f32 v36, v36, v91, v92
    v_max3_f32 v36, v36, v93, v94
    v_max_f32 v36, v36, v95
    v_add_f32 v36, s5, v36
    v_max_f32 v34, v34, v36
    v_pk_fma_f32 v[128:129], v[128:129], s[14:15], v[32:33] op_sel_hi:[1,1,0]
    v_pk_fma_f32 v[130:131], v[130:131], s[14:15], v[32:33] op_sel_hi:[1,1,0]
    v_pk_fma_f32 v[132:133], v[132:133], s[14:15], v[32:33] op_sel_hi:[1,1,0]
    v_pk_fma_f32 v[134:135], v[134:135], s[14:15], v[32:33] op_sel_hi:[1,1,0]
    v_pk_fma_f32 v[136:137], v[136:137], s[14:15], v[32:33] op_sel_hi:[1,1,0]
    v_pk_fma_f32 v[138:139], v[138:139], s[14:15], v[32:33] op_sel_hi:[1,1,0]
    v_pk_fma_f32 v[140:141], v[140:141], s[14:15], v[32:33] op_sel_hi:[1,1,0]
    v_pk_fma_f32 v[142:143], v[142:143], s[14:15], v[32:33] op_sel_hi:[1,1,0]
    v_mfma_f32_32x32x16_bf16 v[16:31], a[160:163], v[112:115], v[16:31]
    v_exp_f32 v128, v128 clamp
    v_exp_f32 v129, v129 clamp
    v_exp_f32 v130, v130 clamp
    v_exp_f32 v131, v131 clamp
    v_mfma_f32_32x32x16_bf16 v[16:31], a[164:167], v[116:119], v[16:31]
    v_exp_f32 v132, v132 clamp
    v_exp_f32 v133, v133 clamp
    v_exp_f32 v134, v134 clamp
    v_exp_f32 v135, v135 clamp
    v_exp_f32 v136, v136 clamp
    v_mfma_f32_32x32x16_bf16 v[112:127], v[212:215], v[252:255], 0
    v_exp_f32 v137, v137 clamp
    v_exp_f32 v138, v138 clamp
    v_exp_f32 v139, v139 clamp
    v_exp_f32 v140, v140 clamp
    v_exp_f32 v141, v141 clamp
    buffer_load_dwordx4 a[24:27], v2, s[16:19], s87 offen offset:2048 sc1
    v_exp_f32 v142, v142 clamp
    v_exp_f32 v143, v143 clamp
    v_cvt_pk_bf16_f32 v128, v128, v129
    v_cvt_pk_bf16_f32 v129, v130, v131
    v_cvt_pk_bf16_f32 v130, v132, v133
    v_cvt_pk_bf16_f32 v131, v134, v135
    buffer_load_dwordx4 a[28:31], v2, s[16:19], s87 offen offset:3072 sc1
    v_cvt_pk_bf16_f32 v132, v136, v137
    v_cvt_pk_bf16_f32 v133, v138, v139
    v_cvt_pk_bf16_f32 v134, v140, v141
    v_cvt_pk_bf16_f32 v135, v142, v143
    v_max3_f32 v37, v96, v97, v98
    v_max3_f32 v37, v37, v99, v100
    v_max3_f32 v37, v37, v101, v102
    s_add_u32 s87, s80, 0x182000
    buffer_load_dwordx4 a[32:35], v2, s[16:19], s87 offen offset:0 sc1
    v_max3_f32 v37, v37, v103, v104
    v_max3_f32 v37, v37, v105, v106
    v_max3_f32 v37, v37, v107, v108
    v_max3_f32 v37, v37, v109, v110
    v_max_f32 v37, v37, v111
    v_add_f32 v37, s6, v37
    v_max_f32 v34, v34, v37
    v_pk_fma_f32 v[144:145], v[144:145], s[14:15], v[32:33] op_sel_hi:[1,1,0]
    v_pk_fma_f32 v[146:147], v[146:147], s[14:15], v[32:33] op_sel_hi:[1,1,0]
    v_pk_fma_f32 v[148:149], v[148:149], s[14:15], v[32:33] op_sel_hi:[1,1,0]
    v_pk_fma_f32 v[150:151], v[150:151], s[14:15], v[32:33] op_sel_hi:[1,1,0]
    v_pk_fma_f32 v[152:153], v[152:153], s[14:15], v[32:33] op_sel_hi:[1,1,0]
    v_pk_fma_f32 v[154:155], v[154:155], s[14:15], v[32:33] op_sel_hi:[1,1,0]
    v_pk_fma_f32 v[156:157], v[156:157], s[14:15], v[32:33] op_sel_hi:[1,1,0]
    v_pk_fma_f32 v[158:159], v[158:159], s[14:15], v[32:33] op_sel_hi:[1,1,0]
    v_mfma_f32_32x32x16_bf16 v[16:31], a[168:171], v[128:131], v[16:31]
    v_exp_f32 v144, v144 clamp
    v_exp_f32 v145, v145 clamp
    v_exp_f32 v146, v146 clamp
    v_exp_f32 v147, v147 clamp
    v_mfma_f32_32x32x16_bf16 v[16:31], a[172:175], v[132:135], v[16:31]
    v_exp_f32 v148, v148 clamp
    v_exp_f32 v149, v149 clamp
    v_exp_f32 v150, v150 clamp
    v_exp_f32 v151, v151 clamp
    v_exp_f32 v152, v152 clamp
    v_mfma_f32_32x32x16_bf16 v[128:143], v[216:219], v[252:255], 0
    v_exp_f32 v153, v153 clamp
    v_exp_f32 v154, v154 clamp
    v_exp_f32 v155, v155 clamp
    v_exp_f32 v156, v156 clamp
    v_exp_f32 v157, v157 clamp
    buffer_load_dwordx4 a[36:39], v2, s[16:19], s87 offen offset:1024 sc1
    v_exp_f32 v158, v158 clamp
    v_exp_f32 v159, v159 clamp
    v_cvt_pk_bf16_f32 v144, v144, v145
    v_cvt_pk_bf16_f32 v145, v146, v147
    v_cvt_pk_bf16_f32 v146, v148, v149
    v_cvt_pk_bf16_f32 v147, v150, v151
    buffer_load_dwordx4 a[40:43], v2, s[16:19], s87 offen offset:2048 sc1
    v_cvt_pk_bf16_f32 v148, v152, v153
    v_cvt_pk_bf16_f32 v149, v154, v155
    v_cvt_pk_bf16_f32 v150, v156, v157
    v_cvt_pk_bf16_f32 v151, v158, v159
    v_max3_f32 v36, v112, v113, v114
    v_max3_f32 v36, v36, v115, v116
    v_max3_f32 v36, v36, v117, v118
    buffer_load_dwordx4 a[44:47], v2, s[16:19], s87 offen offset:3072 sc1
    v_max3_f32 v36, v36, v119, v120
    v_max3_f32 v36, v36, v121, v122
    v_max3_f32 v36, v36, v123, v124
    v_max3_f32 v36, v36, v125, v126
    v_max_f32 v36, v36, v127
    v_add_f32 v36, s6, v36
    v_max_f32 v34, v34, v36
    v_pk_fma_f32 v[160:161], v[160:161], s[14:15], v[32:33] op_sel_hi:[1,1,0]
    v_pk_fma_f32 v[162:163], v[162:163], s[14:15], v[32:33] op_sel_hi:[1,1,0]
    v_pk_fma_f32 v[164:165], v[164:165], s[14:15], v[32:33] op_sel_hi:[1,1,0]
    v_pk_fma_f32 v[166:167], v[166:167], s[14:15], v[32:33] op_sel_hi:[1,1,0]
    v_pk_fma_f32 v[168:169], v[168:169], s[14:15], v[32:33] op_sel_hi:[1,1,0]
    v_pk_fma_f32 v[170:171], v[170:171], s[14:15], v[32:33] op_sel_hi:[1,1,0]
    v_pk_fma_f32 v[172:173], v[172:173], s[14:15], v[32:33] op_sel_hi:[1,1,0]
    v_pk_fma_f32 v[174:175], v[174:175], s[14:15], v[32:33] op_sel_hi:[1,1,0]
    v_mfma_f32_32x32x16_bf16 v[16:31], a[176:179], v[144:147], v[16:31]
    v_exp_f32 v160, v160 clamp
    v_exp_f32 v161, v161 clamp
    v_exp_f32 v162, v162 clamp
    v_exp_f32 v163, v163 clamp
    v_mfma_f32_32x32x16_bf16 v[16:31], a[180:183], v[148:151], v[16:31]
    v_exp_f32 v164, v164 clamp
    v_exp_f32 v165, v165 clamp
    v_exp_f32 v166, v166 clamp
    v_exp_f32 v167, v167 clamp
    v_exp_f32 v168, v168 clamp
    v_mfma_f32_32x32x16_bf16 v[144:159], v[220:223], v[252:255], 0
    v_exp_f32 v169, v169 clamp
    v_exp_f32 v170, v170 clamp
    v_exp_f32 v171, v171 clamp
    v_exp_f32 v172, v172 clamp
    v_exp_f32 v173, v173 clamp
    s_add_u32 s87, s80, 0x183000
    buffer_load_dwordx4 a[48:51], v2, s[16:19], s87 offen offset:0 sc1
    v_exp_f32 v174, v174 clamp
    v_exp_f32 v175, v175 clamp
    v_cvt_pk_bf16_f32 v160, v160, v161
    v_cvt_pk_bf16_f32 v161, v162, v163
    v_cvt_pk_bf16_f32 v162, v164, v165
    v_cvt_pk_bf16_f32 v163, v166, v167
    buffer_load_dwordx4 a[52:55], v2, s[16:19], s87 offen offset:1024 sc1
    v_cvt_pk_bf16_f32 v164, v168, v169
    v_cvt_pk_bf16_f32 v165, v170, v171
    v_cvt_pk_bf16_f32 v166, v172, v173
    v_cvt_pk_bf16_f32 v167, v174, v175
    v_max3_f32 v37, v128, v129, v130
    v_max3_f32 v37, v37, v131, v132
    v_max3_f32 v37, v37, v133, v134
    buffer_load_dwordx4 a[56:59], v2, s[16:19], s87 offen offset:2048 sc1
    v_max3_f32 v37, v37, v135, v136
    v_max3_f32 v37, v37, v137, v138
    v_max3_f32 v37, v37, v139, v140
    v_max3_f32 v37, v37, v141, v142
    v_max_f32 v37, v37, v143
    v_add_f32 v37, s7, v37
    v_max_f32 v34, v34, v37
    v_max3_f32 v36, v144, v145, v146
    v_max3_f32 v36, v36, v147, v148
    v_max3_f32 v36, v36, v149, v150
    v_max3_f32 v36, v36, v151, v152
    v_max3_f32 v36, v36, v153, v154
    v_max3_f32 v36, v36, v155, v156
    v_max3_f32 v36, v36, v157, v158
    v_max_f32 v36, v36, v159
    v_add_f32 v36, s7, v36
    v_max_f32 v34, v34, v36
    v_mov_b32 v35, v34
    s_nop 1
    v_permlane32_swap_b32 v34, v35
    v_max_f32 v34, v34, v35
    v_mul_f32 v34, 0xbeb8aa3b, v34
    v_pk_fma_f32 v[48:49], v[48:49], s[14:15], v[34:35] op_sel_hi:[1,1,0]
    v_pk_fma_f32 v[50:51], v[50:51], s[14:15], v[34:35] op_sel_hi:[1,1,0]
    v_pk_fma_f32 v[52:53], v[52:53], s[14:15], v[34:35] op_sel_hi:[1,1,0]
    v_pk_fma_f32 v[54:55], v[54:55], s[14:15], v[34:35] op_sel_hi:[1,1,0]
    v_pk_fma_f32 v[56:57], v[56:57], s[14:15], v[34:35] op_sel_hi:[1,1,0]
    v_pk_fma_f32 v[58:59], v[58:59], s[14:15], v[34:35] op_sel_hi:[1,1,0]
    v_pk_fma_f32 v[60:61], v[60:61], s[14:15], v[34:35] op_sel_hi:[1,1,0]
    v_pk_fma_f32 v[62:63], v[62:63], s[14:15], v[34:35] op_sel_hi:[1,1,0]
    s_waitcnt vmcnt(24)
    v_mfma_f32_32x32x16_bf16 v[16:31], a[184:187], v[160:163], v[16:31]
    v_exp_f32 v48, v48
    v_exp_f32 v49, v49
    v_exp_f32 v50, v50
    v_exp_f32 v51, v51
    v_exp_f32 v52, v52
    v_exp_f32 v53, v53
    v_mfma_f32_32x32x16_bf16 v[16:31], a[188:191], v[164:167], v[16:31]
    v_exp_f32 v54, v54
    v_exp_f32 v55, v55
    v_exp_f32 v56, v56
    v_exp_f32 v57, v57
    v_exp_f32 v58, v58
    v_exp_f32 v59, v59
    buffer_load_dwordx4 a[60:63], v2, s[16:19], s87 offen offset:3072 sc1
    v_exp_f32 v60, v60
    v_exp_f32 v61, v61
    v_exp_f32 v62, v62
    v_exp_f32 v63, v63
    v_cvt_pk_bf16_f32 v48, v48, v49
    v_cvt_pk_bf16_f32 v49, v50, v51
    v_cvt_pk_bf16_f32 v50, v52, v53
    v_cvt_pk_bf16_f32 v51, v54, v55
    v_cvt_pk_bf16_f32 v52, v56, v57
    v_cvt_pk_bf16_f32 v53, v58, v59
    v_cvt_pk_bf16_f32 v54, v60, v61
    v_cvt_pk_bf16_f32 v55, v62, v63
    s_add_u32 s87, s80, 0x184000
    buffer_load_dwordx4 a[64:67], v2, s[16:19], s87 offen offset:0 sc1
    v_and_b32 v56, v48, v8
    v_and_b32 v57, v49, v9
    v_and_b32 v58, v50, v10
    v_and_b32 v59, v51, v11
    v_and_b32 v60, v52, v12
    v_and_b32 v61, v53, v13
    v_and_b32 v62, v54, v14
    v_and_b32 v63, v55, v15
    v_bfi_b32 v48, v8, 0, v48
    v_bfi_b32 v49, v9, 0, v49
    v_bfi_b32 v50, v10, 0, v50
    v_bfi_b32 v51, v11, 0, v51
    v_bfi_b32 v52, v12, 0, v52
    buffer_load_dwordx4 a[68:71], v2, s[16:19], s87 offen offset:1024 sc1
    v_bfi_b32 v53, v13, 0, v53
    v_bfi_b32 v54, v14, 0, v54
    v_bfi_b32 v55, v15, 0, v55
    v_rcp_f32 v38, v24
    s_nop 0
    v_pk_mul_f32 v[16:17], v[16:17], v[38:39] op_sel_hi:[1,0]
    v_pk_mul_f32 v[18:19], v[18:19], v[38:39] op_sel_hi:[1,0]
    v_pk_mul_f32 v[20:21], v[20:21], v[38:39] op_sel_hi:[1,0]
    v_pk_mul_f32 v[22:23], v[22:23], v[38:39] op_sel_hi:[1,0]
    v_cvt_pk_bf16_f32 v40, v16, v17
    v_cvt_pk_bf16_f32 v41, v18, v19
    v_cvt_pk_bf16_f32 v42, v20, v21
    v_cvt_pk_bf16_f32 v43, v22, v23
    s_add_u32 s64, s85, 0x900000
    buffer_store_dwordx4 v[40:43], v2, s[16:19], s64 offen sc1
    v_pk_fma_f32 v[64:65], v[64:65], s[14:15], v[34:35] op_sel_hi:[1,1,0]
    v_pk_fma_f32 v[66:67], v[66:67], s[14:15], v[34:35] op_sel_hi:[1,1,0]
    v_pk_fma_f32 v[68:69], v[68:69], s[14:15], v[34:35] op_sel_hi:[1,1,0]
    v_pk_fma_f32 v[70:71], v[70:71], s[14:15], v[34:35] op_sel_hi:[1,1,0]
    v_pk_fma_f32 v[72:73], v[72:73], s[14:15], v[34:35] op_sel_hi:[1,1,0]
    v_pk_fma_f32 v[74:75], v[74:75], s[14:15], v[34:35] op_sel_hi:[1,1,0]
    v_pk_fma_f32 v[76:77], v[76:77], s[14:15], v[34:35] op_sel_hi:[1,1,0]
    v_pk_fma_f32 v[78:79], v[78:79], s[14:15], v[34:35] op_sel_hi:[1,1,0]
    v_mfma_f32_32x32x16_bf16 v[16:31], v[236:239], v[56:59], 0
    v_exp_f32 v64, v64 clamp
    v_exp_f32 v65, v65 clamp
    v_exp_f32 v66, v66 clamp
    v_exp_f32 v67, v67 clamp
    v_exp_f32 v68, v68 clamp
    v_mfma_f32_32x32x16_bf16 v[16:31], v[228:231], v[60:63], v[16:31]
    v_exp_f32 v69, v69 clamp
    v_exp_f32 v70, v70 clamp
    v_exp_f32 v71, v71 clamp
    v_exp_f32 v72, v72 clamp
    v_exp_f32 v73, v73 clamp
    v_mfma_f32_32x32x16_bf16 v[16:31], a[136:139], v[48:51], v[16:31]
    v_exp_f32 v74, v74 clamp
    v_exp_f32 v75, v75 clamp
    v_exp_f32 v76, v76 clamp
    v_exp_f32 v77, v77 clamp
    v_exp_f32 v78, v78 clamp
    v_mfma_f32_32x32x16_bf16 v[16:31], a[140:143], v[52:55], v[16:31]
    v_exp_f32 v79, v79 clamp
    v_cvt_pk_bf16_f32 v64, v64, v65
    v_cvt_pk_bf16_f32 v65, v66, v67
    v_cvt_pk_bf16_f32 v66, v68, v69
    v_cvt_pk_bf16_f32 v67, v70, v71
    buffer_load_dwordx4 a[72:75], v2, s[16:19], s87 offen offset:2048 sc1
    v_cvt_pk_bf16_f32 v68, v72, v73
    buffer_load_dwordx4 a[76:79], v2, s[16:19], s87 offen offset:3072 sc1
    v_cvt_pk_bf16_f32 v69, v74, v75
    s_add_u32 s87, s80, 0x185000
    buffer_load_dwordx4 a[80:83], v2, s[16:19], s87 offen offset:0 sc1
    v_cvt_pk_bf16_f32 v70, v76, v77
    v_cvt_pk_bf16_f32 v71, v78, v79
    s_waitcnt vmcnt(23)
    s_barrier
    v_pk_fma_f32 v[80:81], v[80:81], s[14:15], v[34:35] op_sel_hi:[1,1,0]
    v_pk_fma_f32 v[82:83], v[82:83], s[14:15], v[34:35] op_sel_hi:[1,1,0]
    v_pk_fma_f32 v[84:85], v[84:85], s[14:15], v[34:35] op_sel_hi:[1,1,0]
    v_pk_fma_f32 v[86:87], v[86:87], s[14:15], v[34:35] op_sel_hi:[1,1,0]
    v_pk_fma_f32 v[88:89], v[88:89], s[14:15], v[34:35] op_sel_hi:[1,1,0]
    v_pk_fma_f32 v[90:91], v[90:91], s[14:15], v[34:35] op_sel_hi:[1,1,0]
    v_pk_fma_f32 v[92:93], v[92:93], s[14:15], v[34:35] op_sel_hi:[1,1,0]
    v_pk_fma_f32 v[94:95], v[94:95], s[14:15], v[34:35] op_sel_hi:[1,1,0]
    v_mfma_f32_32x32x16_bf16 v[16:31], a[144:147], v[64:67], v[16:31]
    v_exp_f32 v80, v80 clamp
    v_exp_f32 v81, v81 clamp
    v_exp_f32 v82, v82 clamp
    v_exp_f32 v83, v83 clamp
    v_exp_f32 v84, v84 clamp
    v_exp_f32 v85, v85 clamp
    v_mfma_f32_32x32x16_bf16 v[16:31], a[148:151], v[68:71], v[16:31]
    v_exp_f32 v86, v86 clamp
    v_exp_f32 v87, v87 clamp
    v_exp_f32 v88, v88 clamp
    v_exp_f32 v89, v89 clamp
    v_exp_f32 v90, v90 clamp
    v_exp_f32 v91, v91 clamp
    buffer_load_dwordx4 a[84:87], v2, s[16:19], s87 offen offset:1024 sc1
    v_exp_f32 v92, v92 clamp
    v_exp_f32 v93, v93 clamp
    v_exp_f32 v94, v94 clamp
    v_exp_f32 v95, v95 clamp
    buffer_load_dwordx4 a[88:91], v2, s[16:19], s87 offen offset:2048 sc1
    v_cvt_pk_bf16_f32 v80, v80, v81
    v_cvt_pk_bf16_f32 v81, v82, v83
    v_cvt_pk_bf16_f32 v82, v84, v85
    v_cvt_pk_bf16_f32 v83, v86, v87
    buffer_load_dwordx4 a[92:95], v2, s[16:19], s87 offen offset:3072 sc1
    v_cvt_pk_bf16_f32 v84, v88, v89
    v_cvt_pk_bf16_f32 v85, v90, v91
    v_cvt_pk_bf16_f32 v86, v92, v93
    v_cvt_pk_bf16_f32 v87, v94, v95
    s_add_u32 s30, s72, 2
    v_mov_b32 v4, s30
    v_mov_b32 v5, s73
    s_waitcnt vmcnt(6)
    s_mov_b64 exec, 1
    s_cmp_eq_u32 s97, 1
    s_cbranch_scc0 slow4
    buffer_store_dwordx2 v[4:5], v1, s[16:19], s0 offen
back4:
    s_mov_b64 exec, -1
    v_pk_fma_f32 v[96:97], v[96:97], s[14:15], v[34:35] op_sel_hi:[1,1,0]
    v_pk_fma_f32 v[98:99], v[98:99], s[14:15], v[34:35] op_sel_hi:[1,1,0]
    v_pk_fma_f32 v[100:101], v[100:101], s[14:15], v[34:35] op_sel_hi:[1,1,0]
    v_pk_fma_f32 v[102:103], v[102:103], s[14:15], v[34:35] op_sel_hi:[1,1,0]
    v_pk_fma_f32 v[104:105], v[104:105], s[14:15], v[34:35] op_sel_hi:[1,1,0]
    v_pk_fma_f32 v[106:107], v[106:107], s[14:15], v[34:35] op_sel_hi:[1,1,0]
    v_pk_fma_f32 v[108:109], v[108:109], s[14:15], v[34:35] op_sel_hi:[1,1,0]
    v_pk_fma_f32 v[110:111], v[110:111], s[14:15], v[34:35] op_sel_hi:[1,1,0]
    v_mfma_f32_32x32x16_bf16 v[16:31], a[152:155], v[80:83], v[16:31]
    v_exp_f32 v96, v96 clamp
    v_exp_f32 v97, v97 clamp
    v_exp_f32 v98, v98 clamp
    v_exp_f32 v99, v99 clamp
    v_exp_f32 v100, v100 clamp
    v_exp_f32 v101, v101 clamp
    v_mfma_f32_32x32x16_bf16 v[16:31], a[156:159], v[84:87], v[16:31]
    v_exp_f32 v102, v102 clamp
    v_exp_f32 v103, v103 clamp
    v_exp_f32 v104, v104 clamp
    v_exp_f32 v105, v105 clamp
    v_exp_f32 v106, v106 clamp
    v_exp_f32 v107, v107 clamp
    s_add_u32 s87, s80, 0x186000
    buffer_load_dwordx4 a[96:99], v2, s[16:19], s87 offen offset:0 sc1
    v_exp_f32 v108, v108 clamp
    v_exp_f32 v109, v109 clamp
    v_exp_f32 v110, v110 clamp
    v_exp_f32 v111, v111 clamp
    buffer_load_dwordx4 a[100:103], v2, s[16:19], s87 offen offset:1024 sc1
    v_cvt_pk_bf16_f32 v96, v96, v97
    v_cvt_pk_bf16_f32 v97, v98, v99
    v_cvt_pk_bf16_f32 v98, v100, v101
    v_cvt_pk_bf16_f32 v99, v102, v103
    buffer_load_dwordx4 a[104:107], v2, s[16:19], s87 offen offset:2048 sc1
    v_cvt_pk_bf16_f32 v100, v104, v105
    v_cvt_pk_bf16_f32 v101, v106, v107
    v_cvt_pk_bf16_f32 v102, v108, v109
    v_cvt_pk_bf16_f32 v103, v110, v111
    v_pk_fma_f32 v[112:113], v[112:113], s[14:15], v[34:35] op_sel_hi:[1,1,0]
    v_pk_fma_f32 v[114:115], v[114:115], s[14:15], v[34:35] op_sel_hi:[1,1,0]
    v_pk_fma_f32 v[116:117], v[116:117], s[14:15], v[34:35] op_sel_hi:[1,1,0]
    v_pk_fma_f32 v[118:119], v[118:119], s[14:15], v[34:35] op_sel_hi:[1,1,0]
    v_pk_fma_f32 v[120:121], v[120:121], s[14:15], v[34:35] op_sel_hi:[1,1,0]
    v_pk_fma_f32 v[122:123], v[122:123], s[14:15], v[34:35] op_sel_hi:[1,1,0]
    v_pk_fma_f32 v[124:125], v[124:125], s[14:15], v[34:35] op_sel_hi:[1,1,0]
    v_pk_fma_f32 v[126:127], v[126:127], s[14:15], v[34:35] op_sel_hi:[1,1,0]
    v_mfma_f32_32x32x16_bf16 v[16:31], a[160:163], v[96:99], v[16:31]
    v_exp_f32 v112, v112 clamp
    v_exp_f32 v113, v113 clamp
    v_exp_f32 v114, v114 clamp
    v_exp_f32 v115, v115 clamp
    v_exp_f32 v116, v116 clamp
    v_exp_f32 v117, v117 clamp
    v_mfma_f32_32x32x16_bf16 v[16:31], a[164:167], v[100:103], v[16:31]
    v_exp_f32 v118, v118 clamp
    v_exp_f32 v119, v119 clamp
    v_exp_f32 v120, v120 clamp
    v_exp_f32 v121, v121 clamp
    v_exp_f32 v122, v122 clamp
    v_exp_f32 v123, v123 clamp
    buffer_load_dwordx4 a[108:111], v2, s[16:19], s87 offen offset:3072 sc1
    v_exp_f32 v124, v124 clamp
    v_exp_f32 v125, v125 clamp
    v_exp_f32 v126, v126 clamp
    v_exp_f32 v127, v127 clamp
    s_add_u32 s87, s80, 0x187000
    buffer_load_dwordx4 a[112:115], v2, s[16:19], s87 offen offset:0 sc1
    v_cvt_pk_bf16_f32 v112, v112, v113
    v_cvt_pk_bf16_f32 v113, v114, v115
    v_cvt_pk_bf16_f32 v114, v116, v117
    v_cvt_pk_bf16_f32 v115, v118, v119
    buffer_load_dwordx4 a[116:119], v2, s[16:19], s87 offen offset:1024 sc1
    v_cvt_pk_bf16_f32 v116, v120, v121
    v_cvt_pk_bf16_f32 v117, v122, v123
    v_cvt_pk_bf16_f32 v118, v124, v125
    v_cvt_pk_bf16_f32 v119, v126, v127
    v_pk_fma_f32 v[128:129], v[128:129], s[14:15], v[34:35] op_sel_hi:[1,1,0]
    v_pk_fma_f32 v[130:131], v[130:131], s[14:15], v[34:35] op_sel_hi:[1,1,0]
    v_pk_fma_f32 v[132:133], v[132:133], s[14:15], v[34:35] op_sel_hi:[1,1,0]
    v_pk_fma_f32 v[134:135], v[134:135], s[14:15], v[34:35] op_sel_hi:[1,1,0]
    v_pk_fma_f32 v[136:137], v[136:137], s[14:15], v[34:35] op_sel_hi:[1,1,0]
    v_pk_fma_f32 v[138:139], v[138:139], s[14:15], v[34:35] op_sel_hi:[1,1,0]
    v_pk_fma_f32 v[140:141], v[140:141], s[14:15], v[34:35] op_sel_hi:[1,1,0]
    v_pk_fma_f32 v[142:143], v[142:143], s[14:15], v[34:35] op_sel_hi:[1,1,0]
    v_mfma_f32_32x32x16_bf16 v[16:31], a[168:171], v[112:115], v[16:31]
    v_exp_f32 v128, v128 clamp
    v_exp_f32 v129, v129 clamp
    v_exp_f32 v130, v130 clamp
    v_exp_f32 v131, v131 clamp
    v_exp_f32 v132, v132 clamp
    v_exp_f32 v133, v133 clamp
    v_mfma_f32_32x32x16_bf16 v[16:31], a[172:175], v[116:119], v[16:31]
    v_exp_f32 v134, v134 clamp
    v_exp_f32 v135, v135 clamp
    v_exp_f32 v136, v136 clamp
    v_exp_f32 v137, v137 clamp
    v_exp_f32 v138, v138 clamp
    v_exp_f32 v139, v139 clamp
    buffer_load_dwordx4 a[120:123], v2, s[16:19], s87 offen offset:2048 sc1
    v_exp_f32 v140, v140 clamp
    v_exp_f32 v141, v141 clamp
    v_exp_f32 v142, v142 clamp
    v_exp_f32 v143, v143 clamp
    buffer_load_dwordx4 a[124:127], v2, s[16:19], s87 offen offset:3072 sc1
    v_cvt_pk_bf16_f32 v128, v128, v129
    v_cvt_pk_bf16_f32 v129, v130, v131
    v_cvt_pk_bf16_f32 v130, v132, v133
    v_cvt_pk_bf16_f32 v131, v134, v135
    v_cvt_pk_bf16_f32 v132, v136, v137
    v_cvt_pk_bf16_f32 v133, v138, v139
    v_cvt_pk_bf16_f32 v134, v140, v141
    v_cvt_pk_bf16_f32 v135, v142, v143
    v_pk_fma_f32 v[144:145], v[144:145], s[14:15], v[34:35] op_sel_hi:[1,1,0]
    v_pk_fma_f32 v[146:147], v[146:147], s[14:15], v[34:35] op_sel_hi:[1,1,0]
    v_pk_fma_f32 v[148:149], v[148:149], s[14:15], v[34:35] op_sel_hi:[1,1,0]
    v_pk_fma_f32 v[150:151], v[150:151], s[14:15], v[34:35] op_sel_hi:[1,1,0]
    v_pk_fma_f32 v[152:153], v[152:153], s[14:15], v[34:35] op_sel_hi:[1,1,0]
    v_pk_fma_f32 v[154:155], v[154:155], s[14:15], v[34:35] op_sel_hi:[1,1,0]
    v_pk_fma_f32 v[156:157], v[156:157], s[14:15], v[34:35] op_sel_hi:[1,1,0]
    v_pk_fma_f32 v[158:159], v[158:159], s[14:15], v[34:35] op_sel_hi:[1,1,0]
    v_mfma_f32_32x32x16_bf16 v[16:31], a[176:179], v[128:131], v[16:31]
    v_exp_f32 v144, v144 clamp
    v_exp_f32 v145, v145 clamp
    v_exp_f32 v146, v146 clamp
    v_exp_f32 v147, v147 clamp
    v_exp_f32 v148, v148 clamp
    v_exp_f32 v149, v149 clamp
    v_mfma_f32_32x32x16_bf16 v[16:31], a[180:183], v[132:135], v[16:31]
    v_exp_f32 v150, v150 clamp
    v_exp_f32 v151, v151 clamp
    v_exp_f32 v152, v152 clamp
    v_exp_f32 v153, v153 clamp
    v_exp_f32 v154, v154 clamp
    v_exp_f32 v155, v155 clamp
    v_exp_f32 v156, v156 clamp
    v_exp_f32 v157, v157 clamp
    v_exp_f32 v158, v158 clamp
    v_exp_f32 v159, v159 clamp
    v_cvt_pk_bf16_f32 v144, v144, v145
    v_cvt_pk_bf16_f32 v145, v146, v147
    v_cvt_pk_bf16_f32 v146, v148, v149
    v_cvt_pk_bf16_f32 v147, v150, v151
    v_cvt_pk_bf16_f32 v148, v152, v153
    v_cvt_pk_bf16_f32 v149, v154, v155
    v_cvt_pk_bf16_f32 v150, v156, v157
    v_cvt_pk_bf16_f32 v151, v158, v159
    s_lshl_b32 s31, s10, 8
    s_add_u32 s31, s31, 0x440000
    v_lshlrev_b32 v253, 3, v1
    v_add_u32 v253, s31, v253
    s_mov_b32 exec_lo, 0xffffffff
    s_mov_b32 exec_hi, 0x0
    buffer_load_dwordx2 v[36:37], v253, s[16:19], 0 offen sc1
    s_mov_b64 exec, -1
    v_and_b32 v240, 15, v1
    v_lshrrev_b32 v241, 5, v1
    v_bfe_u32 v242, v1, 4, 1
    v_lshl_add_u32 v243, v242, 5, v240
    v_lshlrev_b32 v243, 4, v243
    v_lshl_add_u32 v243, v241, 10, v243
    s_and_b32 s31, s12, 1
    s_lshl_b32 s31, s31, 8
    v_add_u32 v6, s31, v243
    s_lshl_b32 s3, s10, 16
    s_lshr_b32 s28, s12, 1
    s_lshl_b32 s30, s28, 15
    s_add_u32 s3, s3, s30
    s_add_u32 s28, s28, 2
    v_pk_fma_f32 v[176:177], v[176:177], s[14:15], v[34:35] op_sel_hi:[1,1,0]
    v_pk_fma_f32 v[178:179], v[178:179], s[14:15], v[34:35] op_sel_hi:[1,1,0]
    v_pk_fma_f32 v[180:181], v[180:181], s[14:15], v[34:35] op_sel_hi:[1,1,0]
    v_pk_fma_f32 v[182:183], v[182:183], s[14:15], v[34:35] op_sel_hi:[1,1,0]
    v_pk_fma_f32 v[184:185], v[184:185], s[14:15], v[34:35] op_sel_hi:[1,1,0]
    v_pk_fma_f32 v[186:187], v[186:187], s[14:15], v[34:35] op_sel_hi:[1,1,0]
    v_pk_fma_f32 v[188:189], v[188:189], s[14:15], v[34:35] op_sel_hi:[1,1,0]
    v_pk_fma_f32 v[190:191], v[190:191], s[14:15], v[34:35] op_sel_hi:[1,1,0]
    v_mfma_f32_32x32x16_bf16 v[16:31], a[184:187], v[144:147], v[16:31]
    v_exp_f32 v176, v176
    v_exp_f32 v177, v177
    v_exp_f32 v178, v178
    v_exp_f32 v179, v179
    v_exp_f32 v180, v180
    v_exp_f32 v181, v181
    v_mfma_f32_32x32x16_bf16 v[16:31], a[188:191], v[148:151], v[16:31]
    v_exp_f32 v182, v182
    v_exp_f32 v183, v183
    v_exp_f32 v184, v184
    v_exp_f32 v185, v185
    v_exp_f32 v186, v186
    v_exp_f32 v187, v187
    v_exp_f32 v188, v188
    v_exp_f32 v189, v189
    v_exp_f32 v190, v190
    v_exp_f32 v191, v191
    v_cvt_pk_bf16_f32 v176, v176, v177
    v_cvt_pk_bf16_f32 v177, v178, v179
    v_cvt_pk_bf16_f32 v178, v180, v181
    v_cvt_pk_bf16_f32 v179, v182, v183
    v_cvt_pk_bf16_f32 v180, v184, v185
    v_cvt_pk_bf16_f32 v181, v186, v187
    v_cvt_pk_bf16_f32 v182, v188, v189
    v_cvt_pk_bf16_f32 v183, v190, v191
    v_mfma_f32_32x32x16_bf16 v[16:31], v[232:235], v[176:179], v[16:31]
    s_nop 0
    v_mfma_f32_32x32x16_bf16 v[16:31], v[224:227], v[180:183], v[16:31]
    s_nop 11
    v_rcp_f32 v38, v24
    s_nop 0
    v_pk_mul_f32 v[16:17], v[16:17], v[38:39] op_sel_hi:[1,0]
    v_pk_mul_f32 v[18:19], v[18:19], v[38:39] op_sel_hi:[1,0]
    v_pk_mul_f32 v[20:21], v[20:21], v[38:39] op_sel_hi:[1,0]
    v_pk_mul_f32 v[22:23], v[22:23], v[38:39] op_sel_hi:[1,0]
    v_cvt_pk_bf16_f32 v44, v16, v17
    v_cvt_pk_bf16_f32 v45, v18, v19
    v_cvt_pk_bf16_f32 v46, v20, v21
    v_cvt_pk_bf16_f32 v47, v22, v23
    s_add_u32 s65, s85, 0x908000
    buffer_store_dwordx4 v[44:47], v2, s[16:19], s65 offen sc1
    s_waitcnt vmcnt(1)
    s_mov_b32 exec_lo, 0xffffffff
    s_mov_b32 exec_hi, 0x0
    v_subrev_u32 v36, s72, v36
    v_cmp_eq_u32 s[74:75], s73, v37
    v_cmp_gt_u32 s[76:77], 32, v36
    v_cmp_le_u32 vcc, s28, v36
    s_and_b64 s[74:75], s[74:75], s[76:77]
    s_and_b64 vcc, vcc, s[74:75]
    s_cmp_eq_u64 vcc, exec
    s_cselect_b32 s1, 1, 0
    s_mov_b64 exec, -1
    s_cbranch_scc0 oaB0
    s_add_u32 s66, s3, 0x900000
    buffer_load_dwordx4 v[16:19], v6, s[16:19], s66 offen offset:0 sc1
    buffer_load_dwordx4 v[20:23], v6, s[16:19], s66 offen offset:2048 sc1
    s_add_u32 s67, s3, 0x901000
    buffer_load_dwordx4 v[24:27], v6, s[16:19], s67 offen offset:0 sc1
    buffer_load_dwordx4 v[28:31], v6, s[16:19], s67 offen offset:2048 sc1
    s_add_u32 s68, s3, 0x902000
    buffer_load_dwordx4 v[32:35], v6, s[16:19], s68 offen offset:0 sc1
    buffer_load_dwordx4 v[36:39], v6, s[16:19], s68 offen offset:2048 sc1
    s_add_u32 s69, s3, 0x903000
    buffer_load_dwordx4 v[40:43], v6, s[16:19], s69 offen offset:0 sc1
    buffer_load_dwordx4 v[44:47], v6, s[16:19], s69 offen offset:2048 sc1
    s_add_u32 s70, s3, 0x904000
    buffer_load_dwordx4 v[48:51], v6, s[16:19], s70 offen offset:0 sc1
    buffer_load_dwordx4 v[52:55], v6, s[16:19], s70 offen offset:2048 sc1
    s_add_u32 s71, s3, 0x905000
    buffer_load_dwordx4 v[56:59], v6, s[16:19], s71 offen offset:0 sc1
    buffer_load_dwordx4 v[60:63], v6, s[16:19], s71 offen offset:2048 sc1
    s_add_u32 s64, s3, 0x906000
    buffer_load_dwordx4 v[64:67], v6, s[16:19], s64 offen offset:0 sc1
    buffer_load_dwordx4 v[68:71], v6, s[16:19], s64 offen offset:2048 sc1
    s_add_u32 s65, s3, 0x907000
    buffer_load_dwordx4 v[72:75], v6, s[16:19], s65 offen offset:0 sc1
    buffer_load_dwordx4 v[76:79], v6, s[16:19], s65 offen offset:2048 sc1
    s_add_u32 s30, s72, 3
    v_mov_b32 v4, s30
    v_mov_b32 v5, s73
    s_waitcnt vmcnt(16)
    s_mov_b64 exec, 1
    s_cmp_eq_u32 s97, 1
    s_cbranch_scc0 slow5
    buffer_store_dwordx2 v[4:5], v1, s[16:19], s0 offen
back5:
    s_mov_b64 exec, -1
    s_branch oaJ0
oaB0:
    s_add_u32 s30, s72, 3
    v_mov_b32 v4, s30
    v_mov_b32 v5, s73
    s_waitcnt vmcnt(0)
    s_mov_b64 exec, 1
    s_cmp_eq_u32 s97, 1
    s_cbranch_scc0 slow6
    buffer_store_dwordx2 v[4:5], v1, s[16:19], s0 offen
back6:
    s_mov_b64 exec, -1
oaJ0:
    v_bfe_u32 v244, v1, 2, 3
    v_lshl_add_u32 v244, v241, 4, v244
    v_lshlrev_b32 v244, 7, v244
    v_bfe_u32 v245, v1, 3, 2
    v_lshl_add_u32 v244, v245, 5, v244
    v_and_b32 v245, 3, v1
    v_lshl_add_u32 v244, v245, 3, v244
    v_add_u32 v232, 65536, v244
    v_xor_b32 v233, 32, v232
    v_xor_b32 v234, 64, v232
    v_xor_b32 v235, 96, v232
    s_lshl_b32 s31, s11, 11
    s_add_u32 s31, s31, s82
    v_lshrrev_b32 v244, 2, v240
    v_sub_u32 v244, 0, v244
    v_xor_b32 v244, v244, v241
    v_and_b32 v244, 3, v244
    v_lshl_add_u32 v244, v240, 2, v244
    v_lshlrev_b32 v244, 4, v244
    v_lshl_add_u32 v244, v242, 3, v244
    v_add_u32 v244, s31, v244
    v_xor_b32 v245, 32, v244
    ds_read_b64 v[224:225], v244 offset:0
    ds_read_b64 v[226:227], v245 offset:0
    ds_read_b64 v[228:229], v244 offset:1024
    ds_read_b64 v[230:231], v245 offset:1024
    ds_read_b64_tr_b16 v[96:97], v232 offset:0
    ds_read_b64_tr_b16 v[98:99], v232 offset:1024
    ds_read_b64_tr_b16 v[100:101], v233 offset:0
    ds_read_b64_tr_b16 v[102:103], v233 offset:1024
    ds_read_b64_tr_b16 v[104:105], v234 offset:0
    ds_read_b64_tr_b16 v[106:107], v234 offset:1024
    ds_read_b64_tr_b16 v[108:109], v235 offset:0
    ds_read_b64_tr_b16 v[110:111], v235 offset:1024
    ds_read_b64_tr_b16 v[112:113], v232 offset:4096
    ds_read_b64_tr_b16 v[114:115], v232 offset:5120
    ds_read_b64_tr_b16 v[116:117], v233 offset:4096
    ds_read_b64_tr_b16 v[118:119], v233 offset:5120
    v_lshl_add_u32 v246, v242, 1, v241
    v_lshl_add_u32 v246, v246, 4, v240
    v_lshlrev_b32 v246, 4, v246
    v_add_u32 v250, s82, v246
    s_lshl_b32 s31, s12, 10
    v_add_u32 v251, s31, v2
    s_waitcnt lgkmcnt(12)
    v_lshlrev_b32 v80, 16, v224
    v_and_b32 v81, 0xffff0000, v224
    v_lshlrev_b32 v82, 16, v225
    v_and_b32 v83, 0xffff0000, v225
    v_lshlrev_b32 v84, 16, v226
    v_and_b32 v85, 0xffff0000, v226
    v_lshlrev_b32 v86, 16, v227
    v_and_b32 v87, 0xffff0000, v227
    v_lshlrev_b32 v88, 16, v228
    v_and_b32 v89, 0xffff0000, v228
    v_lshlrev_b32 v90, 16, v229
    v_and_b32 v91, 0xffff0000, v229
    v_lshlrev_b32 v92, 16, v230
    v_and_b32 v93, 0xffff0000, v230
    v_lshlrev_b32 v94, 16, v231
    v_and_b32 v95, 0xffff0000, v231
    ds_read_b64_tr_b16 v[120:121], v234 offset:4096
    ds_read_b64_tr_b16 v[122:123], v234 offset:5120
    ds_read_b64_tr_b16 v[124:125], v235 offset:4096
    ds_read_b64_tr_b16 v[126:127], v235 offset:5120
    ds_read_b64_tr_b16 v[128:129], v232 offset:8192
    ds_read_b64_tr_b16 v[130:131], v232 offset:9216
    ds_read_b64_tr_b16 v[132:133], v233 offset:8192
    ds_read_b64_tr_b16 v[134:135], v233 offset:9216
    ds_read_b64_tr_b16 v[136:137], v234 offset:8192
    ds_read_b64_tr_b16 v[138:139], v234 offset:9216
    ds_read_b64_tr_b16 v[140:141], v235 offset:8192
    ds_read_b64_tr_b16 v[142:143], v235 offset:9216
    ds_read_b64_tr_b16 v[144:145], v232 offset:12288
    ds_read_b64_tr_b16 v[146:147], v232 offset:13312
    ds_read_b64_tr_b16 v[148:149], v233 offset:12288
    ds_read_b64_tr_b16 v[150:151], v233 offset:13312
    ds_read_b64_tr_b16 v[152:153], v234 offset:12288
    ds_read_b64_tr_b16 v[154:155], v234 offset:13312
    ds_read_b64_tr_b16 v[156:157], v235 offset:12288
    ds_read_b64_tr_b16 v[158:159], v235 offset:13312
    s_cmp_eq_u32 s1, 1
    s_cbranch_scc1 oaG0
    s_mov_b32 exec_lo, 0xffffffff
    s_mov_b32 exec_hi, 0x0
    s_mov_b32 s30, 0
poll7:
    buffer_load_dwordx2 v[4:5], v253, s[16:19], 0 offen sc1
poll7_c:
    s_waitcnt vmcnt(0)
poll7_l:
    s_add_u32 s30, s30, 1
    v_subrev_u32 v4, s72, v4
    v_cmp_eq_u32 s[74:75], s73, v5
    v_cmp_gt_u32 s[76:77], 32, v4
    v_cmp_le_u32 vcc, s28, v4
    s_and_b64 s[74:75], s[74:75], s[76:77]
    s_and_b64 vcc, vcc, s[74:75]
    s_cmp_eq_u64 vcc, exec
    s_cbranch_scc1 poll7_x
    s_cmp_gt_u32 s30, 0x8000
    s_cbranch_scc0 poll7
poll7_x:
    s_mov_b64 exec, -1
    s_add_u32 s66, s3, 0x900000
    buffer_load_dwordx4 v[16:19], v6, s[16:19], s66 offen offset:0 sc1
    buffer_load_dwordx4 v[20:23], v6, s[16:19], s66 offen offset:2048 sc1
    s_add_u32 s67, s3, 0x901000
    buffer_load_dwordx4 v[24:27], v6, s[16:19], s67 offen offset:0 sc1
    buffer_load_dwordx4 v[28:31], v6, s[16:19], s67 offen offset:2048 sc1
    s_add_u32 s68, s3, 0x902000
    buffer_load_dwordx4 v[32:35], v6, s[16:19], s68 offen offset:0 sc1
    buffer_load_dwordx4 v[36:39], v6, s[16:19], s68 offen offset:2048 sc1
    s_add_u32 s69, s3, 0x903000
    buffer_load_dwordx4 v[40:43], v6, s[16:19], s69 offen offset:0 sc1
    buffer_load_dwordx4 v[44:47], v6, s[16:19], s69 offen offset:2048 sc1
    s_add_u32 s70, s3, 0x904000
    buffer_load_dwordx4 v[48:51], v6, s[16:19], s70 offen offset:0 sc1
    buffer_load_dwordx4 v[52:55], v6, s[16:19], s70 offen offset:2048 sc1
    s_add_u32 s71, s3, 0x905000
    buffer_load_dwordx4 v[56:59], v6, s[16:19], s71 offen offset:0 sc1
    buffer_load_dwordx4 v[60:63], v6, s[16:19], s71 offen offset:2048 sc1
    s_add_u32 s64, s3, 0x906000
    buffer_load_dwordx4 v[64:67], v6, s[16:19], s64 offen offset:0 sc1
    buffer_load_dwordx4 v[68:71], v6, s[16:19], s64 offen offset:2048 sc1
    s_add_u32 s65, s3, 0x907000
    buffer_load_dwordx4 v[72:75], v6, s[16:19], s65 offen offset:0 sc1
    buffer_load_dwordx4 v[76:79], v6, s[16:19], s65 offen offset:2048 sc1
oaG0:
    s_waitcnt vmcnt(15)
    v_mfma_f32_16x16x32_bf16 v[80:83], v[96:99], v[16:19], v[80:83]
    ds_read_b64_tr_b16 v[160:161], v232 offset:16384
    ds_read_b64_tr_b16 v[162:163], v232 offset:17408
    v_mfma_f32_16x16x32_bf16 v[84:87], v[100:103], v[16:19], v[84:87]
    ds_read_b64_tr_b16 v[164:165], v233 offset:16384
    ds_read_b64_tr_b16 v[166:167], v233 offset:17408
    v_mfma_f32_16x16x32_bf16 v[88:91], v[104:107], v[16:19], v[88:91]
    ds_read_b64_tr_b16 v[168:169], v234 offset:16384
    ds_read_b64_tr_b16 v[170:171], v234 offset:17408
    v_mfma_f32_16x16x32_bf16 v[92:95], v[108:111], v[16:19], v[92:95]
    ds_read_b64_tr_b16 v[172:173], v235 offset:16384
    ds_read_b64_tr_b16 v[174:175], v235 offset:17408
    s_waitcnt vmcnt(14)
    v_mfma_f32_16x16x32_bf16 v[80:83], v[112:115], v[20:23], v[80:83]
    ds_read_b64_tr_b16 v[176:177], v232 offset:20480
    ds_read_b64_tr_b16 v[178:179], v232 offset:21504
    v_mfma_f32_16x16x32_bf16 v[84:87], v[116:119], v[20:23], v[84:87]
    ds_read_b64_tr_b16 v[180:181], v233 offset:20480
    ds_read_b64_tr_b16 v[182:183], v233 offset:21504
    v_mfma_f32_16x16x32_bf16 v[88:91], v[120:123], v[20:23], v[88:91]
    ds_read_b64_tr_b16 v[184:185], v234 offset:20480
    ds_read_b64_tr_b16 v[186:187], v234 offset:21504
    v_mfma_f32_16x16x32_bf16 v[92:95], v[124:127], v[20:23], v[92:95]
    ds_read_b64_tr_b16 v[188:189], v235 offset:20480
    ds_read_b64_tr_b16 v[190:191], v235 offset:21504
    s_waitcnt vmcnt(13)
    v_mfma_f32_16x16x32_bf16 v[80:83], v[128:131], v[24:27], v[80:83]
    ds_read_b64_tr_b16 v[192:193], v232 offset:24576
    ds_read_b64_tr_b16 v[194:195], v232 offset:25600
    v_mfma_f32_16x16x32_bf16 v[84:87], v[132:135], v[24:27], v[84:87]
    ds_read_b64_tr_b16 v[196:197], v233 offset:24576
    ds_read_b64_tr_b16 v[198:199], v233 offset:25600
    v_mfma_f32_16x16x32_bf16 v[88:91], v[136:139], v[24:27], v[88:91]
    ds_read_b64_tr_b16 v[200:201], v234 offset:24576
    ds_read_b64_tr_b16 v[202:203], v234 offset:25600
    v_mfma_f32_16x16x32_bf16 v[92:95], v[140:143], v[24:27], v[92:95]
    ds_read_b64_tr_b16 v[204:205], v235 offset:24576
    ds_read_b64_tr_b16 v[206:207], v235 offset:25600
    s_waitcnt vmcnt(12)
    v_mfma_f32_16x16x32_bf16 v[80:83], v[144:147], v[28:31], v[80:83]
    ds_read_b64_tr_b16 v[208:209], v232 offset:28672
    ds_read_b64_tr_b16 v[210:211], v232 offset:29696
    v_mfma_f32_16x16x32_bf16 v[84:87], v[148:151], v[28:31], v[84:87]
    ds_read_b64_tr_b16 v[212:213], v233 offset:28672
    ds_read_b64_tr_b16 v[214:215], v233 offset:29696
    v_mfma_f32_16x16x32_bf16 v[88:91], v[152:155], v[28:31], v[88:91]
    ds_read_b64_tr_b16 v[216:217], v234 offset:28672
    ds_read_b64_tr_b16 v[218:219], v234 offset:29696
    v_mfma_f32_16x16x32_bf16 v[92:95], v[156:159], v[28:31], v[92:95]
    ds_read_b64_tr_b16 v[220:221], v235 offset:28672
    ds_read_b64_tr_b16 v[222:223], v235 offset:29696
    s_waitcnt vmcnt(11)
    v_mfma_f32_16x16x32_bf16 v[80:83], v[160:163], v[32:35], v[80:83]
    ds_read_b64_tr_b16 v[96:97], v232 offset:32768
    ds_read_b64_tr_b16 v[98:99], v232 offset:33792
    v_mfma_f32_16x16x32_bf16 v[84:87], v[164:167], v[32:35], v[84:87]
    ds_read_b64_tr_b16 v[100:101], v233 offset:32768
    ds_read_b64_tr_b16 v[102:103], v233 offset:33792
    v_mfma_f32_16x16x32_bf16 v[88:91], v[168:171], v[32:35], v[88:91]
    ds_read_b64_tr_b16 v[104:105], v234 offset:32768
    ds_read_b64_tr_b16 v[106:107], v234 offset:33792
    v_mfma_f32_16x16x32_bf16 v[92:95], v[172:175], v[32:35], v[92:95]
    ds_read_b64_tr_b16 v[108:109], v235 offset:32768
    ds_read_b64_tr_b16 v[110:111], v235 offset:33792
    s_waitcnt vmcnt(10)
    v_mfma_f32_16x16x32_bf16 v[80:83], v[176:179], v[36:39], v[80:83]
    ds_read_b64_tr_b16 v[112:113], v232 offset:36864
    ds_read_b64_tr_b16 v[114:115], v232 offset:37888
    v_mfma_f32_16x16x32_bf16 v[84:87], v[180:183], v[36:39], v[84:87]
    ds_read_b64_tr_b16 v[116:117], v233 offset:36864
    ds_read_b64_tr_b16 v[118:119], v233 offset:37888
    v_mfma_f32_16x16x32_bf16 v[88:91], v[184:187], v[36:39], v[88:91]
    ds_read_b64_tr_b16 v[120:121], v234 offset:36864
    ds_read_b64_tr_b16 v[122:123], v234 offset:37888
    v_mfma_f32_16x16x32_bf16 v[92:95], v[188:191], v[36:39], v[92:95]
    ds_read_b64_tr_b16 v[124:125], v235 offset:36864
    ds_read_b64_tr_b16 v[126:127], v235 offset:37888
    s_waitcnt vmcnt(9)
    v_mfma_f32_16x16x32_bf16 v[80:83], v[192:195], v[40:43], v[80:83]
    ds_read_b64_tr_b16 v[128:129], v232 offset:40960
    ds_read_b64_tr_b16 v[130:131], v232 offset:41984
    v_mfma_f32_16x16x32_bf16 v[84:87], v[196:199], v[40:43], v[84:87]
    ds_read_b64_tr_b16 v[132:133], v233 offset:40960
    ds_read_b64_tr_b16 v[134:135], v233 offset:41984
    v_mfma_f32_16x16x32_bf16 v[88:91], v[200:203], v[40:43], v[88:91]
    ds_read_b64_tr_b16 v[136:137], v234 offset:40960
    ds_read_b64_tr_b16 v[138:139], v234 offset:41984
    v_mfma_f32_16x16x32_bf16 v[92:95], v[204:207], v[40:43], v[92:95]
    ds_read_b64_tr_b16 v[140:141], v235 offset:40960
    ds_read_b64_tr_b16 v[142:143], v235 offset:41984
    s_waitcnt vmcnt(8)
    v_mfma_f32_16x16x32_bf16 v[80:83], v[208:211], v[44:47], v[80:83]
    ds_read_b64_tr_b16 v[144:145], v232 offset:45056
    ds_read_b64_tr_b16 v[146:147], v232 offset:46080
    v_mfma_f32_16x16x32_bf16 v[84:87], v[212:215], v[44:47], v[84:87]
    ds_read_b64_tr_b16 v[148:149], v233 offset:45056
    ds_read_b64_tr_b16 v[150:151], v233 offset:46080
    v_mfma_f32_16x16x32_bf16 v[88:91], v[216:219], v[44:47], v[88:91]
    ds_read_b64_tr_b16 v[152:153], v234 offset:45056
    ds_read_b64_tr_b16 v[154:155], v234 offset:46080
    v_mfma_f32_16x16x32_bf16 v[92:95], v[220:223], v[44:47], v[92:95]
    ds_read_b64_tr_b16 v[156:157], v235 offset:45056
    ds_read_b64_tr_b16 v[158:159], v235 offset:46080
    s_waitcnt vmcnt(7)
    v_mfma_f32_16x16x32_bf16 v[80:83], v[96:99], v[48:51], v[80:83]
    ds_read_b64_tr_b16 v[160:161], v232 offset:49152
    ds_read_b64_tr_b16 v[162:163], v232 offset:50176
    v_mfma_f32_16x16x32_bf16 v[84:87], v[100:103], v[48:51], v[84:87]
    ds_read_b64_tr_b16 v[164:165], v233 offset:49152
    ds_read_b64_tr_b16 v[166:167], v233 offset:50176
    v_mfma_f32_16x16x32_bf16 v[88:91], v[104:107], v[48:51], v[88:91]
    ds_read_b64_tr_b16 v[168:169], v234 offset:49152
    ds_read_b64_tr_b16 v[170:171], v234 offset:50176
    v_mfma_f32_16x16x32_bf16 v[92:95], v[108:111], v[48:51], v[92:95]
    ds_read_b64_tr_b16 v[172:173], v235 offset:49152
    ds_read_b64_tr_b16 v[174:175], v235 offset:50176
    s_waitcnt vmcnt(6)
    v_mfma_f32_16x16x32_bf16 v[80:83], v[112:115], v[52:55], v[80:83]
    ds_read_b64_tr_b16 v[176:177], v232 offset:53248
    ds_read_b64_tr_b16 v[178:179], v232 offset:54272
    v_mfma_f32_16x16x32_bf16 v[84:87], v[116:119], v[52:55], v[84:87]
    ds_read_b64_tr_b16 v[180:181], v233 offset:53248
    ds_read_b64_tr_b16 v[182:183], v233 offset:54272
    v_mfma_f32_16x16x32_bf16 v[88:91], v[120:123], v[52:55], v[88:91]
    ds_read_b64_tr_b16 v[184:185], v234 offset:53248
    ds_read_b64_tr_b16 v[186:187], v234 offset:54272
    v_mfma_f32_16x16x32_bf16 v[92:95], v[124:127], v[52:55], v[92:95]
    ds_read_b64_tr_b16 v[188:189], v235 offset:53248
    ds_read_b64_tr_b16 v[190:191], v235 offset:54272
    s_waitcnt vmcnt(5)
    v_mfma_f32_16x16x32_bf16 v[80:83], v[128:131], v[56:59], v[80:83]
    ds_read_b64_tr_b16 v[192:193], v232 offset:57344
    ds_read_b64_tr_b16 v[194:195], v232 offset:58368
    v_mfma_f32_16x16x32_bf16 v[84:87], v[132:135], v[56:59], v[84:87]
    ds_read_b64_tr_b16 v[196:197], v233 offset:57344
    ds_read_b64_tr_b16 v[198:199], v233 offset:58368
    v_mfma_f32_16x16x32_bf16 v[88:91], v[136:139], v[56:59], v[88:91]
    ds_read_b64_tr_b16 v[200:201], v234 offset:57344
    ds_read_b64_tr_b16 v[202:203], v234 offset:58368
    v_mfma_f32_16x16x32_bf16 v[92:95], v[140:143], v[56:59], v[92:95]
    ds_read_b64_tr_b16 v[204:205], v235 offset:57344
    ds_read_b64_tr_b16 v[206:207], v235 offset:58368
    s_waitcnt vmcnt(4)
    v_mfma_f32_16x16x32_bf16 v[80:83], v[144:147], v[60:63], v[80:83]
    ds_read_b64_tr_b16 v[208:209], v232 offset:61440
    ds_read_b64_tr_b16 v[210:211], v232 offset:62464
    v_mfma_f32_16x16x32_bf16 v[84:87], v[148:151], v[60:63], v[84:87]
    ds_read_b64_tr_b16 v[212:213], v233 offset:61440
    ds_read_b64_tr_b16 v[214:215], v233 offset:62464
    v_mfma_f32_16x16x32_bf16 v[88:91], v[152:155], v[60:63], v[88:91]
    ds_read_b64_tr_b16 v[216:217], v234 offset:61440
    ds_read_b64_tr_b16 v[218:219], v234 offset:62464
    v_mfma_f32_16x16x32_bf16 v[92:95], v[156:159], v[60:63], v[92:95]
    ds_read_b64_tr_b16 v[220:221], v235 offset:61440
    ds_read_b64_tr_b16 v[222:223], v235 offset:62464
    s_waitcnt vmcnt(3)
    v_mfma_f32_16x16x32_bf16 v[80:83], v[160:163], v[64:67], v[80:83]
    v_mfma_f32_16x16x32_bf16 v[84:87], v[164:167], v[64:67], v[84:87]
    v_mfma_f32_16x16x32_bf16 v[88:91], v[168:171], v[64:67], v[88:91]
    v_mfma_f32_16x16x32_bf16 v[92:95], v[172:175], v[64:67], v[92:95]
    s_waitcnt vmcnt(2)
    v_mfma_f32_16x16x32_bf16 v[80:83], v[176:179], v[68:71], v[80:83]
    v_mfma_f32_16x16x32_bf16 v[84:87], v[180:183], v[68:71], v[84:87]
    v_mfma_f32_16x16x32_bf16 v[88:91], v[184:187], v[68:71], v[88:91]
    v_mfma_f32_16x16x32_bf16 v[92:95], v[188:191], v[68:71], v[92:95]
    s_waitcnt vmcnt(1) lgkmcnt(8)
    v_mfma_f32_16x16x32_bf16 v[80:83], v[192:195], v[72:75], v[80:83]
    v_mfma_f32_16x16x32_bf16 v[84:87], v[196:199], v[72:75], v[84:87]
    v_mfma_f32_16x16x32_bf16 v[88:91], v[200:203], v[72:75], v[88:91]
    v_mfma_f32_16x16x32_bf16 v[92:95], v[204:207], v[72:75], v[92:95]
    s_waitcnt vmcnt(0) lgkmcnt(0)
    v_mfma_f32_16x16x32_bf16 v[80:83], v[208:211], v[76:79], v[80:83]
    v_mfma_f32_16x16x32_bf16 v[84:87], v[212:215], v[76:79], v[84:87]
    v_mfma_f32_16x16x32_bf16 v[88:91], v[216:219], v[76:79], v[88:91]
    v_mfma_f32_16x16x32_bf16 v[92:95], v[220:223], v[76:79], v[92:95]
    s_add_u32 s66, s91, 0x0
    s_add_u32 s67, s95, 0xd00000
    s_nop 2
    v_cvt_pk_bf16_f32 v240, v80, v81
    v_cvt_pk_bf16_f32 v241, v82, v83
    v_cvt_pk_bf16_f32 v242, v84, v85
    v_cvt_pk_bf16_f32 v243, v86, v87
    v_cvt_pk_bf16_f32 v244, v88, v89
    v_cvt_pk_bf16_f32 v245, v90, v91
    v_cvt_pk_bf16_f32 v246, v92, v93
    v_cvt_pk_bf16_f32 v247, v94, v95
    v_permlane16_swap_b32 v240, v242
    v_permlane16_swap_b32 v241, v243
    v_permlane16_swap_b32 v244, v246
    v_permlane16_swap_b32 v245, v247
    buffer_store_dwordx4 v[240:243], v250, s[24:27], s66 offen offset:0 sc1
    buffer_store_dwordx4 v[244:247], v250, s[24:27], s66 offen offset:1024 sc1
    v_pk_mul_f32 v[16:17], v[80:81], v[80:81]
    v_pk_add_f32 v[20:21], v[80:81], v[82:83]
    v_pk_fma_f32 v[16:17], v[82:83], v[82:83], v[16:17]
    v_pk_fma_f32 v[16:17], v[84:85], v[84:85], v[16:17]
    v_pk_add_f32 v[20:21], v[20:21], v[84:85]
    v_pk_fma_f32 v[16:17], v[86:87], v[86:87], v[16:17]
    v_pk_add_f32 v[20:21], v[20:21], v[86:87]
    v_pk_fma_f32 v[16:17], v[88:89], v[88:89], v[16:17]
    v_pk_add_f32 v[20:21], v[20:21], v[88:89]
    v_pk_fma_f32 v[16:17], v[90:91], v[90:91], v[16:17]
    v_pk_add_f32 v[20:21], v[20:21], v[90:91]
    v_pk_fma_f32 v[16:17], v[92:93], v[92:93], v[16:17]
    v_pk_add_f32 v[20:21], v[20:21], v[92:93]
    v_pk_fma_f32 v[16:17], v[94:95], v[94:95], v[16:17]
    v_pk_add_f32 v[20:21], v[20:21], v[94:95]
    v_add_f32 v18, v20, v21
    v_add_f32 v19, v16, v17
    s_cmp_eq_u32 s97, 1
    s_cbranch_scc0 slow8
    buffer_store_dwordx2 v[18:19], v251, s[16:19], s67 offen
back8:
    s_add_u32 s30, s72, 4
    v_mov_b32 v4, s30
    v_mov_b32 v5, s73
    s_waitcnt vmcnt(0)
    s_mov_b64 exec, 1
    s_cmp_eq_u32 s97, 1
    s_cbranch_scc0 slow9
    buffer_store_dwordx2 v[4:5], v1, s[16:19], s0 offen
back9:
    s_mov_b64 exec, -1
    s_lshl_b32 s31, s11, 14
    s_add_u32 s31, s31, 0x400000
    v_lshlrev_b32 v6, 7, v1
    v_add_u32 v6, s31, v6
    s_mov_b32 exec_lo, 0xffffffff
    s_mov_b32 exec_hi, 0xffff
    buffer_load_dwordx2 v[4:5], v6, s[16:19], 0 offen sc1
    s_mov_b64 exec, -1
    v_mov_b32 v136, 0x3f803f80
    v_mov_b32 v137, v136
    v_mov_b32 v138, v136
    v_mov_b32 v139, v136
    s_nop 1
    v_mfma_f32_16x16x32_bf16 v[224:227], v[136:139], a[0:3], 0
    v_mfma_f32_16x16x32_bf16 v[228:231], v[136:139], a[4:7], 0
    v_mfma_f32_16x16x32_bf16 v[224:227], v[136:139], a[8:11], v[224:227]
    v_mfma_f32_16x16x32_bf16 v[228:231], v[136:139], a[12:15], v[228:231]
    v_mfma_f32_16x16x32_bf16 v[224:227], v[136:139], a[16:19], v[224:227]
    v_mfma_f32_16x16x32_bf16 v[228:231], v[136:139], a[20:23], v[228:231]
    v_mfma_f32_16x16x32_bf16 v[224:227], v[136:139], a[24:27], v[224:227]
    v_mfma_f32_16x16x32_bf16 v[228:231], v[136:139], a[28:31], v[228:231]
    v_mfma_f32_16x16x32_bf16 v[224:227], v[136:139], a[32:35], v[224:227]
    v_mfma_f32_16x16x32_bf16 v[228:231], v[136:139], a[36:39], v[228:231]
    v_mfma_f32_16x16x32_bf16 v[224:227], v[136:139], a[40:43], v[224:227]
    v_mfma_f32_16x16x32_bf16 v[228:231], v[136:139], a[44:47], v[228:231]
    v_mfma_f32_16x16x32_bf16 v[224:227], v[136:139], a[48:51], v[224:227]
    v_mfma_f32_16x16x32_bf16 v[228:231], v[136:139], a[52:55], v[228:231]
    v_mfma_f32_16x16x32_bf16 v[224:227], v[136:139], a[56:59], v[224:227]
    v_mfma_f32_16x16x32_bf16 v[228:231], v[136:139], a[60:63], v[228:231]
    v_mfma_f32_16x16x32_bf16 v[224:227], v[136:139], a[64:67], v[224:227]
    v_mfma_f32_16x16x32_bf16 v[228:231], v[136:139], a[68:71], v[228:231]
    v_mfma_f32_16x16x32_bf16 v[224:227], v[136:139], a[72:75], v[224:227]
    v_mfma_f32_16x16x32_bf16 v[228:231], v[136:139], a[76:79], v[228:231]
    v_mfma_f32_16x16x32_bf16 v[224:227], v[136:139], a[80:83], v[224:227]
    v_mfma_f32_16x16x32_bf16 v[228:231], v[136:139], a[84:87], v[228:231]
    v_mfma_f32_16x16x32_bf16 v[224:227], v[136:139], a[88:91], v[224:227]
    v_mfma_f32_16x16x32_bf16 v[228:231], v[136:139], a[92:95], v[228:231]
    v_mfma_f32_16x16x32_bf16 v[224:227], v[136:139], a[96:99], v[224:227]
    v_mfma_f32_16x16x32_bf16 v[228:231], v[136:139], a[100:103], v[228:231]
    v_mfma_f32_16x16x32_bf16 v[224:227], v[136:139], a[104:107], v[224:227]
    v_mfma_f32_16x16x32_bf16 v[228:231], v[136:139], a[108:111], v[228:231]
    v_mfma_f32_16x16x32_bf16 v[224:227], v[136:139], a[112:115], v[224:227]
    v_mfma_f32_16x16x32_bf16 v[228:231], v[136:139], a[116:119], v[228:231]
    v_mfma_f32_16x16x32_bf16 v[224:227], v[136:139], a[120:123], v[224:227]
    v_mfma_f32_16x16x32_bf16 v[228:231], v[136:139], a[124:127], v[228:231]
    s_mov_b32 exec_lo, 0xffffffff
    s_mov_b32 exec_hi, 0xffff
    s_mov_b32 s30, 0
    s_branch poll10_c
poll10:
    buffer_load_dwordx2 v[4:5], v6, s[16:19], 0 offen sc1
poll10_c:
    s_waitcnt vmcnt(0)
poll10_l:
    s_add_u32 s30, s30, 1
    v_subrev_u32 v4, s72, v4
    v_cmp_eq_u32 s[74:75], s73, v5
    v_cmp_gt_u32 s[76:77], 32, v4
    v_cmp_le_u32 vcc, 2, v4
    s_and_b64 s[74:75], s[74:75], s[76:77]
    s_and_b64 vcc, vcc, s[74:75]
    s_cmp_eq_u64 vcc, exec
    s_cbranch_scc1 poll10_x
    s_cmp_gt_u32 s30, 0x8000
    s_cbranch_scc0 poll10
poll10_x:
    s_mov_b64 exec, -1
    v_lshlrev_b32 v6, 5, v1
    s_lshl_b32 s31, s10, 8
    s_add_u32 s31, s31, 0x440000
    s_cmp_ge_u32 s12, 2
    s_cbranch_scc1 qbS0
    s_lshl_b32 s30, s12, 3
    s_add_u32 s30, s30, s31
    v_add_u32 v6, s30, v6
    s_mov_b32 exec_lo, 0xff
    s_mov_b32 exec_hi, 0x0
    s_mov_b32 s30, 0
poll11:
    buffer_load_dwordx2 v[4:5], v6, s[16:19], 0 offen sc1
poll11_c:
    s_waitcnt vmcnt(0)
poll11_l:
    s_add_u32 s30, s30, 1
    v_subrev_u32 v4, s72, v4
    v_cmp_eq_u32 s[74:75], s73, v5
    v_cmp_gt_u32 s[76:77], 32, v4
    v_cmp_le_u32 vcc, 4, v4
    s_and_b64 s[74:75], s[74:75], s[76:77]
    s_and_b64 vcc, vcc, s[74:75]
    s_cmp_eq_u64 vcc, exec
    s_cbranch_scc1 poll11_x
    s_cmp_gt_u32 s30, 0x8000
    s_cbranch_scc0 poll11
poll11_x:
    s_mov_b64 exec, -1
    s_add_u32 m0, s82, 0
    s_add_u32 s86, s81, 0x0
    buffer_load_dwordx4 v2, s[24:27], s86 offen offset:0 sc1 lds
    buffer_load_dwordx4 v2, s[24:27], s86 offen offset:1024 sc1 lds
    buffer_load_dwordx4 v2, s[24:27], s86 offen offset:2048 sc1 lds
    buffer_load_dwordx4 v2, s[24:27], s86 offen offset:3072 sc1 lds
    s_add_u32 m0, s82, 4096
    s_add_u32 s86, s81, 0x1000
    buffer_load_dwordx4 v2, s[24:27], s86 offen offset:0 sc1 lds
    buffer_load_dwordx4 v2, s[24:27], s86 offen offset:1024 sc1 lds
    buffer_load_dwordx4 v2, s[24:27], s86 offen offset:2048 sc1 lds
    buffer_load_dwordx4 v2, s[24:27], s86 offen offset:3072 sc1 lds
    s_add_u32 m0, s82, 8192
    s_add_u32 s86, s81, 0x2000
    buffer_load_dwordx4 v2, s[24:27], s86 offen offset:0 sc1 lds
    buffer_load_dwordx4 v2, s[24:27], s86 offen offset:1024 sc1 lds
    buffer_load_dwordx4 v2, s[24:27], s86 offen offset:2048 sc1 lds
    buffer_load_dwordx4 v2, s[24:27], s86 offen offset:3072 sc1 lds
    s_add_u32 m0, s82, 12288
    s_add_u32 s86, s81, 0x3000
    buffer_load_dwordx4 v2, s[24:27], s86 offen offset:0 sc1 lds
    buffer_load_dwordx4 v2, s[24:27], s86 offen offset:1024 sc1 lds
    buffer_load_dwordx4 v2, s[24:27], s86 offen offset:2048 sc1 lds
    buffer_load_dwordx4 v2, s[24:27], s86 offen offset:3072 sc1 lds
    s_waitcnt vmcnt(8)
    s_branch qbT0
qbS0:
qbT0:
    s_and_b32 s30, s12, 1
    s_lshl_b32 s30, s30, 14
    s_lshr_b32 s28, s12, 1
    s_lshl_b32 s28, s28, 12
    s_add_u32 s28, s28, s30
    s_add_u32 s28, s28, 32768
    s_lshl_b32 s3, s10, 16
    s_add_u32 s3, s3, s28
    s_barrier
    ds_read_b128 v[16:19], v2 offset:0
    ds_read_b128 v[20:23], v2 offset:16384
    ds_read_b128 v[32:35], v2 offset:1024
    ds_read_b128 v[36:39], v2 offset:17408
    s_waitcnt lgkmcnt(2)
    v_mfma_f32_16x16x32_bf16 v[48:51], v[16:19], a[0:3], 0
    v_mfma_f32_16x16x32_bf16 v[64:67], v[16:19], a[4:7], 0
    ds_read_b128 v[16:19], v2 offset:2048
    v_mfma_f32_16x16x32_bf16 v[52:55], v[20:23], a[0:3], 0
    v_mfma_f32_16x16x32_bf16 v[68:71], v[20:23], a[4:7], 0
    ds_read_b128 v[20:23], v2 offset:18432
    s_mov_b32 exec_lo, 0xcccccccc
    s_mov_b32 exec_hi, 0x0
    buffer_load_dwordx2 v[4:5], v253, s[16:19], 0 offen sc1
    s_mov_b64 exec, -1
    s_waitcnt lgkmcnt(2)
    v_mfma_f32_16x16x32_bf16 v[48:51], v[32:35], a[8:11], v[48:51]
    v_mfma_f32_16x16x32_bf16 v[64:67], v[32:35], a[12:15], v[64:67]
    ds_read_b128 v[32:35], v2 offset:3072
    v_mfma_f32_16x16x32_bf16 v[52:55], v[36:39], a[8:11], v[52:55]
    v_mfma_f32_16x16x32_bf16 v[68:71], v[36:39], a[12:15], v[68:71]
    ds_read_b128 v[36:39], v2 offset:19456
    s_waitcnt lgkmcnt(2)
    v_mfma_f32_16x16x32_bf16 v[48:51], v[16:19], a[16:19], v[48:51]
    v_mfma_f32_16x16x32_bf16 v[64:67], v[16:19], a[20:23], v[64:67]
    ds_read_b128 v[16:19], v2 offset:4096
    v_mfma_f32_16x16x32_bf16 v[52:55], v[20:23], a[16:19], v[52:55]
    v_mfma_f32_16x16x32_bf16 v[68:71], v[20:23], a[20:23], v[68:71]
    ds_read_b128 v[20:23], v2 offset:20480
    s_waitcnt lgkmcnt(2)
    v_mfma_f32_16x16x32_bf16 v[48:51], v[32:35], a[24:27], v[48:51]
    v_mfma_f32_16x16x32_bf16 v[64:67], v[32:35], a[28:31], v[64:67]
    ds_read_b128 v[32:35], v2 offset:5120
    v_mfma_f32_16x16x32_bf16 v[52:55], v[36:39], a[24:27], v[52:55]
    v_mfma_f32_16x16x32_bf16 v[68:71], v[36:39], a[28:31], v[68:71]
    ds_read_b128 v[36:39], v2 offset:21504
    s_waitcnt lgkmcnt(2)
    v_mfma_f32_16x16x32_bf16 v[48:51], v[16:19], a[32:35], v[48:51]
    v_mfma_f32_16x16x32_bf16 v[64:67], v[16:19], a[36:39], v[64:67]
    ds_read_b128 v[16:19], v2 offset:6144
    v_mfma_f32_16x16x32_bf16 v[52:55], v[20:23], a[32:35], v[52:55]
    v_mfma_f32_16x16x32_bf16 v[68:71], v[20:23], a[36:39], v[68:71]
    ds_read_b128 v[20:23], v2 offset:22528
    s_waitcnt lgkmcnt(2)
    v_mfma_f32_16x16x32_bf16 v[48:51], v[32:35], a[40:43], v[48:51]
    v_mfma_f32_16x16x32_bf16 v[64:67], v[32:35], a[44:47], v[64:67]
    ds_read_b128 v[32:35], v2 offset:7168
    v_mfma_f32_16x16x32_bf16 v[52:55], v[36:39], a[40:43], v[52:55]
    v_mfma_f32_16x16x32_bf16 v[68:71], v[36:39], a[44:47], v[68:71]
    ds_read_b128 v[36:39], v2 offset:23552
    s_waitcnt vmcnt(0)
    s_barrier
    s_mov_b32 exec_lo, 0xcccccccc
    s_mov_b32 exec_hi, 0x0
    s_mov_b32 s30, 0
    s_branch poll12_l
poll12:
    buffer_load_dwordx2 v[4:5], v253, s[16:19], 0 offen sc1
poll12_c:
    s_waitcnt vmcnt(0)
poll12_l:
    s_add_u32 s30, s30, 1
    v_subrev_u32 v4, s72, v4
    v_cmp_eq_u32 s[74:75], s73, v5
    v_cmp_gt_u32 s[76:77], 32, v4
    v_cmp_le_u32 vcc, 4, v4
    s_and_b64 s[74:75], s[74:75], s[76:77]
    s_and_b64 vcc, vcc, s[74:75]
    s_cmp_eq_u64 vcc, exec
    s_cbranch_scc1 poll12_x
    s_cmp_gt_u32 s30, 0x8000
    s_cbranch_scc0 poll12
poll12_x:
    s_mov_b64 exec, -1
    s_waitcnt lgkmcnt(2)
    v_mfma_f32_16x16x32_bf16 v[48:51], v[16:19], a[48:51], v[48:51]
    s_add_u32 m0, s28, 0
    s_add_u32 s86, s3, 0x0
    buffer_load_dwordx4 v2, s[24:27], s86 offen offset:0 sc1 lds
    v_mfma_f32_16x16x32_bf16 v[64:67], v[16:19], a[52:55], v[64:67]
    ds_read_b128 v[16:19], v2 offset:8192
    v_mfma_f32_16x16x32_bf16 v[52:55], v[20:23], a[48:51], v[52:55]
    buffer_load_dwordx4 v2, s[24:27], s86 offen offset:1024 sc1 lds
    v_mfma_f32_16x16x32_bf16 v[68:71], v[20:23], a[52:55], v[68:71]
    ds_read_b128 v[20:23], v2 offset:24576
    s_waitcnt lgkmcnt(2)
    v_mfma_f32_16x16x32_bf16 v[48:51], v[32:35], a[56:59], v[48:51]
    buffer_load_dwordx4 v2, s[24:27], s86 offen offset:2048 sc1 lds
    v_mfma_f32_16x16x32_bf16 v[64:67], v[32:35], a[60:63], v[64:67]
    ds_read_b128 v[32:35], v2 offset:9216
    v_mfma_f32_16x16x32_bf16 v[52:55], v[36:39], a[56:59], v[52:55]
    buffer_load_dwordx4 v2, s[24:27], s86 offen offset:3072 sc1 lds
    v_mfma_f32_16x16x32_bf16 v[68:71], v[36:39], a[60:63], v[68:71]
    ds_read_b128 v[36:39], v2 offset:25600
    s_waitcnt lgkmcnt(2)
    v_mfma_f32_16x16x32_bf16 v[48:51], v[16:19], a[64:67], v[48:51]
    s_add_u32 m0, s28, 8192
    s_add_u32 s86, s3, 0x2000
    buffer_load_dwordx4 v2, s[24:27], s86 offen offset:0 sc1 lds
    v_mfma_f32_16x16x32_bf16 v[64:67], v[16:19], a[68:71], v[64:67]
    ds_read_b128 v[16:19], v2 offset:10240
    v_mfma_f32_16x16x32_bf16 v[52:55], v[20:23], a[64:67], v[52:55]
    v_mfma_f32_16x16x32_bf16 v[68:71], v[20:23], a[68:71], v[68:71]
    ds_read_b128 v[20:23], v2 offset:26624
    s_waitcnt lgkmcnt(2)
    v_mfma_f32_16x16x32_bf16 v[48:51], v[32:35], a[72:75], v[48:51]
    buffer_load_dwordx4 v2, s[24:27], s86 offen offset:1024 sc1 lds
    v_mfma_f32_16x16x32_bf16 v[64:67], v[32:35], a[76:79], v[64:67]
    ds_read_b128 v[144:147], v2 offset:11264
    v_mfma_f32_16x16x32_bf16 v[52:55], v[36:39], a[72:75], v[52:55]
    v_mfma_f32_16x16x32_bf16 v[68:71], v[36:39], a[76:79], v[68:71]
    ds_read_b128 v[148:151], v2 offset:27648
    s_waitcnt lgkmcnt(2)
    v_mfma_f32_16x16x32_bf16 v[48:51], v[16:19], a[80:83], v[48:51]
    buffer_load_dwordx4 v2, s[24:27], s86 offen offset:2048 sc1 lds
    v_mfma_f32_16x16x32_bf16 v[64:67], v[16:19], a[84:87], v[64:67]
    ds_read_b128 v[160:163], v2 offset:12288
    v_mfma_f32_16x16x32_bf16 v[52:55], v[20:23], a[80:83], v[52:55]
    v_mfma_f32_16x16x32_bf16 v[68:71], v[20:23], a[84:87], v[68:71]
    ds_read_b128 v[164:167], v2 offset:28672
    s_waitcnt lgkmcnt(2)
    v_mfma_f32_16x16x32_bf16 v[48:51], v[144:147], a[88:91], v[48:51]
    buffer_load_dwordx4 v2, s[24:27], s86 offen offset:3072 sc1 lds
    v_mfma_f32_16x16x32_bf16 v[64:67], v[144:147], a[92:95], v[64:67]
    ds_read_b128 v[176:179], v2 offset:13312
    v_mfma_f32_16x16x32_bf16 v[52:55], v[148:151], a[88:91], v[52:55]
    s_add_u32 s88, s83, 0xd00000
    buffer_load_dwordx4 v[96:99], v2, s[16:19], s88 offen sc1
    v_mfma_f32_16x16x32_bf16 v[68:71], v[148:151], a[92:95], v[68:71]
    ds_read_b128 v[180:183], v2 offset:29696
    s_waitcnt lgkmcnt(2)
    v_mfma_f32_16x16x32_bf16 v[48:51], v[160:163], a[96:99], v[48:51]
    s_add_u32 s88, s83, 0xd01000
    buffer_load_dwordx4 v[100:103], v2, s[16:19], s88 offen sc1
    v_mfma_f32_16x16x32_bf16 v[64:67], v[160:163], a[100:103], v[64:67]
    ds_read_b128 v[192:195], v2 offset:14336
    v_mfma_f32_16x16x32_bf16 v[52:55], v[164:167], a[96:99], v[52:55]
    s_add_u32 s88, s83, 0xd02000
    buffer_load_dwordx4 v[104:107], v2, s[16:19], s88 offen sc1
    v_mfma_f32_16x16x32_bf16 v[68:71], v[164:167], a[100:103], v[68:71]
    ds_read_b128 v[196:199], v2 offset:30720
    s_waitcnt lgkmcnt(2)
    v_mfma_f32_16x16x32_bf16 v[48:51], v[176:179], a[104:107], v[48:51]
    s_add_u32 s88, s83, 0xd03000
    buffer_load_dwordx4 v[108:111], v2, s[16:19], s88 offen sc1
    v_mfma_f32_16x16x32_bf16 v[64:67], v[176:179], a[108:111], v[64:67]
    ds_read_b128 v[208:211], v2 offset:15360
    v_mfma_f32_16x16x32_bf16 v[52:55], v[180:183], a[104:107], v[52:55]
    v_mfma_f32_16x16x32_bf16 v[68:71], v[180:183], a[108:111], v[68:71]
    ds_read_b128 v[212:215], v2 offset:31744
    s_waitcnt lgkmcnt(2)
    v_mfma_f32_16x16x32_bf16 v[48:51], v[192:195], a[112:115], v[48:51]
    s_add_u32 s87, s80, 0x188000
    buffer_load_dwordx4 a[128:131], v2, s[16:19], s87 offen offset:0 sc1
    v_mfma_f32_16x16x32_bf16 v[64:67], v[192:195], a[116:119], v[64:67]
    v_mfma_f32_16x16x32_bf16 v[52:55], v[196:199], a[112:115], v[52:55]
    v_mfma_f32_16x16x32_bf16 v[68:71], v[196:199], a[116:119], v[68:71]
    s_waitcnt lgkmcnt(0)
    v_mfma_f32_16x16x32_bf16 v[48:51], v[208:211], a[120:123], v[48:51]
    buffer_load_dwordx4 a[132:135], v2, s[16:19], s87 offen offset:1024 sc1
    v_mfma_f32_16x16x32_bf16 v[64:67], v[208:211], a[124:127], v[64:67]
    v_mfma_f32_16x16x32_bf16 v[52:55], v[212:215], a[120:123], v[52:55]
    v_mfma_f32_16x16x32_bf16 v[68:71], v[212:215], a[124:127], v[68:71]
    s_waitcnt vmcnt(10)
    s_barrier
    ds_read_b128 v[24:27], v2 offset:32768
    ds_read_b128 v[28:31], v2 offset:49152
    ds_read_b128 v[40:43], v2 offset:33792
    ds_read_b128 v[44:47], v2 offset:50176
    s_waitcnt lgkmcnt(2)
    v_mfma_f32_16x16x32_bf16 v[56:59], v[24:27], a[0:3], 0
    buffer_load_dwordx4 a[136:139], v2, s[16:19], s87 offen offset:2048 sc1
    v_mfma_f32_16x16x32_bf16 v[72:75], v[24:27], a[4:7], 0
    ds_read_b128 v[24:27], v2 offset:34816
    v_mfma_f32_16x16x32_bf16 v[60:63], v[28:31], a[0:3], 0
    v_mfma_f32_16x16x32_bf16 v[76:79], v[28:31], a[4:7], 0
    ds_read_b128 v[28:31], v2 offset:51200
    s_waitcnt lgkmcnt(2)
    v_mfma_f32_16x16x32_bf16 v[56:59], v[40:43], a[8:11], v[56:59]
    buffer_load_dwordx4 a[140:143], v2, s[16:19], s87 offen offset:3072 sc1
    v_mfma_f32_16x16x32_bf16 v[72:75], v[40:43], a[12:15], v[72:75]
    ds_read_b128 v[40:43], v2 offset:35840
    v_mfma_f32_16x16x32_bf16 v[60:63], v[44:47], a[8:11], v[60:63]
    v_mfma_f32_16x16x32_bf16 v[76:79], v[44:47], a[12:15], v[76:79]
    ds_read_b128 v[44:47], v2 offset:52224
    s_waitcnt lgkmcnt(2)
    v_mfma_f32_16x16x32_bf16 v[56:59], v[24:27], a[16:19], v[56:59]
    s_add_u32 s87, s80, 0x189000
    buffer_load_dwordx4 a[144:147], v2, s[16:19], s87 offen offset:0 sc1
    v_mfma_f32_16x16x32_bf16 v[72:75], v[24:27], a[20:23], v[72:75]
    ds_read_b128 v[24:27], v2 offset:36864
    v_mfma_f32_16x16x32_bf16 v[60:63], v[28:31], a[16:19], v[60:63]
    v_mfma_f32_16x16x32_bf16 v[76:79], v[28:31], a[20:23], v[76:79]
    ds_read_b128 v[28:31], v2 offset:53248
    s_waitcnt vmcnt(5)
    s_waitcnt lgkmcnt(2)
    v_mfma_f32_16x16x32_bf16 v[56:59], v[40:43], a[24:27], v[56:59]
    buffer_load_dwordx4 a[148:151], v2, s[16:19], s87 offen offset:1024 sc1
    v_mfma_f32_16x16x32_bf16 v[72:75], v[40:43], a[28:31], v[72:75]
    ds_read_b128 v[40:43], v2 offset:37888
    v_add_f32 v96, v96, v98
    v_mfma_f32_16x16x32_bf16 v[60:63], v[44:47], a[24:27], v[60:63]
    v_add_f32 v97, v97, v99
    v_add_f32 v96, v96, v100
    v_mfma_f32_16x16x32_bf16 v[76:79], v[44:47], a[28:31], v[76:79]
    ds_read_b128 v[44:47], v2 offset:54272
    v_add_f32 v97, v97, v101
    s_waitcnt lgkmcnt(2)
    v_mfma_f32_16x16x32_bf16 v[56:59], v[24:27], a[32:35], v[56:59]
    buffer_load_dwordx4 a[152:155], v2, s[16:19], s87 offen offset:2048 sc1
    v_mfma_f32_16x16x32_bf16 v[72:75], v[24:27], a[36:39], v[72:75]
    ds_read_b128 v[24:27], v2 offset:38912
    v_add_f32 v96, v96, v102
    v_mfma_f32_16x16x32_bf16 v[60:63], v[28:31], a[32:35], v[60:63]
    v_add_f32 v97, v97, v103
    v_add_f32 v96, v96, v104
    v_mfma_f32_16x16x32_bf16 v[76:79], v[28:31], a[36:39], v[76:79]
    ds_read_b128 v[28:31], v2 offset:55296
    v_add_f32 v97, v97, v105
    s_waitcnt lgkmcnt(2)
    v_mfma_f32_16x16x32_bf16 v[56:59], v[40:43], a[40:43], v[56:59]
    buffer_load_dwordx4 a[156:159], v2, s[16:19], s87 offen offset:3072 sc1
    v_mfma_f32_16x16x32_bf16 v[72:75], v[40:43], a[44:47], v[72:75]
    ds_read_b128 v[40:43], v2 offset:39936
    v_add_f32 v96, v96, v106
    v_mfma_f32_16x16x32_bf16 v[60:63], v[44:47], a[40:43], v[60:63]
    v_add_f32 v97, v97, v107
    v_add_f32 v96, v96, v108
    v_mfma_f32_16x16x32_bf16 v[76:79], v[44:47], a[44:47], v[76:79]
    ds_read_b128 v[44:47], v2 offset:56320
    v_add_f32 v97, v97, v109
    s_barrier
    s_waitcnt lgkmcnt(2)
    v_mfma_f32_16x16x32_bf16 v[56:59], v[24:27], a[48:51], v[56:59]
    s_add_u32 s87, s80, 0x18a000
    buffer_load_dwordx4 a[160:163], v2, s[16:19], s87 offen offset:0 sc1
    v_mfma_f32_16x16x32_bf16 v[72:75], v[24:27], a[52:55], v[72:75]
    ds_read_b128 v[24:27], v2 offset:40960
    v_add_f32 v96, v96, v110
    v_mfma_f32_16x16x32_bf16 v[60:63], v[28:31], a[48:51], v[60:63]
    v_add_f32 v97, v97, v111
    v_mov_b32 v98, v96
    v_mfma_f32_16x16x32_bf16 v[76:79], v[28:31], a[52:55], v[76:79]
    ds_read_b128 v[28:31], v2 offset:57344
    v_mov_b32 v99, v97
    s_waitcnt lgkmcnt(2)
    v_mfma_f32_16x16x32_bf16 v[56:59], v[40:43], a[56:59], v[56:59]
    buffer_load_dwordx4 a[164:167], v2, s[16:19], s87 offen offset:1024 sc1
    v_mfma_f32_16x16x32_bf16 v[72:75], v[40:43], a[60:63], v[72:75]
    ds_read_b128 v[40:43], v2 offset:41984
    v_permlane16_swap_b32 v96, v98
    v_mfma_f32_16x16x32_bf16 v[60:63], v[44:47], a[56:59], v[60:63]
    v_permlane16_swap_b32 v97, v99
    v_add_f32 v96, v96, v98
    v_mfma_f32_16x16x32_bf16 v[76:79], v[44:47], a[60:63], v[76:79]
    ds_read_b128 v[44:47], v2 offset:58368
    v_add_f32 v97, v97, v99
    s_waitcnt lgkmcnt(2)
    v_mfma_f32_16x16x32_bf16 v[56:59], v[24:27], a[64:67], v[56:59]
    buffer_load_dwordx4 a[168:171], v2, s[16:19], s87 offen offset:2048 sc1
    v_mfma_f32_16x16x32_bf16 v[72:75], v[24:27], a[68:71], v[72:75]
    ds_read_b128 v[24:27], v2 offset:43008
    v_mov_b32 v98, v96
    v_mfma_f32_16x16x32_bf16 v[60:63], v[28:31], a[64:67], v[60:63]
    v_mov_b32 v99, v97
    v_permlane32_swap_b32 v96, v98
    v_mfma_f32_16x16x32_bf16 v[76:79], v[28:31], a[68:71], v[76:79]
    ds_read_b128 v[28:31], v2 offset:59392
    v_permlane32_swap_b32 v97, v99
    s_waitcnt lgkmcnt(2)
    v_mfma_f32_16x16x32_bf16 v[56:59], v[40:43], a[72:75], v[56:59]
    buffer_load_dwordx4 a[172:175], v2, s[16:19], s87 offen offset:3072 sc1
    v_mfma_f32_16x16x32_bf16 v[72:75], v[40:43], a[76:79], v[72:75]
    ds_read_b128 v[152:155], v2 offset:44032
    v_add_f32 v96, v96, v98
    v_mfma_f32_16x16x32_bf16 v[60:63], v[44:47], a[72:75], v[60:63]
    v_add_f32 v97, v97, v99
    v_mul_f32 v96, 0x3b000000, v96
    v_mfma_f32_16x16x32_bf16 v[76:79], v[44:47], a[76:79], v[76:79]
    ds_read_b128 v[156:159], v2 offset:60416
    v_mul_f32 v97, 0x3b000000, v97
    s_waitcnt lgkmcnt(2)
    v_mfma_f32_16x16x32_bf16 v[56:59], v[24:27], a[80:83], v[56:59]
    s_add_u32 s87, s80, 0x18b000
    buffer_load_dwordx4 a[176:179], v2, s[16:19], s87 offen offset:0 sc1
    v_mfma_f32_16x16x32_bf16 v[72:75], v[24:27], a[84:87], v[72:75]
    ds_read_b128 v[168:171], v2 offset:45056
    v_fma_f32 v97, -v96, v96, v97
    v_mfma_f32_16x16x32_bf16 v[60:63], v[28:31], a[80:83], v[60:63]
    v_max_f32 v97, 0, v97
    v_add_f32 v97, 0x3727c5ac, v97
    v_mfma_f32_16x16x32_bf16 v[76:79], v[28:31], a[84:87], v[76:79]
    ds_read_b128 v[172:175], v2 offset:61440
    v_rsq_f32 v97, v97
    v_lshrrev_b32 v98, 6, v0
    v_and_b32 v99, 15, v1
    v_lshl_add_u32 v98, v98, 4, v99
    v_lshlrev_b32 v98, 2, v98
    v_add_u32 v98, 161792, v98
    ds_write2_b32 v98, v97, v96 offset1:64
    s_waitcnt lgkmcnt(3)
    v_mfma_f32_16x16x32_bf16 v[56:59], v[152:155], a[88:91], v[56:59]
    buffer_load_dwordx4 a[180:183], v2, s[16:19], s87 offen offset:1024 sc1
    v_mfma_f32_16x16x32_bf16 v[72:75], v[152:155], a[92:95], v[72:75]
    ds_read_b128 v[184:187], v2 offset:46080
    v_mfma_f32_16x16x32_bf16 v[60:63], v[156:159], a[88:91], v[60:63]
    v_mfma_f32_16x16x32_bf16 v[76:79], v[156:159], a[92:95], v[76:79]
    ds_read_b128 v[188:191], v2 offset:62464
    s_waitcnt lgkmcnt(2)
    s_barrier
    v_mfma_f32_16x16x32_bf16 v[56:59], v[168:171], a[96:99], v[56:59]
    buffer_load_dwordx4 a[184:187], v2, s[16:19], s87 offen offset:2048 sc1
    v_mfma_f32_16x16x32_bf16 v[72:75], v[168:171], a[100:103], v[72:75]
    ds_read_b128 v[200:203], v2 offset:47104
    v_lshrrev_b32 v248, 4, v1
    v_mfma_f32_16x16x32_bf16 v[60:63], v[172:175], a[96:99], v[60:63]
    v_lshlrev_b32 v248, 4, v248
    v_add_u32 v248, 161792, v248
    v_mfma_f32_16x16x32_bf16 v[76:79], v[172:175], a[100:103], v[76:79]
    ds_read_b128 v[204:207], v2 offset:63488
    v_and_b32 v249, 15, v1
    s_waitcnt lgkmcnt(2)
    v_mfma_f32_16x16x32_bf16 v[56:59], v[184:187], a[104:107], v[56:59]
    buffer_load_dwordx4 a[188:191], v2, s[16:19], s87 offen offset:3072 sc1
    v_mfma_f32_16x16x32_bf16 v[72:75], v[184:187], a[108:111], v[72:75]
    ds_read_b128 v[216:219], v2 offset:48128
    v_lshlrev_b32 v249, 2, v249
    v_mfma_f32_16x16x32_bf16 v[60:63], v[188:191], a[104:107], v[60:63]
    v_add_u32 v249, 161792, v249
    ds_read2_b32 v[128:129], v249 offset0:0 offset1:64
    v_mfma_f32_16x16x32_bf16 v[76:79], v[188:191], a[108:111], v[76:79]
    ds_read_b128 v[220:223], v2 offset:64512
    ds_read2_b32 v[130:131], v249 offset0:16 offset1:80
    s_waitcnt lgkmcnt(4)
    v_mfma_f32_16x16x32_bf16 v[56:59], v[200:203], a[112:115], v[56:59]
    ds_read2_b32 v[132:133], v249 offset0:32 offset1:96
    ds_read2_b32 v[134:135], v249 offset0:48 offset1:112
    v_mfma_f32_16x16x32_bf16 v[72:75], v[200:203], a[116:119], v[72:75]
    ds_read_b128 v[112:115], v248 offset:0
    v_mfma_f32_16x16x32_bf16 v[60:63], v[204:207], a[112:115], v[60:63]
    ds_read_b128 v[116:119], v248 offset:64
    ds_read_b128 v[120:123], v248 offset:128
    v_mfma_f32_16x16x32_bf16 v[76:79], v[204:207], a[116:119], v[76:79]
    ds_read_b128 v[124:127], v248 offset:192
    s_waitcnt lgkmcnt(7)
    v_mfma_f32_16x16x32_bf16 v[56:59], v[216:219], a[120:123], v[56:59]
    ds_read_b128 v[96:99], v248 offset:256
    ds_read_b128 v[100:103], v248 offset:320
    v_mfma_f32_16x16x32_bf16 v[72:75], v[216:219], a[124:127], v[72:75]
    ds_read_b128 v[104:107], v248 offset:384
    v_mfma_f32_16x16x32_bf16 v[60:63], v[220:223], a[120:123], v[60:63]
    ds_read_b128 v[108:111], v248 offset:448
    s_mul_i32 s31, s12, 192
    v_mfma_f32_16x16x32_bf16 v[76:79], v[220:223], a[124:127], v[76:79]
    v_add_u32 v248, s31, v248
    v_add_u32 v249, s31, v249
    ds_write_b32 v249, v224 offset:1344
    ds_write_b32 v249, v228 offset:1408
    v_mov_b32 v136, 0x3f803f80
    v_mov_b32 v137, v136
    v_mov_b32 v138, v136
    v_mov_b32 v139, v136
    s_waitcnt lgkmcnt(0)
    ds_read_b128 v[16:19], v2 offset:0
    ds_read_b128 v[20:23], v2 offset:16384
    ds_read_b128 v[24:27], v2 offset:32768
    ds_read_b128 v[28:31], v2 offset:49152
    ds_read_b128 v[32:35], v2 offset:1024
    ds_read_b128 v[36:39], v2 offset:17408
    ds_read_b128 v[40:43], v2 offset:33792
    ds_read_b128 v[44:47], v2 offset:50176
    v_pk_fma_f32 v[48:49], v[96:97], v[224:225], v[48:49] op_sel_hi:[1,0,1] neg_lo:[1,0,0] neg_hi:[1,0,0]
    v_pk_fma_f32 v[50:51], v[98:99], v[224:225], v[50:51] op_sel_hi:[1,0,1] neg_lo:[1,0,0] neg_hi:[1,0,0]
    v_pk_fma_f32 v[52:53], v[100:101], v[224:225], v[52:53] op_sel_hi:[1,0,1] neg_lo:[1,0,0] neg_hi:[1,0,0]
    v_pk_fma_f32 v[54:55], v[102:103], v[224:225], v[54:55] op_sel_hi:[1,0,1] neg_lo:[1,0,0] neg_hi:[1,0,0]
    v_pk_fma_f32 v[56:57], v[104:105], v[224:225], v[56:57] op_sel_hi:[1,0,1] neg_lo:[1,0,0] neg_hi:[1,0,0]
    v_pk_fma_f32 v[58:59], v[106:107], v[224:225], v[58:59] op_sel_hi:[1,0,1] neg_lo:[1,0,0] neg_hi:[1,0,0]
    v_pk_fma_f32 v[60:61], v[108:109], v[224:225], v[60:61] op_sel_hi:[1,0,1] neg_lo:[1,0,0] neg_hi:[1,0,0]
    v_pk_fma_f32 v[62:63], v[110:111], v[224:225], v[62:63] op_sel_hi:[1,0,1] neg_lo:[1,0,0] neg_hi:[1,0,0]
    v_pk_fma_f32 v[64:65], v[96:97], v[228:229], v[64:65] op_sel_hi:[1,0,1] neg_lo:[1,0,0] neg_hi:[1,0,0]
    v_pk_fma_f32 v[66:67], v[98:99], v[228:229], v[66:67] op_sel_hi:[1,0,1] neg_lo:[1,0,0] neg_hi:[1,0,0]
    v_pk_fma_f32 v[68:69], v[100:101], v[228:229], v[68:69] op_sel_hi:[1,0,1] neg_lo:[1,0,0] neg_hi:[1,0,0]
    v_pk_fma_f32 v[70:71], v[102:103], v[228:229], v[70:71] op_sel_hi:[1,0,1] neg_lo:[1,0,0] neg_hi:[1,0,0]
    v_pk_fma_f32 v[72:73], v[104:105], v[228:229], v[72:73] op_sel_hi:[1,0,1] neg_lo:[1,0,0] neg_hi:[1,0,0]
    v_pk_fma_f32 v[74:75], v[106:107], v[228:229], v[74:75] op_sel_hi:[1,0,1] neg_lo:[1,0,0] neg_hi:[1,0,0]
    v_pk_fma_f32 v[76:77], v[108:109], v[228:229], v[76:77] op_sel_hi:[1,0,1] neg_lo:[1,0,0] neg_hi:[1,0,0]
    v_pk_fma_f32 v[78:79], v[110:111], v[228:229], v[78:79] op_sel_hi:[1,0,1] neg_lo:[1,0,0] neg_hi:[1,0,0]
    v_pk_mul_f32 v[48:49], v[48:49], v[112:113]
    v_pk_mul_f32 v[50:51], v[50:51], v[114:115]
    v_pk_mul_f32 v[52:53], v[52:53], v[116:117]
    v_pk_mul_f32 v[54:55], v[54:55], v[118:119]
    v_pk_mul_f32 v[56:57], v[56:57], v[120:121]
    v_pk_mul_f32 v[58:59], v[58:59], v[122:123]
    v_pk_mul_f32 v[60:61], v[60:61], v[124:125]
    v_pk_mul_f32 v[62:63], v[62:63], v[126:127]
    v_pk_mul_f32 v[96:97], v[48:49], s[92:93]
    v_pk_mul_f32 v[98:99], v[50:51], s[92:93]
    v_pk_mul_f32 v[100:101], v[52:53], s[92:93]
    v_pk_mul_f32 v[102:103], v[54:55], s[92:93]
    v_pk_mul_f32 v[104:105], v[56:57], s[92:93]
    v_pk_mul_f32 v[106:107], v[58:59], s[92:93]
    v_pk_mul_f32 v[108:109], v[60:61], s[92:93]
    v_pk_mul_f32 v[110:111], v[62:63], s[92:93]
    v_pk_mul_f32 v[64:65], v[64:65], v[112:113]
    v_pk_mul_f32 v[66:67], v[66:67], v[114:115]
    v_pk_mul_f32 v[68:69], v[68:69], v[116:117]
    v_pk_mul_f32 v[70:71], v[70:71], v[118:119]
    v_pk_mul_f32 v[72:73], v[72:73], v[120:121]
    v_pk_mul_f32 v[74:75], v[74:75], v[122:123]
    v_pk_mul_f32 v[76:77], v[76:77], v[124:125]
    v_pk_mul_f32 v[78:79], v[78:79], v[126:127]
    v_exp_f32 v96, v96 clamp
    v_exp_f32 v97, v97 clamp
    v_exp_f32 v98, v98 clamp
    v_exp_f32 v99, v99 clamp
    v_exp_f32 v100, v100 clamp
    v_exp_f32 v101, v101 clamp
    v_exp_f32 v102, v102 clamp
    v_exp_f32 v103, v103 clamp
    v_exp_f32 v104, v104 clamp
    v_exp_f32 v105, v105 clamp
    v_exp_f32 v106, v106 clamp
    v_exp_f32 v107, v107 clamp
    v_exp_f32 v108, v108 clamp
    v_exp_f32 v109, v109 clamp
    v_exp_f32 v110, v110 clamp
    v_exp_f32 v111, v111 clamp
    v_max_f32 v48, s94, v48
    v_max_f32 v49, s94, v49
    v_max_f32 v50, s94, v50
    v_max_f32 v51, s94, v51
    v_max_f32 v52, s94, v52
    v_max_f32 v53, s94, v53
    v_max_f32 v54, s94, v54
    v_max_f32 v55, s94, v55
    v_max_f32 v56, s94, v56
    v_max_f32 v57, s94, v57
    v_max_f32 v58, s94, v58
    v_max_f32 v59, s94, v59
    v_max_f32 v60, s94, v60
    v_max_f32 v61, s94, v61
    v_max_f32 v62, s94, v62
    v_max_f32 v63, s94, v63
    v_cvt_pk_bf16_f32 v232, v64, v65
    v_cvt_pk_bf16_f32 v233, v66, v67
    v_cvt_pk_bf16_f32 v234, v68, v69
    v_cvt_pk_bf16_f32 v235, v70, v71
    v_cvt_pk_bf16_f32 v236, v72, v73
    v_cvt_pk_bf16_f32 v237, v74, v75
    v_cvt_pk_bf16_f32 v238, v76, v77
    v_cvt_pk_bf16_f32 v239, v78, v79
    v_pk_add_f32 v[48:49], v[48:49], v[96:97]
    v_pk_add_f32 v[50:51], v[50:51], v[98:99]
    v_pk_add_f32 v[52:53], v[52:53], v[100:101]
    v_pk_add_f32 v[54:55], v[54:55], v[102:103]
    v_pk_add_f32 v[56:57], v[56:57], v[104:105]
    v_pk_add_f32 v[58:59], v[58:59], v[106:107]
    v_pk_add_f32 v[60:61], v[60:61], v[108:109]
    v_pk_add_f32 v[62:63], v[62:63], v[110:111]
    v_cvt_pk_bf16_f32 v224, v48, v49
    v_cvt_pk_bf16_f32 v225, v50, v51
    v_cvt_pk_bf16_f32 v226, v52, v53
    v_cvt_pk_bf16_f32 v227, v54, v55
    v_cvt_pk_bf16_f32 v228, v56, v57
    v_cvt_pk_bf16_f32 v229, v58, v59
    v_cvt_pk_bf16_f32 v230, v60, v61
    v_cvt_pk_bf16_f32 v231, v62, v63
    v_mfma_f32_16x16x32_bf16 v[96:99], v[232:235], v[224:227], 0
    v_mfma_f32_16x16x32_bf16 v[100:103], v[136:139], v[224:227], 0
    v_mfma_f32_16x16x32_bf16 v[96:99], v[236:239], v[228:231], v[96:99]
    v_mfma_f32_16x16x32_bf16 v[100:103], v[136:139], v[228:231], v[100:103]
    s_mul_i32 s31, s13, 1152
    v_lshlrev_b32 v6, 2, v1
    s_add_u32 s3, s31, 0x420000
    s_nop 3
    buffer_atomic_add_f32 v96, v6, s[16:19], s3 offen offset:0
    buffer_atomic_add_f32 v97, v6, s[16:19], s3 offen offset:256
    buffer_atomic_add_f32 v98, v6, s[16:19], s3 offen offset:512
    buffer_atomic_add_f32 v99, v6, s[16:19], s3 offen offset:768
    s_mov_b64 exec, 0xffff
    buffer_atomic_add_f32 v100, v6, s[16:19], s3 offen offset:1024
    s_mov_b64 exec, -1
    v_mov_b32 v140, 1
    v_lshlrev_b32 v141, 7, v1
    s_lshl_b32 s86, s13, 10
    s_add_u32 s86, s86, 0x450000
    v_and_b32 v104, 15, v1
    v_lshrrev_b32 v105, 5, v1
    v_bfe_u32 v106, v1, 4, 1
    s_lshl_b32 s31, s11, 11
    s_add_u32 s31, s31, s82
    v_lshl_add_u32 v107, v105, 4, v104
    v_lshlrev_b32 v107, 4, v107
    v_lshl_add_u32 v107, v106, 3, v107
    v_add_u32 v107, s31, v107
    ds_read_b64 v[224:225], v107 offset:0
    ds_read_b64 v[226:227], v107 offset:512
    ds_read_b64 v[228:229], v107 offset:1024
    ds_read_b64 v[230:231], v107 offset:1536
    v_lshrrev_b32 v108, 3, v1
    v_lshlrev_b32 v108, 10, v108
    v_bfe_u32 v109, v1, 4, 2
    v_lshlrev_b32 v109, 1, v109
    v_and_b32 v110, 7, v1
    v_xor_b32 v109, v109, v110
    v_lshl_add_u32 v6, v109, 4, v108
    s_lshl_b32 s89, s12, 17
    s_lshl_b32 s31, s11, 7
    s_add_u32 s89, s89, s31
    s_mov_b32 s20, s78
    s_mov_b32 s21, s79
    s_waitcnt lgkmcnt(0)
    s_waitcnt vmcnt(20)
    s_waitcnt lgkmcnt(7)
    v_mfma_f32_16x16x32_bf16 v[80:83], a[128:131], v[16:19], 0
    ds_read_b128 v[16:19], v2 offset:2048
    s_waitcnt lgkmcnt(7)
    v_mfma_f32_16x16x32_bf16 v[84:87], a[128:131], v[20:23], 0
    ds_read_b128 v[20:23], v2 offset:18432
    s_waitcnt lgkmcnt(7)
    v_mfma_f32_16x16x32_bf16 v[88:91], a[128:131], v[24:27], 0
    ds_read_b128 v[24:27], v2 offset:34816
    s_waitcnt lgkmcnt(7)
    v_mfma_f32_16x16x32_bf16 v[92:95], a[128:131], v[28:31], 0
    ds_read_b128 v[28:31], v2 offset:51200
    s_waitcnt vmcnt(19)
    s_waitcnt lgkmcnt(7)
    v_mfma_f32_16x16x32_bf16 v[80:83], a[132:135], v[32:35], v[80:83]
    ds_read_b128 v[32:35], v2 offset:3072
    s_waitcnt lgkmcnt(7)
    v_mfma_f32_16x16x32_bf16 v[84:87], a[132:135], v[36:39], v[84:87]
    ds_read_b128 v[36:39], v2 offset:19456
    s_waitcnt lgkmcnt(7)
    v_mfma_f32_16x16x32_bf16 v[88:91], a[132:135], v[40:43], v[88:91]
    ds_read_b128 v[40:43], v2 offset:35840
    s_waitcnt lgkmcnt(7)
    v_mfma_f32_16x16x32_bf16 v[92:95], a[132:135], v[44:47], v[92:95]
    ds_read_b128 v[44:47], v2 offset:52224
    s_waitcnt vmcnt(18)
    s_waitcnt lgkmcnt(7)
    v_mfma_f32_16x16x32_bf16 v[80:83], a[136:139], v[16:19], v[80:83]
    ds_read_b128 v[16:19], v2 offset:4096
    s_waitcnt lgkmcnt(7)
    v_mfma_f32_16x16x32_bf16 v[84:87], a[136:139], v[20:23], v[84:87]
    ds_read_b128 v[20:23], v2 offset:20480
    s_waitcnt lgkmcnt(7)
    v_mfma_f32_16x16x32_bf16 v[88:91], a[136:139], v[24:27], v[88:91]
    ds_read_b128 v[24:27], v2 offset:36864
    s_waitcnt lgkmcnt(7)
    v_mfma_f32_16x16x32_bf16 v[92:95], a[136:139], v[28:31], v[92:95]
    ds_read_b128 v[28:31], v2 offset:53248
    s_waitcnt vmcnt(17)
    s_waitcnt lgkmcnt(7)
    v_mfma_f32_16x16x32_bf16 v[80:83], a[140:143], v[32:35], v[80:83]
    ds_read_b128 v[32:35], v2 offset:5120
    s_waitcnt lgkmcnt(7)
    v_mfma_f32_16x16x32_bf16 v[84:87], a[140:143], v[36:39], v[84:87]
    ds_read_b128 v[36:39], v2 offset:21504
    s_waitcnt lgkmcnt(7)
    v_mfma_f32_16x16x32_bf16 v[88:91], a[140:143], v[40:43], v[88:91]
    ds_read_b128 v[40:43], v2 offset:37888
    s_waitcnt lgkmcnt(7)
    v_mfma_f32_16x16x32_bf16 v[92:95], a[140:143], v[44:47], v[92:95]
    ds_read_b128 v[44:47], v2 offset:54272
    s_waitcnt vmcnt(16)
    s_waitcnt lgkmcnt(7)
    v_mfma_f32_16x16x32_bf16 v[80:83], a[144:147], v[16:19], v[80:83]
    ds_read_b128 v[16:19], v2 offset:6144
    s_waitcnt lgkmcnt(7)
    v_mfma_f32_16x16x32_bf16 v[84:87], a[144:147], v[20:23], v[84:87]
    ds_read_b128 v[20:23], v2 offset:22528
    s_waitcnt lgkmcnt(7)
    v_mfma_f32_16x16x32_bf16 v[88:91], a[144:147], v[24:27], v[88:91]
    ds_read_b128 v[24:27], v2 offset:38912
    s_waitcnt lgkmcnt(7)
    v_mfma_f32_16x16x32_bf16 v[92:95], a[144:147], v[28:31], v[92:95]
    ds_read_b128 v[28:31], v2 offset:55296
    s_waitcnt vmcnt(15)
    s_waitcnt lgkmcnt(7)
    v_mfma_f32_16x16x32_bf16 v[80:83], a[148:151], v[32:35], v[80:83]
    ds_read_b128 v[32:35], v2 offset:7168
    s_waitcnt lgkmcnt(7)
    v_mfma_f32_16x16x32_bf16 v[84:87], a[148:151], v[36:39], v[84:87]
    ds_read_b128 v[36:39], v2 offset:23552
    s_waitcnt lgkmcnt(7)
    v_mfma_f32_16x16x32_bf16 v[88:91], a[148:151], v[40:43], v[88:91]
    ds_read_b128 v[40:43], v2 offset:39936
    s_waitcnt lgkmcnt(7)
    v_mfma_f32_16x16x32_bf16 v[92:95], a[148:151], v[44:47], v[92:95]
    ds_read_b128 v[44:47], v2 offset:56320
    s_waitcnt vmcnt(14)
    s_waitcnt lgkmcnt(7)
    v_mfma_f32_16x16x32_bf16 v[80:83], a[152:155], v[16:19], v[80:83]
    ds_read_b128 v[16:19], v2 offset:8192
    s_waitcnt lgkmcnt(7)
    v_mfma_f32_16x16x32_bf16 v[84:87], a[152:155], v[20:23], v[84:87]
    ds_read_b128 v[20:23], v2 offset:24576
    s_waitcnt lgkmcnt(7)
    v_mfma_f32_16x16x32_bf16 v[88:91], a[152:155], v[24:27], v[88:91]
    ds_read_b128 v[24:27], v2 offset:40960
    s_waitcnt lgkmcnt(7)
    v_mfma_f32_16x16x32_bf16 v[92:95], a[152:155], v[28:31], v[92:95]
    ds_read_b128 v[28:31], v2 offset:57344
    s_waitcnt vmcnt(13)
    s_waitcnt lgkmcnt(7)
    v_mfma_f32_16x16x32_bf16 v[80:83], a[156:159], v[32:35], v[80:83]
    ds_read_b128 v[32:35], v2 offset:9216
    s_waitcnt lgkmcnt(7)
    v_mfma_f32_16x16x32_bf16 v[84:87], a[156:159], v[36:39], v[84:87]
    ds_read_b128 v[36:39], v2 offset:25600
    s_waitcnt lgkmcnt(7)
    v_mfma_f32_16x16x32_bf16 v[88:91], a[156:159], v[40:43], v[88:91]
    ds_read_b128 v[40:43], v2 offset:41984
    s_waitcnt lgkmcnt(7)
    v_mfma_f32_16x16x32_bf16 v[92:95], a[156:159], v[44:47], v[92:95]
    ds_read_b128 v[44:47], v2 offset:58368
    s_waitcnt vmcnt(12)
    s_waitcnt lgkmcnt(7)
    v_mfma_f32_16x16x32_bf16 v[80:83], a[160:163], v[16:19], v[80:83]
    ds_read_b128 v[16:19], v2 offset:10240
    s_waitcnt lgkmcnt(7)
    v_mfma_f32_16x16x32_bf16 v[84:87], a[160:163], v[20:23], v[84:87]
    ds_read_b128 v[20:23], v2 offset:26624
    s_waitcnt lgkmcnt(7)
    v_mfma_f32_16x16x32_bf16 v[88:91], a[160:163], v[24:27], v[88:91]
    ds_read_b128 v[24:27], v2 offset:43008
    s_waitcnt lgkmcnt(7)
    v_mfma_f32_16x16x32_bf16 v[92:95], a[160:163], v[28:31], v[92:95]
    ds_read_b128 v[28:31], v2 offset:59392
    s_waitcnt vmcnt(11)
    s_waitcnt lgkmcnt(7)
    v_mfma_f32_16x16x32_bf16 v[80:83], a[164:167], v[32:35], v[80:83]
    s_waitcnt lgkmcnt(6)
    v_mfma_f32_16x16x32_bf16 v[84:87], a[164:167], v[36:39], v[84:87]
    s_waitcnt lgkmcnt(5)
    v_mfma_f32_16x16x32_bf16 v[88:91], a[164:167], v[40:43], v[88:91]
    s_waitcnt lgkmcnt(4)
    v_mfma_f32_16x16x32_bf16 v[92:95], a[164:167], v[44:47], v[92:95]
    s_waitcnt vmcnt(10)
    s_waitcnt lgkmcnt(3)
    v_mfma_f32_16x16x32_bf16 v[80:83], a[168:171], v[16:19], v[80:83]
    s_waitcnt lgkmcnt(2)
    v_mfma_f32_16x16x32_bf16 v[84:87], a[168:171], v[20:23], v[84:87]
    s_waitcnt lgkmcnt(1)
    v_mfma_f32_16x16x32_bf16 v[88:91], a[168:171], v[24:27], v[88:91]
    s_waitcnt lgkmcnt(0)
    v_mfma_f32_16x16x32_bf16 v[92:95], a[168:171], v[28:31], v[92:95]
    s_barrier
    s_waitcnt vmcnt(5)
    s_waitcnt vmcnt(0)
    s_mov_b64 exec, 0xff
    buffer_atomic_add v140, v141, s[16:19], s86 offen sc1
    s_mov_b64 exec, -1
    v_mfma_f32_16x16x32_bf16 v[80:83], a[172:175], v[144:147], v[80:83]
    s_add_u32 m0, s82, 0
    s_add_u32 s90, s89, 0
    buffer_load_dwordx4 v6, s[20:23], s90 offen lds
    v_mfma_f32_16x16x32_bf16 v[84:87], a[172:175], v[148:151], v[84:87]
    v_mfma_f32_16x16x32_bf16 v[88:91], a[172:175], v[152:155], v[88:91]
    v_mfma_f32_16x16x32_bf16 v[92:95], a[172:175], v[156:159], v[92:95]
    s_add_u32 m0, s82, 1024
    s_add_u32 s90, s89, 8192
    buffer_load_dwordx4 v6, s[20:23], s90 offen lds
    v_mfma_f32_16x16x32_bf16 v[80:83], a[176:179], v[160:163], v[80:83]
    v_mfma_f32_16x16x32_bf16 v[84:87], a[176:179], v[164:167], v[84:87]
    v_mfma_f32_16x16x32_bf16 v[88:91], a[176:179], v[168:171], v[88:91]
    v_mfma_f32_16x16x32_bf16 v[92:95], a[176:179], v[172:175], v[92:95]
    s_add_u32 m0, s82, 2048
    s_add_u32 s90, s89, 16384
    buffer_load_dwordx4 v6, s[20:23], s90 offen lds
    v_mfma_f32_16x16x32_bf16 v[80:83], a[180:183], v[176:179], v[80:83]
    v_mfma_f32_16x16x32_bf16 v[84:87], a[180:183], v[180:183], v[84:87]
    v_mfma_f32_16x16x32_bf16 v[88:91], a[180:183], v[184:187], v[88:91]
    s_add_u32 m0, s82, 3072
    s_add_u32 s90, s89, 24576
    buffer_load_dwordx4 v6, s[20:23], s90 offen lds
    v_mfma_f32_16x16x32_bf16 v[92:95], a[180:183], v[188:191], v[92:95]
    v_mfma_f32_16x16x32_bf16 v[80:83], a[184:187], v[192:195], v[80:83]
    v_mfma_f32_16x16x32_bf16 v[84:87], a[184:187], v[196:199], v[84:87]
    v_mfma_f32_16x16x32_bf16 v[88:91], a[184:187], v[200:203], v[88:91]
    s_add_u32 m0, s82, 4096
    s_add_u32 s90, s89, 32768
    buffer_load_dwordx4 v6, s[20:23], s90 offen lds
    v_mfma_f32_16x16x32_bf16 v[92:95], a[184:187], v[204:207], v[92:95]
    v_mfma_f32_16x16x32_bf16 v[80:83], a[188:191], v[208:211], v[80:83]
    v_mfma_f32_16x16x32_bf16 v[84:87], a[188:191], v[212:215], v[84:87]
    v_mfma_f32_16x16x32_bf16 v[88:91], a[188:191], v[216:219], v[88:91]
    s_add_u32 m0, s82, 5120
    s_add_u32 s90, s89, 40960
    buffer_load_dwordx4 v6, s[20:23], s90 offen lds
    v_mfma_f32_16x16x32_bf16 v[92:95], a[188:191], v[220:223], v[92:95]
    v_mfma_f32_16x16x32_bf16 v[244:247], a[128:131], v[136:139], 0
    v_mfma_f32_16x16x32_bf16 v[244:247], a[132:135], v[136:139], v[244:247]
    s_add_u32 m0, s82, 6144
    s_add_u32 s90, s89, 49152
    buffer_load_dwordx4 v6, s[20:23], s90 offen lds
    v_mfma_f32_16x16x32_bf16 v[244:247], a[136:139], v[136:139], v[244:247]
    v_mfma_f32_16x16x32_bf16 v[244:247], a[140:143], v[136:139], v[244:247]
    v_mfma_f32_16x16x32_bf16 v[244:247], a[144:147], v[136:139], v[244:247]
    v_mfma_f32_16x16x32_bf16 v[244:247], a[148:151], v[136:139], v[244:247]
    s_add_u32 m0, s82, 7168
    s_add_u32 s90, s89, 57344
    buffer_load_dwordx4 v6, s[20:23], s90 offen lds
    v_mfma_f32_16x16x32_bf16 v[244:247], a[152:155], v[136:139], v[244:247]
    v_mfma_f32_16x16x32_bf16 v[244:247], a[156:159], v[136:139], v[244:247]
    v_mfma_f32_16x16x32_bf16 v[244:247], a[160:163], v[136:139], v[244:247]
    s_add_u32 m0, s82, 8192
    s_add_u32 s90, s89, 65536
    buffer_load_dwordx4 v6, s[20:23], s90 offen lds
    v_mfma_f32_16x16x32_bf16 v[244:247], a[164:167], v[136:139], v[244:247]
    v_mfma_f32_16x16x32_bf16 v[244:247], a[168:171], v[136:139], v[244:247]
    v_mfma_f32_16x16x32_bf16 v[244:247], a[172:175], v[136:139], v[244:247]
    v_mfma_f32_16x16x32_bf16 v[244:247], a[176:179], v[136:139], v[244:247]
    s_add_u32 m0, s82, 9216
    s_add_u32 s90, s89, 73728
    buffer_load_dwordx4 v6, s[20:23], s90 offen lds
    v_mfma_f32_16x16x32_bf16 v[244:247], a[180:183], v[136:139], v[244:247]
    v_mfma_f32_16x16x32_bf16 v[244:247], a[184:187], v[136:139], v[244:247]
    v_mfma_f32_16x16x32_bf16 v[244:247], a[188:191], v[136:139], v[244:247]
    s_nop 7
    ds_write_b128 v248, v[244:247] offset:1280
    s_and_b32 s30, s2, 7
    s_lshl_b32 s30, s30, 7
    s_add_u32 s86, s86, s30
    s_mov_b64 exec, 1
    buffer_load_dword v24, v1, s[16:19], s86 offen sc1
    s_mov_b64 exec, -1
    v_and_b32 v16, 15, v1
    v_lshrrev_b32 v17, 5, v1
    v_bfe_u32 v18, v1, 4, 1
    v_and_b32 v19, 3, v1
    v_bfe_u32 v20, v1, 2, 2
    v_lshl_add_u32 v19, v19, 2, v20
    v_lshlrev_b32 v19, 6, v19
    v_mov_b32 v20, 0x400
    s_mov_b32 s100, 0xffff
    s_mov_b32 s101, 0xffff
    v_cndmask_b32 v19, v20, v19, s[100:101]
    v_lshl_add_u32 v249, v17, 5, v19
    s_add_u32 m0, s82, 10240
    s_add_u32 s90, s89, 81920
    buffer_load_dwordx4 v6, s[20:23], s90 offen lds
    v_pk_fma_f32 v[80:81], v[244:245], v[128:129], v[80:81] op_sel:[0,1,0] op_sel_hi:[1,1,1] neg_lo:[1,0,0] neg_hi:[1,0,0]
    v_pk_fma_f32 v[82:83], v[246:247], v[128:129], v[82:83] op_sel:[0,1,0] op_sel_hi:[1,1,1] neg_lo:[1,0,0] neg_hi:[1,0,0]
    v_pk_fma_f32 v[84:85], v[244:245], v[130:131], v[84:85] op_sel:[0,1,0] op_sel_hi:[1,1,1] neg_lo:[1,0,0] neg_hi:[1,0,0]
    v_pk_fma_f32 v[86:87], v[246:247], v[130:131], v[86:87] op_sel:[0,1,0] op_sel_hi:[1,1,1] neg_lo:[1,0,0] neg_hi:[1,0,0]
    v_pk_fma_f32 v[88:89], v[244:245], v[132:133], v[88:89] op_sel:[0,1,0] op_sel_hi:[1,1,1] neg_lo:[1,0,0] neg_hi:[1,0,0]
    v_pk_fma_f32 v[90:91], v[246:247], v[132:133], v[90:91] op_sel:[0,1,0] op_sel_hi:[1,1,1] neg_lo:[1,0,0] neg_hi:[1,0,0]
    s_add_u32 m0, s82, 11264
    s_add_u32 s90, s89, 90112
    buffer_load_dwordx4 v6, s[20:23], s90 offen lds
    v_pk_fma_f32 v[92:93], v[244:245], v[134:135], v[92:93] op_sel:[0,1,0] op_sel_hi:[1,1,1] neg_lo:[1,0,0] neg_hi:[1,0,0]
    v_pk_fma_f32 v[94:95], v[246:247], v[134:135], v[94:95] op_sel:[0,1,0] op_sel_hi:[1,1,1] neg_lo:[1,0,0] neg_hi:[1,0,0]
    v_pk_mul_f32 v[80:81], v[80:81], v[128:129] op_sel_hi:[1,0]
    v_pk_mul_f32 v[82:83], v[82:83], v[128:129] op_sel_hi:[1,0]
    v_pk_mul_f32 v[84:85], v[84:85], v[130:131] op_sel_hi:[1,0]
    v_pk_mul_f32 v[86:87], v[86:87], v[130:131] op_sel_hi:[1,0]
    v_pk_mul_f32 v[88:89], v[88:89], v[132:133] op_sel_hi:[1,0]
    s_add_u32 m0, s82, 12288
    s_add_u32 s90, s89, 98304
    buffer_load_dwordx4 v6, s[20:23], s90 offen lds
    v_pk_mul_f32 v[90:91], v[90:91], v[132:133] op_sel_hi:[1,0]
    v_pk_mul_f32 v[92:93], v[92:93], v[134:135] op_sel_hi:[1,0]
    v_pk_mul_f32 v[94:95], v[94:95], v[134:135] op_sel_hi:[1,0]
    v_pk_mul_f32 v[96:97], v[80:81], s[92:93]
    v_pk_mul_f32 v[98:99], v[82:83], s[92:93]
    v_pk_mul_f32 v[100:101], v[84:85], s[92:93]
    v_pk_mul_f32 v[102:103], v[86:87], s[92:93]
    s_add_u32 m0, s82, 13312
    s_add_u32 s90, s89, 106496
    buffer_load_dwordx4 v6, s[20:23], s90 offen lds
    v_pk_mul_f32 v[104:105], v[88:89], s[92:93]
    v_pk_mul_f32 v[106:107], v[90:91], s[92:93]
    v_pk_mul_f32 v[108:109], v[92:93], s[92:93]
    v_pk_mul_f32 v[110:111], v[94:95], s[92:93]
    v_exp_f32 v96, v96 clamp
    v_exp_f32 v97, v97 clamp
    s_add_u32 m0, s82, 14336
    s_add_u32 s90, s89, 114688
    buffer_load_dwordx4 v6, s[20:23], s90 offen lds
    v_exp_f32 v98, v98 clamp
    v_exp_f32 v99, v99 clamp
    v_exp_f32 v100, v100 clamp
    v_exp_f32 v101, v101 clamp
    v_exp_f32 v102, v102 clamp
    v_exp_f32 v103, v103 clamp
    v_exp_f32 v104, v104 clamp
    s_add_u32 m0, s82, 15360
    s_add_u32 s90, s89, 122880
    buffer_load_dwordx4 v6, s[20:23], s90 offen lds
    v_exp_f32 v105, v105 clamp
    v_exp_f32 v106, v106 clamp
    v_exp_f32 v107, v107 clamp
    v_exp_f32 v108, v108 clamp
    v_exp_f32 v109, v109 clamp
    v_exp_f32 v110, v110 clamp
    v_exp_f32 v111, v111 clamp
    s_waitcnt vmcnt(6)
    v_readfirstlane_b32 s1, v24
    s_nop 0
    s_cmp_lg_u32 s1, 32
    s_cbranch_scc1 obn0
    buffer_load_dwordx4 v[48:51], v249, s[16:19], s3 offen offset:0 sc1
    buffer_load_dwordx4 v[52:55], v249, s[16:19], s3 offen offset:16 sc1
    s_branch obm0
obn0:
    s_mov_b64 exec, 1
    buffer_load_dword v24, v1, s[16:19], s86 offen sc1
    s_mov_b64 exec, -1
obm0:
    v_max_f32 v80, s94, v80
    v_max_f32 v81, s94, v81
    v_max_f32 v82, s94, v82
    v_max_f32 v83, s94, v83
    v_max_f32 v84, s94, v84
    v_max_f32 v85, s94, v85
    v_max_f32 v86, s94, v86
    v_max_f32 v87, s94, v87
    v_max_f32 v88, s94, v88
    v_max_f32 v89, s94, v89
    v_max_f32 v90, s94, v90
    v_max_f32 v91, s94, v91
    v_max_f32 v92, s94, v92
    v_max_f32 v93, s94, v93
    v_max_f32 v94, s94, v94
    v_max_f32 v95, s94, v95
    v_pk_add_f32 v[80:81], v[80:81], v[96:97]
    v_pk_add_f32 v[82:83], v[82:83], v[98:99]
    v_pk_add_f32 v[84:85], v[84:85], v[100:101]
    v_pk_add_f32 v[86:87], v[86:87], v[102:103]
    v_pk_add_f32 v[88:89], v[88:89], v[104:105]
    v_pk_add_f32 v[90:91], v[90:91], v[106:107]
    v_pk_add_f32 v[92:93], v[92:93], v[108:109]
    v_pk_add_f32 v[94:95], v[94:95], v[110:111]
    v_cvt_pk_bf16_f32 v240, v80, v81
    v_cvt_pk_bf16_f32 v241, v82, v83
    v_cvt_pk_bf16_f32 v242, v84, v85
    v_cvt_pk_bf16_f32 v243, v86, v87
    v_cvt_pk_bf16_f32 v244, v88, v89
    v_cvt_pk_bf16_f32 v245, v90, v91
    v_cvt_pk_bf16_f32 v246, v92, v93
    v_cvt_pk_bf16_f32 v247, v94, v95
    v_permlane16_swap_b32 v240, v242
    v_permlane16_swap_b32 v241, v243
    v_permlane16_swap_b32 v244, v246
    v_permlane16_swap_b32 v245, v247
    v_lshlrev_b32 v80, 16, v224
    v_and_b32 v81, 0xffff0000, v224
    v_lshlrev_b32 v82, 16, v225
    v_and_b32 v83, 0xffff0000, v225
    v_lshlrev_b32 v84, 16, v226
    v_and_b32 v85, 0xffff0000, v226
    v_lshlrev_b32 v86, 16, v227
    v_and_b32 v87, 0xffff0000, v227
    v_lshlrev_b32 v88, 16, v228
    v_and_b32 v89, 0xffff0000, v228
    v_lshlrev_b32 v90, 16, v229
    v_and_b32 v91, 0xffff0000, v229
    v_lshlrev_b32 v92, 16, v230
    v_and_b32 v93, 0xffff0000, v230
    v_lshlrev_b32 v94, 16, v231
    v_and_b32 v95, 0xffff0000, v231
    v_lshl_add_u32 v23, v18, 5, v16
    v_lshlrev_b32 v23, 4, v23
    v_lshl_add_u32 v23, v17, 10, v23
    s_and_b32 s31, s12, 1
    s_lshl_b32 s31, s31, 8
    v_add_u32 v6, s31, v23
    v_bfe_u32 v19, v1, 2, 3
    v_lshl_add_u32 v19, v17, 4, v19
    v_lshlrev_b32 v19, 7, v19
    v_bfe_u32 v20, v1, 3, 2
    v_lshl_add_u32 v19, v20, 5, v19
    v_and_b32 v20, 3, v1
    v_lshl_add_u32 v232, v20, 3, v19
    v_xor_b32 v233, 32, v232
    v_xor_b32 v234, 64, v232
    v_xor_b32 v235, 96, v232
    s_cmp_eq_u32 s1, 32
    s_cbranch_scc1 obk0
    s_mov_b32 s89, 0
    s_branch obq0_c
obq0:
    s_mov_b64 exec, 1
    buffer_load_dword v24, v1, s[16:19], s86 offen sc1
    s_mov_b64 exec, -1
obq0_c:
    s_waitcnt vmcnt(0)
    v_readfirstlane_b32 s30, v24
    s_add_u32 s89, s89, 1
    s_cmp_gt_u32 s89, 0x8000
    s_cselect_b32 s30, 32, s30
    s_cmp_lg_u32 s30, 32
    s_cbranch_scc1 obq0
    buffer_load_dwordx4 v[48:51], v249, s[16:19], s3 offen offset:0 sc1
    buffer_load_dwordx4 v[52:55], v249, s[16:19], s3 offen offset:16 sc1
obk0:
    s_add_u32 s87, s80, 0x0
    buffer_load_dwordx4 a[0:3], v2, s[16:19], s87 offen offset:0 sc1
    buffer_load_dwordx4 a[4:7], v2, s[16:19], s87 offen offset:1024 sc1
    buffer_load_dwordx4 a[8:11], v2, s[16:19], s87 offen offset:2048 sc1
    buffer_load_dwordx4 a[12:15], v2, s[16:19], s87 offen offset:3072 sc1
    s_add_u32 s87, s80, 0x1000
    buffer_load_dwordx4 a[16:19], v2, s[16:19], s87 offen offset:0 sc1
    buffer_load_dwordx4 a[20:23], v2, s[16:19], s87 offen offset:1024 sc1
    buffer_load_dwordx4 a[24:27], v2, s[16:19], s87 offen offset:2048 sc1
    buffer_load_dwordx4 a[28:31], v2, s[16:19], s87 offen offset:3072 sc1
    s_lshl_b32 s3, s10, 16
    s_lshr_b32 s30, s12, 1
    s_lshl_b32 s30, s30, 15
    s_add_u32 s3, s3, s30
    s_add_u32 s68, s85, 0x900000
    s_add_u32 s69, s85, 0x908000
    s_waitcnt vmcnt(8)
    v_cvt_pk_bf16_f32 v56, v48, v49
    v_cvt_pk_bf16_f32 v57, v50, v51
    v_cvt_pk_bf16_f32 v58, v52, v53
    v_cvt_pk_bf16_f32 v59, v54, v55
    s_nop 1
    v_mfma_f32_32x32x16_bf16 v[16:31], v[56:59], v[240:243], 0
    v_mfma_f32_32x32x16_bf16 v[32:47], v[56:59], v[244:247], 0
    s_nop 10
    v_add_f32 v24, s94, v24
    v_rcp_f32 v24, v24
    s_nop 0
    v_pk_mul_f32 v[16:17], v[16:17], v[24:25] op_sel_hi:[1,0]
    v_pk_mul_f32 v[18:19], v[18:19], v[24:25] op_sel_hi:[1,0]
    v_pk_mul_f32 v[20:21], v[20:21], v[24:25] op_sel_hi:[1,0]
    v_pk_mul_f32 v[22:23], v[22:23], v[24:25] op_sel_hi:[1,0]
    v_cvt_pk_bf16_f32 v60, v16, v17
    v_cvt_pk_bf16_f32 v61, v18, v19
    v_cvt_pk_bf16_f32 v62, v20, v21
    v_cvt_pk_bf16_f32 v63, v22, v23
    v_add_f32 v40, s94, v40
    v_rcp_f32 v40, v40
    s_nop 0
    v_pk_mul_f32 v[32:33], v[32:33], v[40:41] op_sel_hi:[1,0]
    v_pk_mul_f32 v[34:35], v[34:35], v[40:41] op_sel_hi:[1,0]
    v_pk_mul_f32 v[36:37], v[36:37], v[40:41] op_sel_hi:[1,0]
    v_pk_mul_f32 v[38:39], v[38:39], v[40:41] op_sel_hi:[1,0]
    v_cvt_pk_bf16_f32 v64, v32, v33
    v_cvt_pk_bf16_f32 v65, v34, v35
    v_cvt_pk_bf16_f32 v66, v36, v37
    v_cvt_pk_bf16_f32 v67, v38, v39
    s_cmp_eq_u32 s97, 1
    s_cbranch_scc0 slow13
    buffer_store_dwordx4 v[60:63], v2, s[16:19], s68 offen
    buffer_store_dwordx4 v[64:67], v2, s[16:19], s69 offen
back13:
    s_add_u32 s30, s72, 5
    v_mov_b32 v4, s30
    v_mov_b32 v5, s73
    s_waitcnt vmcnt(0)
    s_mov_b64 exec, 1
    s_cmp_eq_u32 s97, 1
    s_cbranch_scc0 slow14
    buffer_store_dwordx2 v[4:5], v1, s[16:19], s0 offen
back14:
    s_mov_b64 exec, -1
    s_barrier
    s_mov_b32 exec_lo, 0xffffffff
    s_mov_b32 exec_hi, 0x0
    buffer_load_dwordx2 v[4:5], v253, s[16:19], 0 offen sc1
    s_mov_b64 exec, -1
    ds_read_b64_tr_b16 v[96:97], v232 offset:0
    ds_read_b64_tr_b16 v[98:99], v232 offset:1024
    ds_read_b64_tr_b16 v[100:101], v233 offset:0
    ds_read_b64_tr_b16 v[102:103], v233 offset:1024
    ds_read_b64_tr_b16 v[104:105], v234 offset:0
    ds_read_b64_tr_b16 v[106:107], v234 offset:1024
    ds_read_b64_tr_b16 v[108:109], v235 offset:0
    ds_read_b64_tr_b16 v[110:111], v235 offset:1024
    ds_read_b64_tr_b16 v[112:113], v232 offset:4096
    ds_read_b64_tr_b16 v[114:115], v232 offset:5120
    ds_read_b64_tr_b16 v[116:117], v233 offset:4096
    ds_read_b64_tr_b16 v[118:119], v233 offset:5120
    ds_read_b64_tr_b16 v[120:121], v234 offset:4096
    ds_read_b64_tr_b16 v[122:123], v234 offset:5120
    ds_read_b64_tr_b16 v[124:125], v235 offset:4096
    ds_read_b64_tr_b16 v[126:127], v235 offset:5120
    ds_read_b64_tr_b16 v[128:129], v232 offset:8192
    ds_read_b64_tr_b16 v[130:131], v232 offset:9216
    ds_read_b64_tr_b16 v[132:133], v233 offset:8192
    ds_read_b64_tr_b16 v[134:135], v233 offset:9216
    ds_read_b64_tr_b16 v[136:137], v234 offset:8192
    ds_read_b64_tr_b16 v[138:139], v234 offset:9216
    ds_read_b64_tr_b16 v[140:141], v235 offset:8192
    ds_read_b64_tr_b16 v[142:143], v235 offset:9216
    ds_read_b64_tr_b16 v[144:145], v232 offset:12288
    ds_read_b64_tr_b16 v[146:147], v232 offset:13312
    ds_read_b64_tr_b16 v[148:149], v233 offset:12288
    ds_read_b64_tr_b16 v[150:151], v233 offset:13312
    ds_read_b64_tr_b16 v[152:153], v234 offset:12288
    ds_read_b64_tr_b16 v[154:155], v234 offset:13312
    ds_read_b64_tr_b16 v[156:157], v235 offset:12288
    ds_read_b64_tr_b16 v[158:159], v235 offset:13312
    ds_read_b64_tr_b16 v[160:161], v232 offset:16384
    ds_read_b64_tr_b16 v[162:163], v232 offset:17408
    ds_read_b64_tr_b16 v[164:165], v233 offset:16384
    ds_read_b64_tr_b16 v[166:167], v233 offset:17408
    ds_read_b64_tr_b16 v[168:169], v234 offset:16384
    ds_read_b64_tr_b16 v[170:171], v234 offset:17408
    ds_read_b64_tr_b16 v[172:173], v235 offset:16384
    ds_read_b64_tr_b16 v[174:175], v235 offset:17408
    ds_read_b64_tr_b16 v[176:177], v232 offset:20480
    ds_read_b64_tr_b16 v[178:179], v232 offset:21504
    ds_read_b64_tr_b16 v[180:181], v233 offset:20480
    ds_read_b64_tr_b16 v[182:183], v233 offset:21504
    ds_read_b64_tr_b16 v[184:185], v234 offset:20480
    ds_read_b64_tr_b16 v[186:187], v234 offset:21504
    ds_read_b64_tr_b16 v[188:189], v235 offset:20480
    ds_read_b64_tr_b16 v[190:191], v235 offset:21504
    ds_read_b64_tr_b16 v[192:193], v232 offset:24576
    ds_read_b64_tr_b16 v[194:195], v232 offset:25600
    ds_read_b64_tr_b16 v[196:197], v233 offset:24576
    ds_read_b64_tr_b16 v[198:199], v233 offset:25600
    ds_read_b64_tr_b16 v[200:201], v234 offset:24576
    ds_read_b64_tr_b16 v[202:203], v234 offset:25600
    ds_read_b64_tr_b16 v[204:205], v235 offset:24576
    ds_read_b64_tr_b16 v[206:207], v235 offset:25600
    ds_read_b64_tr_b16 v[208:209], v232 offset:28672
    ds_read_b64_tr_b16 v[210:211], v232 offset:29696
    ds_read_b64_tr_b16 v[212:213], v233 offset:28672
    ds_read_b64_tr_b16 v[214:215], v233 offset:29696
    ds_read_b64_tr_b16 v[216:217], v234 offset:28672
    ds_read_b64_tr_b16 v[218:219], v234 offset:29696
    ds_read_b64_tr_b16 v[220:221], v235 offset:28672
    ds_read_b64_tr_b16 v[222:223], v235 offset:29696
    ds_read_b64_tr_b16 a[128:129], v232 offset:32768
    ds_read_b64_tr_b16 a[130:131], v232 offset:33792
    ds_read_b64_tr_b16 a[132:133], v233 offset:32768
    ds_read_b64_tr_b16 a[134:135], v233 offset:33792
    ds_read_b64_tr_b16 a[136:137], v234 offset:32768
    ds_read_b64_tr_b16 a[138:139], v234 offset:33792
    ds_read_b64_tr_b16 a[140:141], v235 offset:32768
    ds_read_b64_tr_b16 a[142:143], v235 offset:33792
    ds_read_b64_tr_b16 a[144:145], v232 offset:36864
    ds_read_b64_tr_b16 a[146:147], v232 offset:37888
    ds_read_b64_tr_b16 a[148:149], v233 offset:36864
    ds_read_b64_tr_b16 a[150:151], v233 offset:37888
    ds_read_b64_tr_b16 a[152:153], v234 offset:36864
    ds_read_b64_tr_b16 a[154:155], v234 offset:37888
    ds_read_b64_tr_b16 a[156:157], v235 offset:36864
    ds_read_b64_tr_b16 a[158:159], v235 offset:37888
    ds_read_b64_tr_b16 a[160:161], v232 offset:40960
    ds_read_b64_tr_b16 a[162:163], v232 offset:41984
    ds_read_b64_tr_b16 a[164:165], v233 offset:40960
    ds_read_b64_tr_b16 a[166:167], v233 offset:41984
    ds_read_b64_tr_b16 a[168:169], v234 offset:40960
    ds_read_b64_tr_b16 a[170:171], v234 offset:41984
    ds_read_b64_tr_b16 a[172:173], v235 offset:40960
    ds_read_b64_tr_b16 a[174:175], v235 offset:41984
    ds_read_b64_tr_b16 a[176:177], v232 offset:45056
    ds_read_b64_tr_b16 a[178:179], v232 offset:46080
    ds_read_b64_tr_b16 a[180:181], v233 offset:45056
    ds_read_b64_tr_b16 a[182:183], v233 offset:46080
    ds_read_b64_tr_b16 a[184:185], v234 offset:45056
    ds_read_b64_tr_b16 a[186:187], v234 offset:46080
    ds_read_b64_tr_b16 a[188:189], v235 offset:45056
    ds_read_b64_tr_b16 a[190:191], v235 offset:46080
    s_mov_b32 exec_lo, 0xffffffff
    s_mov_b32 exec_hi, 0x0
    s_mov_b32 s30, 0
    s_branch poll15_c
poll15:
    buffer_load_dwordx2 v[4:5], v253, s[16:19], 0 offen sc1
poll15_c:
    s_waitcnt vmcnt(0)
poll15_l:
    s_add_u32 s30, s30, 1
    v_subrev_u32 v4, s72, v4
    v_cmp_eq_u32 s[74:75], s73, v5
    v_cmp_gt_u32 s[76:77], 32, v4
    v_cmp_le_u32 vcc, 5, v4
    s_and_b64 s[74:75], s[74:75], s[76:77]
    s_and_b64 vcc, vcc, s[74:75]
    s_cmp_eq_u64 vcc, exec
    s_cbranch_scc1 poll15_x
    s_cmp_gt_u32 s30, 0x8000
    s_cbranch_scc0 poll15
poll15_x:
    s_mov_b64 exec, -1
    s_add_u32 s88, s3, 0x900000
    buffer_load_dwordx4 v[16:19], v6, s[16:19], s88 offen offset:0 sc1
    buffer_load_dwordx4 v[20:23], v6, s[16:19], s88 offen offset:2048 sc1
    s_add_u32 s88, s3, 0x901000
    buffer_load_dwordx4 v[24:27], v6, s[16:19], s88 offen offset:0 sc1
    buffer_load_dwordx4 v[28:31], v6, s[16:19], s88 offen offset:2048 sc1
    s_waitcnt vmcnt(3) lgkmcnt(0)
    v_mfma_f32_16x16x32_bf16 v[80:83], v[96:99], v[16:19], v[80:83]
    s_add_u32 s88, s3, 0x902000
    buffer_load_dwordx4 v[32:35], v6, s[16:19], s88 offen offset:0 sc1
    v_mfma_f32_16x16x32_bf16 v[84:87], v[100:103], v[16:19], v[84:87]
    v_mfma_f32_16x16x32_bf16 v[88:91], v[104:107], v[16:19], v[88:91]
    buffer_load_dwordx4 v[36:39], v6, s[16:19], s88 offen offset:2048 sc1
    v_mfma_f32_16x16x32_bf16 v[92:95], v[108:111], v[16:19], v[92:95]
    s_waitcnt vmcnt(4)
    v_mfma_f32_16x16x32_bf16 v[80:83], v[112:115], v[20:23], v[80:83]
    s_add_u32 s88, s3, 0x903000
    buffer_load_dwordx4 v[40:43], v6, s[16:19], s88 offen offset:0 sc1
    v_mfma_f32_16x16x32_bf16 v[84:87], v[116:119], v[20:23], v[84:87]
    v_mfma_f32_16x16x32_bf16 v[88:91], v[120:123], v[20:23], v[88:91]
    buffer_load_dwordx4 v[44:47], v6, s[16:19], s88 offen offset:2048 sc1
    v_mfma_f32_16x16x32_bf16 v[92:95], v[124:127], v[20:23], v[92:95]
    s_waitcnt vmcnt(5)
    v_mfma_f32_16x16x32_bf16 v[80:83], v[128:131], v[24:27], v[80:83]
    s_add_u32 s88, s3, 0x904000
    buffer_load_dwordx4 v[48:51], v6, s[16:19], s88 offen offset:0 sc1
    v_mfma_f32_16x16x32_bf16 v[84:87], v[132:135], v[24:27], v[84:87]
    v_mfma_f32_16x16x32_bf16 v[88:91], v[136:139], v[24:27], v[88:91]
    buffer_load_dwordx4 v[52:55], v6, s[16:19], s88 offen offset:2048 sc1
    v_mfma_f32_16x16x32_bf16 v[92:95], v[140:143], v[24:27], v[92:95]
    s_waitcnt vmcnt(6)
    v_mfma_f32_16x16x32_bf16 v[80:83], v[144:147], v[28:31], v[80:83]
    s_add_u32 s88, s3, 0x905000
    buffer_load_dwordx4 v[56:59], v6, s[16:19], s88 offen offset:0 sc1
    v_mfma_f32_16x16x32_bf16 v[84:87], v[148:151], v[28:31], v[84:87]
    v_mfma_f32_16x16x32_bf16 v[88:91], v[152:155], v[28:31], v[88:91]
    buffer_load_dwordx4 v[60:63], v6, s[16:19], s88 offen offset:2048 sc1
    v_mfma_f32_16x16x32_bf16 v[92:95], v[156:159], v[28:31], v[92:95]
    s_waitcnt vmcnt(7)
    v_mfma_f32_16x16x32_bf16 v[80:83], v[160:163], v[32:35], v[80:83]
    s_add_u32 s88, s3, 0x906000
    buffer_load_dwordx4 v[64:67], v6, s[16:19], s88 offen offset:0 sc1
    ds_read_b64_tr_b16 v[96:97], v232 offset:49152
    v_mfma_f32_16x16x32_bf16 v[84:87], v[164:167], v[32:35], v[84:87]
    ds_read_b64_tr_b16 v[98:99], v232 offset:50176
    v_mfma_f32_16x16x32_bf16 v[88:91], v[168:171], v[32:35], v[88:91]
    buffer_load_dwordx4 v[68:71], v6, s[16:19], s88 offen offset:2048 sc1
    ds_read_b64_tr_b16 v[100:101], v233 offset:49152
    v_mfma_f32_16x16x32_bf16 v[92:95], v[172:175], v[32:35], v[92:95]
    ds_read_b64_tr_b16 v[102:103], v233 offset:50176
    s_waitcnt vmcnt(8)
    v_mfma_f32_16x16x32_bf16 v[80:83], v[176:179], v[36:39], v[80:83]
    s_add_u32 s88, s3, 0x907000
    buffer_load_dwordx4 v[72:75], v6, s[16:19], s88 offen offset:0 sc1
    ds_read_b64_tr_b16 v[104:105], v234 offset:49152
    v_mfma_f32_16x16x32_bf16 v[84:87], v[180:183], v[36:39], v[84:87]
    ds_read_b64_tr_b16 v[106:107], v234 offset:50176
    v_mfma_f32_16x16x32_bf16 v[88:91], v[184:187], v[36:39], v[88:91]
    buffer_load_dwordx4 v[76:79], v6, s[16:19], s88 offen offset:2048 sc1
    ds_read_b64_tr_b16 v[108:109], v235 offset:49152
    v_mfma_f32_16x16x32_bf16 v[92:95], v[188:191], v[36:39], v[92:95]
    ds_read_b64_tr_b16 v[110:111], v235 offset:50176
    s_waitcnt vmcnt(9)
    v_mfma_f32_16x16x32_bf16 v[80:83], v[192:195], v[40:43], v[80:83]
    s_add_u32 s87, s80, 0x2000
    buffer_load_dwordx4 a[32:35], v2, s[16:19], s87 offen offset:0 sc1
    ds_read_b64_tr_b16 v[112:113], v232 offset:53248
    v_mfma_f32_16x16x32_bf16 v[84:87], v[196:199], v[40:43], v[84:87]
    ds_read_b64_tr_b16 v[114:115], v232 offset:54272
    ds_read_b64_tr_b16 v[116:117], v233 offset:53248
    v_mfma_f32_16x16x32_bf16 v[88:91], v[200:203], v[40:43], v[88:91]
    buffer_load_dwordx4 a[36:39], v2, s[16:19], s87 offen offset:1024 sc1
    ds_read_b64_tr_b16 v[118:119], v233 offset:54272
    v_mfma_f32_16x16x32_bf16 v[92:95], v[204:207], v[40:43], v[92:95]
    ds_read_b64_tr_b16 v[120:121], v234 offset:53248
    ds_read_b64_tr_b16 v[122:123], v234 offset:54272
    s_waitcnt vmcnt(10)
    v_mfma_f32_16x16x32_bf16 v[80:83], v[208:211], v[44:47], v[80:83]
    buffer_load_dwordx4 a[40:43], v2, s[16:19], s87 offen offset:2048 sc1
    ds_read_b64_tr_b16 v[124:125], v235 offset:53248
    v_mfma_f32_16x16x32_bf16 v[84:87], v[212:215], v[44:47], v[84:87]
    ds_read_b64_tr_b16 v[126:127], v235 offset:54272
    ds_read_b64_tr_b16 v[128:129], v232 offset:57344
    v_mfma_f32_16x16x32_bf16 v[88:91], v[216:219], v[44:47], v[88:91]
    buffer_load_dwordx4 a[44:47], v2, s[16:19], s87 offen offset:3072 sc1
    ds_read_b64_tr_b16 v[130:131], v232 offset:58368
    v_mfma_f32_16x16x32_bf16 v[92:95], v[220:223], v[44:47], v[92:95]
    ds_read_b64_tr_b16 v[132:133], v233 offset:57344
    ds_read_b64_tr_b16 v[134:135], v233 offset:58368
    s_waitcnt vmcnt(11)
    v_mfma_f32_16x16x32_bf16 v[80:83], a[128:131], v[48:51], v[80:83]
    s_add_u32 s87, s80, 0x3000
    buffer_load_dwordx4 a[48:51], v2, s[16:19], s87 offen offset:0 sc1
    ds_read_b64_tr_b16 v[136:137], v234 offset:57344
    v_mfma_f32_16x16x32_bf16 v[84:87], a[132:135], v[48:51], v[84:87]
    ds_read_b64_tr_b16 v[138:139], v234 offset:58368
    ds_read_b64_tr_b16 v[140:141], v235 offset:57344
    v_mfma_f32_16x16x32_bf16 v[88:91], a[136:139], v[48:51], v[88:91]
    buffer_load_dwordx4 a[52:55], v2, s[16:19], s87 offen offset:1024 sc1
    ds_read_b64_tr_b16 v[142:143], v235 offset:58368
    v_mfma_f32_16x16x32_bf16 v[92:95], a[140:143], v[48:51], v[92:95]
    ds_read_b64_tr_b16 v[144:145], v232 offset:61440
    ds_read_b64_tr_b16 v[146:147], v232 offset:62464
    s_waitcnt vmcnt(12)
    v_mfma_f32_16x16x32_bf16 v[80:83], a[144:147], v[52:55], v[80:83]
    buffer_load_dwordx4 a[56:59], v2, s[16:19], s87 offen offset:2048 sc1
    ds_read_b64_tr_b16 v[148:149], v233 offset:61440
    v_mfma_f32_16x16x32_bf16 v[84:87], a[148:151], v[52:55], v[84:87]
    ds_read_b64_tr_b16 v[150:151], v233 offset:62464
    ds_read_b64_tr_b16 v[152:153], v234 offset:61440
    v_mfma_f32_16x16x32_bf16 v[88:91], a[152:155], v[52:55], v[88:91]
    buffer_load_dwordx4 a[60:63], v2, s[16:19], s87 offen offset:3072 sc1
    ds_read_b64_tr_b16 v[154:155], v234 offset:62464
    v_mfma_f32_16x16x32_bf16 v[92:95], a[156:159], v[52:55], v[92:95]
    ds_read_b64_tr_b16 v[156:157], v235 offset:61440
    ds_read_b64_tr_b16 v[158:159], v235 offset:62464
    s_waitcnt vmcnt(13)
    v_mfma_f32_16x16x32_bf16 v[80:83], a[160:163], v[56:59], v[80:83]
    v_mfma_f32_16x16x32_bf16 v[84:87], a[164:167], v[56:59], v[84:87]
    v_mfma_f32_16x16x32_bf16 v[88:91], a[168:171], v[56:59], v[88:91]
    v_mfma_f32_16x16x32_bf16 v[92:95], a[172:175], v[56:59], v[92:95]
    s_waitcnt vmcnt(12)
    v_mfma_f32_16x16x32_bf16 v[80:83], a[176:179], v[60:63], v[80:83]
    v_mfma_f32_16x16x32_bf16 v[84:87], a[180:183], v[60:63], v[84:87]
    v_mfma_f32_16x16x32_bf16 v[88:91], a[184:187], v[60:63], v[88:91]
    v_mfma_f32_16x16x32_bf16 v[92:95], a[188:191], v[60:63], v[92:95]
    s_waitcnt vmcnt(11) lgkmcnt(0)
    v_mfma_f32_16x16x32_bf16 v[80:83], v[96:99], v[64:67], v[80:83]
    v_mfma_f32_16x16x32_bf16 v[84:87], v[100:103], v[64:67], v[84:87]
    v_mfma_f32_16x16x32_bf16 v[88:91], v[104:107], v[64:67], v[88:91]
    v_mfma_f32_16x16x32_bf16 v[92:95], v[108:111], v[64:67], v[92:95]
    s_waitcnt vmcnt(10)
    v_mfma_f32_16x16x32_bf16 v[80:83], v[112:115], v[68:71], v[80:83]
    v_mfma_f32_16x16x32_bf16 v[84:87], v[116:119], v[68:71], v[84:87]
    v_mfma_f32_16x16x32_bf16 v[88:91], v[120:123], v[68:71], v[88:91]
    v_mfma_f32_16x16x32_bf16 v[92:95], v[124:127], v[68:71], v[92:95]
    s_waitcnt vmcnt(9)
    v_mfma_f32_16x16x32_bf16 v[80:83], v[128:131], v[72:75], v[80:83]
    v_mfma_f32_16x16x32_bf16 v[84:87], v[132:135], v[72:75], v[84:87]
    v_mfma_f32_16x16x32_bf16 v[88:91], v[136:139], v[72:75], v[88:91]
    v_mfma_f32_16x16x32_bf16 v[92:95], v[140:143], v[72:75], v[92:95]
    s_waitcnt vmcnt(8)
    v_mfma_f32_16x16x32_bf16 v[80:83], v[144:147], v[76:79], v[80:83]
    v_mfma_f32_16x16x32_bf16 v[84:87], v[148:151], v[76:79], v[84:87]
    v_mfma_f32_16x16x32_bf16 v[88:91], v[152:155], v[76:79], v[88:91]
    v_mfma_f32_16x16x32_bf16 v[92:95], v[156:159], v[76:79], v[92:95]
    s_add_u32 s70, s91, 0x0
    s_add_u32 s71, s95, 0xd00000
    s_nop 2
    v_cvt_pk_bf16_f32 v240, v80, v81
    v_cvt_pk_bf16_f32 v241, v82, v83
    v_cvt_pk_bf16_f32 v242, v84, v85
    v_cvt_pk_bf16_f32 v243, v86, v87
    v_cvt_pk_bf16_f32 v244, v88, v89
    v_cvt_pk_bf16_f32 v245, v90, v91
    v_cvt_pk_bf16_f32 v246, v92, v93
    v_cvt_pk_bf16_f32 v247, v94, v95
    v_permlane16_swap_b32 v240, v242
    v_permlane16_swap_b32 v241, v243
    v_permlane16_swap_b32 v244, v246
    v_permlane16_swap_b32 v245, v247
    s_cmp_eq_u32 s97, 1
    s_cbranch_scc0 slow16
    buffer_store_dwordx4 v[240:243], v250, s[24:27], s70 offen offset:0
    buffer_store_dwordx4 v[244:247], v250, s[24:27], s70 offen offset:1024
back16:
    v_pk_mul_f32 v[16:17], v[80:81], v[80:81]
    v_pk_add_f32 v[20:21], v[80:81], v[82:83]
    v_pk_fma_f32 v[16:17], v[82:83], v[82:83], v[16:17]
    v_pk_fma_f32 v[16:17], v[84:85], v[84:85], v[16:17]
    v_pk_add_f32 v[20:21], v[20:21], v[84:85]
    v_pk_fma_f32 v[16:17], v[86:87], v[86:87], v[16:17]
    v_pk_add_f32 v[20:21], v[20:21], v[86:87]
    v_pk_fma_f32 v[16:17], v[88:89], v[88:89], v[16:17]
    v_pk_add_f32 v[20:21], v[20:21], v[88:89]
    v_pk_fma_f32 v[16:17], v[90:91], v[90:91], v[16:17]
    v_pk_add_f32 v[20:21], v[20:21], v[90:91]
    v_pk_fma_f32 v[16:17], v[92:93], v[92:93], v[16:17]
    v_pk_add_f32 v[20:21], v[20:21], v[92:93]
    v_pk_fma_f32 v[16:17], v[94:95], v[94:95], v[16:17]
    v_pk_add_f32 v[20:21], v[20:21], v[94:95]
    v_add_f32 v18, v20, v21
    v_add_f32 v19, v16, v17
    s_cmp_eq_u32 s97, 1
    s_cbranch_scc0 slow17
    buffer_store_dwordx2 v[18:19], v251, s[16:19], s71 offen
back17:
    s_add_u32 s30, s72, 7
    v_mov_b32 v4, s30
    v_mov_b32 v5, s73
    s_waitcnt vmcnt(0)
    s_mov_b64 exec, 1
    s_cmp_eq_u32 s97, 1
    s_cbranch_scc0 slow18
    buffer_store_dwordx2 v[4:5], v1, s[16:19], s0 offen
back18:
    s_mov_b64 exec, -1
    global_load_dwordx4 v[100:103], v2, s[8:9]
    s_add_u32 s87, s80, 0x4000
    buffer_load_dwordx4 a[64:67], v2, s[16:19], s87 offen offset:0 sc1
    buffer_load_dwordx4 a[68:71], v2, s[16:19], s87 offen offset:1024 sc1
    buffer_load_dwordx4 a[72:75], v2, s[16:19], s87 offen offset:2048 sc1
    buffer_load_dwordx4 a[76:79], v2, s[16:19], s87 offen offset:3072 sc1
    s_add_u32 s87, s80, 0x5000
    buffer_load_dwordx4 a[80:83], v2, s[16:19], s87 offen offset:0 sc1
    buffer_load_dwordx4 a[84:87], v2, s[16:19], s87 offen offset:1024 sc1
    buffer_load_dwordx4 a[88:91], v2, s[16:19], s87 offen offset:2048 sc1
    buffer_load_dwordx4 a[92:95], v2, s[16:19], s87 offen offset:3072 sc1
    s_cmp_lg_u32 s12, 0
    s_cbranch_scc1 qa_np0
    s_mov_b32 exec_lo, 0xffffffff
    s_mov_b32 exec_hi, 0x0
    s_mov_b32 s30, 0
poll19:
    buffer_load_dwordx2 v[4:5], v253, s[16:19], 0 offen sc1
poll19_c:
    s_waitcnt vmcnt(0)
poll19_l:
    s_add_u32 s30, s30, 1
    v_subrev_u32 v4, s72, v4
    v_cmp_eq_u32 s[74:75], s73, v5
    v_cmp_gt_u32 s[76:77], 32, v4
    v_cmp_le_u32 vcc, 7, v4
    s_and_b64 s[74:75], s[74:75], s[76:77]
    s_and_b64 vcc, vcc, s[74:75]
    s_cmp_eq_u64 vcc, exec
    s_cbranch_scc1 poll19_x
    s_cmp_gt_u32 s30, 0x8000
    s_cbranch_scc0 poll19
poll19_x:
    s_mov_b64 exec, -1
qa_np0:
    s_barrier
    v_lshlrev_b32 v6, 12, v1
    v_sub_u32 v6, s29, v6
    v_subrev_u32 v6, 4096, v6
    s_min_u32 s31, s10, 4
    s_bfm_b64 s[100:101], s31, 0
    v_mov_b32 v140, s29
    s_mov_b64 s[74:75], 0x10
    v_cndmask_b32 v6, v6, v140, s[74:75]
    s_cmp_eq_u32 s100, 0
    s_cselect_b32 s100, 0x10, s100
    s_add_u32 m0, s82, 0
    s_add_u32 s86, s81, 0x0
    buffer_load_dwordx4 v2, s[24:27], s86 offen offset:0 sc1 lds
    buffer_load_dwordx4 v2, s[24:27], s86 offen offset:1024 sc1 lds
    buffer_load_dwordx4 v2, s[24:27], s86 offen offset:2048 sc1 lds
    buffer_load_dwordx4 v2, s[24:27], s86 offen offset:3072 sc1 lds
    s_add_u32 m0, s82, 4096
    s_add_u32 s86, s81, 0x1000
    buffer_load_dwordx4 v2, s[24:27], s86 offen offset:0 sc1 lds
    buffer_load_dwordx4 v2, s[24:27], s86 offen offset:1024 sc1 lds
    buffer_load_dwordx4 v2, s[24:27], s86 offen offset:2048 sc1 lds
    buffer_load_dwordx4 v2, s[24:27], s86 offen offset:3072 sc1 lds
    s_add_u32 m0, s82, 8192
    s_add_u32 s86, s81, 0x2000
    buffer_load_dwordx4 v2, s[24:27], s86 offen offset:0 sc1 lds
    buffer_load_dwordx4 v2, s[24:27], s86 offen offset:1024 sc1 lds
    buffer_load_dwordx4 v2, s[24:27], s86 offen offset:2048 sc1 lds
    buffer_load_dwordx4 v2, s[24:27], s86 offen offset:3072 sc1 lds
    s_waitcnt vmcnt(8)
    s_barrier
    ds_read_b128 v[16:19], v2 offset:0
    ds_read_b128 v[20:23], v2 offset:16384
    ds_read_b128 v[24:27], v2 offset:32768
    ds_read_b128 v[28:31], v2 offset:49152
    s_waitcnt lgkmcnt(3)
    v_mfma_f32_16x16x32_bf16 v[48:51], a[0:3], v[16:19], 0
    ds_read_b128 v[32:35], v2 offset:1024
    v_mfma_f32_16x16x32_bf16 v[64:67], v[16:19], a[4:7], 0
    s_waitcnt lgkmcnt(3)
    v_mfma_f32_16x16x32_bf16 v[52:55], a[0:3], v[20:23], 0
    ds_read_b128 v[36:39], v2 offset:17408
    v_mfma_f32_16x16x32_bf16 v[68:71], v[20:23], a[4:7], 0
    s_add_u32 m0, s82, 12288
    s_add_u32 s86, s81, 0x3000
    buffer_load_dwordx4 v2, s[24:27], s86 offen offset:0 sc1 lds
    s_waitcnt lgkmcnt(3)
    v_mfma_f32_16x16x32_bf16 v[56:59], a[0:3], v[24:27], 0
    ds_read_b128 v[40:43], v2 offset:33792
    v_mfma_f32_16x16x32_bf16 v[72:75], v[24:27], a[4:7], 0
    s_waitcnt lgkmcnt(3)
    v_mfma_f32_16x16x32_bf16 v[60:63], a[0:3], v[28:31], 0
    ds_read_b128 v[44:47], v2 offset:50176
    v_mfma_f32_16x16x32_bf16 v[76:79], v[28:31], a[4:7], 0
    buffer_load_dwordx4 v2, s[24:27], s86 offen offset:1024 sc1 lds
    s_waitcnt lgkmcnt(3)
    v_mfma_f32_16x16x32_bf16 v[48:51], a[8:11], v[32:35], v[48:51]
    ds_read_b128 v[16:19], v2 offset:2048
    v_mfma_f32_16x16x32_bf16 v[64:67], v[32:35], a[12:15], v[64:67]
    s_waitcnt lgkmcnt(3)
    v_mfma_f32_16x16x32_bf16 v[52:55], a[8:11], v[36:39], v[52:55]
    ds_read_b128 v[20:23], v2 offset:18432
    v_mfma_f32_16x16x32_bf16 v[68:71], v[36:39], a[12:15], v[68:71]
    buffer_load_dwordx4 v2, s[24:27], s86 offen offset:2048 sc1 lds
    s_waitcnt lgkmcnt(3)
    v_mfma_f32_16x16x32_bf16 v[56:59], a[8:11], v[40:43], v[56:59]
    ds_read_b128 v[24:27], v2 offset:34816
    v_mfma_f32_16x16x32_bf16 v[72:75], v[40:43], a[12:15], v[72:75]
    s_waitcnt lgkmcnt(3)
    v_mfma_f32_16x16x32_bf16 v[60:63], a[8:11], v[44:47], v[60:63]
    ds_read_b128 v[28:31], v2 offset:51200
    v_mfma_f32_16x16x32_bf16 v[76:79], v[44:47], a[12:15], v[76:79]
    buffer_load_dwordx4 v2, s[24:27], s86 offen offset:3072 sc1 lds
    s_waitcnt lgkmcnt(3)
    v_mfma_f32_16x16x32_bf16 v[48:51], a[16:19], v[16:19], v[48:51]
    ds_read_b128 v[32:35], v2 offset:3072
    v_mfma_f32_16x16x32_bf16 v[64:67], v[16:19], a[20:23], v[64:67]
    s_waitcnt lgkmcnt(3)
    v_mfma_f32_16x16x32_bf16 v[52:55], a[16:19], v[20:23], v[52:55]
    ds_read_b128 v[36:39], v2 offset:19456
    v_mfma_f32_16x16x32_bf16 v[68:71], v[20:23], a[20:23], v[68:71]
    s_add_u32 s88, s83, 0xd00000
    buffer_load_dwordx4 v[96:99], v2, s[16:19], s88 offen sc1
    s_waitcnt lgkmcnt(3)
    v_mfma_f32_16x16x32_bf16 v[56:59], a[16:19], v[24:27], v[56:59]
    ds_read_b128 v[40:43], v2 offset:35840
    v_mfma_f32_16x16x32_bf16 v[72:75], v[24:27], a[20:23], v[72:75]
    s_waitcnt lgkmcnt(3)
    v_mfma_f32_16x16x32_bf16 v[60:63], a[16:19], v[28:31], v[60:63]
    ds_read_b128 v[44:47], v2 offset:52224
    v_mfma_f32_16x16x32_bf16 v[76:79], v[28:31], a[20:23], v[76:79]
    s_add_u32 s88, s83, 0xd01000
    buffer_load_dwordx4 v[100:103], v2, s[16:19], s88 offen sc1
    s_waitcnt vmcnt(10)
    s_barrier
    s_waitcnt lgkmcnt(3)
    v_mfma_f32_16x16x32_bf16 v[48:51], a[24:27], v[32:35], v[48:51]
    ds_read_b128 v[16:19], v2 offset:4096
    v_mfma_f32_16x16x32_bf16 v[64:67], v[32:35], a[28:31], v[64:67]
    s_waitcnt lgkmcnt(3)
    v_mfma_f32_16x16x32_bf16 v[52:55], a[24:27], v[36:39], v[52:55]
    ds_read_b128 v[20:23], v2 offset:20480
    v_mfma_f32_16x16x32_bf16 v[68:71], v[36:39], a[28:31], v[68:71]
    s_add_u32 s88, s83, 0xd02000
    buffer_load_dwordx4 v[104:107], v2, s[16:19], s88 offen sc1
    s_waitcnt lgkmcnt(3)
    v_mfma_f32_16x16x32_bf16 v[56:59], a[24:27], v[40:43], v[56:59]
    ds_read_b128 v[24:27], v2 offset:36864
    v_mfma_f32_16x16x32_bf16 v[72:75], v[40:43], a[28:31], v[72:75]
    s_waitcnt lgkmcnt(3)
    v_mfma_f32_16x16x32_bf16 v[60:63], a[24:27], v[44:47], v[60:63]
    ds_read_b128 v[28:31], v2 offset:53248
    v_mfma_f32_16x16x32_bf16 v[76:79], v[44:47], a[28:31], v[76:79]
    s_add_u32 s88, s83, 0xd03000
    buffer_load_dwordx4 v[108:111], v2, s[16:19], s88 offen sc1
    s_waitcnt lgkmcnt(3)
    v_mfma_f32_16x16x32_bf16 v[48:51], a[32:35], v[16:19], v[48:51]
    ds_read_b128 v[32:35], v2 offset:5120
    v_mfma_f32_16x16x32_bf16 v[64:67], v[16:19], a[36:39], v[64:67]
    s_waitcnt lgkmcnt(3)
    v_mfma_f32_16x16x32_bf16 v[52:55], a[32:35], v[20:23], v[52:55]
    ds_read_b128 v[36:39], v2 offset:21504
    v_mfma_f32_16x16x32_bf16 v[68:71], v[20:23], a[36:39], v[68:71]
    s_add_u32 s87, s80, 0x6000
    buffer_load_dwordx4 a[96:99], v2, s[16:19], s87 offen offset:0 sc1
    s_waitcnt lgkmcnt(3)
    v_mfma_f32_16x16x32_bf16 v[56:59], a[32:35], v[24:27], v[56:59]
    ds_read_b128 v[40:43], v2 offset:37888
    v_mfma_f32_16x16x32_bf16 v[72:75], v[24:27], a[36:39], v[72:75]
    s_waitcnt lgkmcnt(3)
    v_mfma_f32_16x16x32_bf16 v[60:63], a[32:35], v[28:31], v[60:63]
    ds_read_b128 v[44:47], v2 offset:54272
    v_mfma_f32_16x16x32_bf16 v[76:79], v[28:31], a[36:39], v[76:79]
    buffer_load_dwordx4 a[100:103], v2, s[16:19], s87 offen offset:1024 sc1
    s_waitcnt lgkmcnt(3)
    v_mfma_f32_16x16x32_bf16 v[48:51], a[40:43], v[32:35], v[48:51]
    ds_read_b128 v[16:19], v2 offset:6144
    v_mfma_f32_16x16x32_bf16 v[64:67], v[32:35], a[44:47], v[64:67]
    s_waitcnt lgkmcnt(3)
    v_mfma_f32_16x16x32_bf16 v[52:55], a[40:43], v[36:39], v[52:55]
    ds_read_b128 v[20:23], v2 offset:22528
    v_mfma_f32_16x16x32_bf16 v[68:71], v[36:39], a[44:47], v[68:71]
    buffer_load_dwordx4 a[104:107], v2, s[16:19], s87 offen offset:2048 sc1
    s_waitcnt lgkmcnt(3)
    v_mfma_f32_16x16x32_bf16 v[56:59], a[40:43], v[40:43], v[56:59]
    ds_read_b128 v[24:27], v2 offset:38912
    v_mfma_f32_16x16x32_bf16 v[72:75], v[40:43], a[44:47], v[72:75]
    s_waitcnt lgkmcnt(3)
    v_mfma_f32_16x16x32_bf16 v[60:63], a[40:43], v[44:47], v[60:63]
    ds_read_b128 v[28:31], v2 offset:55296
    v_mfma_f32_16x16x32_bf16 v[76:79], v[44:47], a[44:47], v[76:79]
    buffer_load_dwordx4 a[108:111], v2, s[16:19], s87 offen offset:3072 sc1
    s_waitcnt lgkmcnt(3)
    v_mfma_f32_16x16x32_bf16 v[48:51], a[48:51], v[16:19], v[48:51]
    ds_read_b128 v[32:35], v2 offset:7168
    v_mfma_f32_16x16x32_bf16 v[64:67], v[16:19], a[52:55], v[64:67]
    s_waitcnt lgkmcnt(3)
    v_mfma_f32_16x16x32_bf16 v[52:55], a[48:51], v[20:23], v[52:55]
    ds_read_b128 v[36:39], v2 offset:23552
    v_mfma_f32_16x16x32_bf16 v[68:71], v[20:23], a[52:55], v[68:71]
    s_add_u32 s87, s80, 0x7000
    buffer_load_dwordx4 a[112:115], v2, s[16:19], s87 offen offset:0 sc1
    s_waitcnt lgkmcnt(3)
    v_mfma_f32_16x16x32_bf16 v[56:59], a[48:51], v[24:27], v[56:59]
    ds_read_b128 v[40:43], v2 offset:39936
    v_mfma_f32_16x16x32_bf16 v[72:75], v[24:27], a[52:55], v[72:75]
    s_waitcnt lgkmcnt(3)
    v_mfma_f32_16x16x32_bf16 v[60:63], a[48:51], v[28:31], v[60:63]
    ds_read_b128 v[44:47], v2 offset:56320
    v_mfma_f32_16x16x32_bf16 v[76:79], v[28:31], a[52:55], v[76:79]
    buffer_load_dwordx4 a[116:119], v2, s[16:19], s87 offen offset:1024 sc1
    s_waitcnt vmcnt(14)
    s_barrier
    s_waitcnt vmcnt(6)
    s_waitcnt lgkmcnt(3)
    v_mfma_f32_16x16x32_bf16 v[48:51], a[56:59], v[32:35], v[48:51]
    ds_read_b128 v[16:19], v2 offset:8192
    v_add_f32 v96, v96, v98
    v_mfma_f32_16x16x32_bf16 v[64:67], v[32:35], a[60:63], v[64:67]
    v_add_f32 v97, v97, v99
    s_waitcnt lgkmcnt(3)
    v_mfma_f32_16x16x32_bf16 v[52:55], a[56:59], v[36:39], v[52:55]
    ds_read_b128 v[20:23], v2 offset:24576
    v_add_f32 v96, v96, v100
    v_mfma_f32_16x16x32_bf16 v[68:71], v[36:39], a[60:63], v[68:71]
    buffer_load_dwordx4 a[120:123], v2, s[16:19], s87 offen offset:2048 sc1
    s_waitcnt lgkmcnt(3)
    v_mfma_f32_16x16x32_bf16 v[56:59], a[56:59], v[40:43], v[56:59]
    ds_read_b128 v[24:27], v2 offset:40960
    v_add_f32 v97, v97, v101
    v_mfma_f32_16x16x32_bf16 v[72:75], v[40:43], a[60:63], v[72:75]
    v_add_f32 v96, v96, v102
    s_waitcnt lgkmcnt(3)
    v_mfma_f32_16x16x32_bf16 v[60:63], a[56:59], v[44:47], v[60:63]
    ds_read_b128 v[28:31], v2 offset:57344
    v_add_f32 v97, v97, v103
    v_mfma_f32_16x16x32_bf16 v[76:79], v[44:47], a[60:63], v[76:79]
    buffer_load_dwordx4 a[124:127], v2, s[16:19], s87 offen offset:3072 sc1
    s_waitcnt lgkmcnt(3)
    v_mfma_f32_16x16x32_bf16 v[48:51], a[64:67], v[16:19], v[48:51]
    ds_read_b128 v[32:35], v2 offset:9216
    v_add_f32 v96, v96, v104
    v_mfma_f32_16x16x32_bf16 v[64:67], v[16:19], a[68:71], v[64:67]
    v_add_f32 v97, v97, v105
    s_waitcnt lgkmcnt(3)
    v_mfma_f32_16x16x32_bf16 v[52:55], a[64:67], v[20:23], v[52:55]
    ds_read_b128 v[36:39], v2 offset:25600
    v_add_f32 v96, v96, v106
    v_mfma_f32_16x16x32_bf16 v[68:71], v[20:23], a[68:71], v[68:71]
    v_add_f32 v97, v97, v107
    s_waitcnt lgkmcnt(3)
    v_mfma_f32_16x16x32_bf16 v[56:59], a[64:67], v[24:27], v[56:59]
    ds_read_b128 v[40:43], v2 offset:41984
    v_add_f32 v96, v96, v108
    v_mfma_f32_16x16x32_bf16 v[72:75], v[24:27], a[68:71], v[72:75]
    v_add_f32 v97, v97, v109
    s_waitcnt lgkmcnt(3)
    v_mfma_f32_16x16x32_bf16 v[60:63], a[64:67], v[28:31], v[60:63]
    ds_read_b128 v[44:47], v2 offset:58368
    v_add_f32 v96, v96, v110
    v_mfma_f32_16x16x32_bf16 v[76:79], v[28:31], a[68:71], v[76:79]
    v_add_f32 v97, v97, v111
    s_waitcnt lgkmcnt(3)
    v_mfma_f32_16x16x32_bf16 v[48:51], a[72:75], v[32:35], v[48:51]
    ds_read_b128 v[16:19], v2 offset:10240
    v_mov_b32 v98, v96
    v_mfma_f32_16x16x32_bf16 v[64:67], v[32:35], a[76:79], v[64:67]
    v_mov_b32 v99, v97
    s_waitcnt lgkmcnt(3)
    v_mfma_f32_16x16x32_bf16 v[52:55], a[72:75], v[36:39], v[52:55]
    ds_read_b128 v[20:23], v2 offset:26624
    v_permlane16_swap_b32 v96, v98
    v_mfma_f32_16x16x32_bf16 v[68:71], v[36:39], a[76:79], v[68:71]
    v_permlane16_swap_b32 v97, v99
    s_waitcnt lgkmcnt(3)
    v_mfma_f32_16x16x32_bf16 v[56:59], a[72:75], v[40:43], v[56:59]
    ds_read_b128 v[24:27], v2 offset:43008
    v_add_f32 v96, v96, v98
    v_mfma_f32_16x16x32_bf16 v[72:75], v[40:43], a[76:79], v[72:75]
    v_add_f32 v97, v97, v99
    s_waitcnt lgkmcnt(3)
    v_mfma_f32_16x16x32_bf16 v[60:63], a[72:75], v[44:47], v[60:63]
    ds_read_b128 v[28:31], v2 offset:59392
    v_mov_b32 v98, v96
    v_mfma_f32_16x16x32_bf16 v[76:79], v[44:47], a[76:79], v[76:79]
    v_mov_b32 v99, v97
    s_waitcnt lgkmcnt(3)
    v_mfma_f32_16x16x32_bf16 v[48:51], a[80:83], v[16:19], v[48:51]
    ds_read_b128 v[144:147], v2 offset:11264
    v_permlane32_swap_b32 v96, v98
    v_mfma_f32_16x16x32_bf16 v[64:67], v[16:19], a[84:87], v[64:67]
    v_permlane32_swap_b32 v97, v99
    s_waitcnt lgkmcnt(3)
    v_mfma_f32_16x16x32_bf16 v[52:55], a[80:83], v[20:23], v[52:55]
    ds_read_b128 v[148:151], v2 offset:27648
    v_add_f32 v96, v96, v98
    v_mfma_f32_16x16x32_bf16 v[68:71], v[20:23], a[84:87], v[68:71]
    v_add_f32 v97, v97, v99
    s_waitcnt lgkmcnt(3)
    v_mfma_f32_16x16x32_bf16 v[56:59], a[80:83], v[24:27], v[56:59]
    ds_read_b128 v[152:155], v2 offset:44032
    v_mul_f32 v96, 0x3b000000, v96
    v_mfma_f32_16x16x32_bf16 v[72:75], v[24:27], a[84:87], v[72:75]
    v_mul_f32 v97, 0x3b000000, v97
    s_waitcnt lgkmcnt(3)
    v_mfma_f32_16x16x32_bf16 v[60:63], a[80:83], v[28:31], v[60:63]
    ds_read_b128 v[156:159], v2 offset:60416
    v_fma_f32 v97, -v96, v96, v97
    v_mfma_f32_16x16x32_bf16 v[76:79], v[28:31], a[84:87], v[76:79]
    v_max_f32 v97, 0, v97
    s_barrier
    s_waitcnt lgkmcnt(3)
    v_mfma_f32_16x16x32_bf16 v[48:51], a[88:91], v[144:147], v[48:51]
    ds_read_b128 v[160:163], v2 offset:12288
    v_add_f32 v97, 0x3727c5ac, v97
    v_mfma_f32_16x16x32_bf16 v[64:67], v[144:147], a[92:95], v[64:67]
    v_rsq_f32 v97, v97
    s_waitcnt lgkmcnt(3)
    v_mfma_f32_16x16x32_bf16 v[52:55], a[88:91], v[148:151], v[52:55]
    ds_read_b128 v[164:167], v2 offset:28672
    v_lshrrev_b32 v98, 6, v0
    v_mfma_f32_16x16x32_bf16 v[68:71], v[148:151], a[92:95], v[68:71]
    v_and_b32 v99, 15, v1
    s_waitcnt lgkmcnt(3)
    v_mfma_f32_16x16x32_bf16 v[56:59], a[88:91], v[152:155], v[56:59]
    ds_read_b128 v[168:171], v2 offset:45056
    v_lshl_add_u32 v98, v98, 4, v99
    v_mfma_f32_16x16x32_bf16 v[72:75], v[152:155], a[92:95], v[72:75]
    v_lshlrev_b32 v98, 2, v98
    s_waitcnt lgkmcnt(3)
    v_mfma_f32_16x16x32_bf16 v[60:63], a[88:91], v[156:159], v[60:63]
    ds_read_b128 v[172:175], v2 offset:61440
    v_add_u32 v98, 161792, v98
    v_mfma_f32_16x16x32_bf16 v[76:79], v[156:159], a[92:95], v[76:79]
    ds_write2_b32 v98, v97, v96 offset1:64
    s_waitcnt vmcnt(6)
    s_waitcnt lgkmcnt(4)
    v_mfma_f32_16x16x32_bf16 v[48:51], a[96:99], v[160:163], v[48:51]
    ds_read_b128 v[176:179], v2 offset:13312
    v_mfma_f32_16x16x32_bf16 v[64:67], v[160:163], a[100:103], v[64:67]
    s_waitcnt lgkmcnt(4)
    v_mfma_f32_16x16x32_bf16 v[52:55], a[96:99], v[164:167], v[52:55]
    ds_read_b128 v[180:183], v2 offset:29696
    v_mfma_f32_16x16x32_bf16 v[68:71], v[164:167], a[100:103], v[68:71]
    s_waitcnt lgkmcnt(4)
    v_mfma_f32_16x16x32_bf16 v[56:59], a[96:99], v[168:171], v[56:59]
    ds_read_b128 v[184:187], v2 offset:46080
    v_mfma_f32_16x16x32_bf16 v[72:75], v[168:171], a[100:103], v[72:75]
    s_waitcnt lgkmcnt(4)
    v_mfma_f32_16x16x32_bf16 v[60:63], a[96:99], v[172:175], v[60:63]
    ds_read_b128 v[188:191], v2 offset:62464
    v_mfma_f32_16x16x32_bf16 v[76:79], v[172:175], a[100:103], v[76:79]
    s_waitcnt lgkmcnt(4)
    s_barrier
    s_waitcnt vmcnt(4)
    s_waitcnt lgkmcnt(3)
    v_mfma_f32_16x16x32_bf16 v[48:51], a[104:107], v[176:179], v[48:51]
    ds_read_b128 v[192:195], v2 offset:14336
    v_lshrrev_b32 v248, 4, v1
    v_mfma_f32_16x16x32_bf16 v[64:67], v[176:179], a[108:111], v[64:67]
    v_lshlrev_b32 v248, 4, v248
    s_waitcnt lgkmcnt(3)
    v_mfma_f32_16x16x32_bf16 v[52:55], a[104:107], v[180:183], v[52:55]
    ds_read_b128 v[196:199], v2 offset:30720
    v_add_u32 v248, 161792, v248
    v_mfma_f32_16x16x32_bf16 v[68:71], v[180:183], a[108:111], v[68:71]
    v_and_b32 v249, 15, v1
    s_waitcnt lgkmcnt(3)
    v_mfma_f32_16x16x32_bf16 v[56:59], a[104:107], v[184:187], v[56:59]
    ds_read_b128 v[200:203], v2 offset:47104
    v_lshlrev_b32 v249, 2, v249
    v_mfma_f32_16x16x32_bf16 v[72:75], v[184:187], a[108:111], v[72:75]
    v_add_u32 v249, 161792, v249
    s_waitcnt lgkmcnt(3)
    v_mfma_f32_16x16x32_bf16 v[60:63], a[104:107], v[188:191], v[60:63]
    ds_read_b128 v[204:207], v2 offset:63488
    ds_read2_b32 v[128:129], v249 offset0:0 offset1:64
    v_mfma_f32_16x16x32_bf16 v[76:79], v[188:191], a[108:111], v[76:79]
    ds_read2_b32 v[130:131], v249 offset0:16 offset1:80
    s_waitcnt vmcnt(2)
    s_waitcnt lgkmcnt(5)
    v_mfma_f32_16x16x32_bf16 v[48:51], a[112:115], v[192:195], v[48:51]
    ds_read_b128 v[208:211], v2 offset:15360
    ds_read2_b32 v[132:133], v249 offset0:32 offset1:96
    v_mfma_f32_16x16x32_bf16 v[64:67], v[192:195], a[116:119], v[64:67]
    ds_read2_b32 v[134:135], v249 offset0:48 offset1:112
    s_waitcnt lgkmcnt(7)
    v_mfma_f32_16x16x32_bf16 v[52:55], a[112:115], v[196:199], v[52:55]
    ds_read_b128 v[212:215], v2 offset:31744
    ds_read_b128 v[112:115], v248 offset:0
    v_mfma_f32_16x16x32_bf16 v[68:71], v[196:199], a[116:119], v[68:71]
    ds_read_b128 v[116:119], v248 offset:64
    s_waitcnt lgkmcnt(9)
    v_mfma_f32_16x16x32_bf16 v[56:59], a[112:115], v[200:203], v[56:59]
    ds_read_b128 v[216:219], v2 offset:48128
    ds_read_b128 v[120:123], v248 offset:128
    v_mfma_f32_16x16x32_bf16 v[72:75], v[200:203], a[116:119], v[72:75]
    ds_read_b128 v[124:127], v248 offset:192
    s_waitcnt lgkmcnt(11)
    v_mfma_f32_16x16x32_bf16 v[60:63], a[112:115], v[204:207], v[60:63]
    ds_read_b128 v[220:223], v2 offset:64512
    ds_read_b128 v[96:99], v248 offset:256
    v_mfma_f32_16x16x32_bf16 v[76:79], v[204:207], a[116:119], v[76:79]
    ds_read_b128 v[100:103], v248 offset:320
    s_waitcnt vmcnt(0)
    s_waitcnt lgkmcnt(11)
    v_mfma_f32_16x16x32_bf16 v[48:51], a[120:123], v[208:211], v[48:51]
    ds_read_b128 v[104:107], v248 offset:384
    v_mfma_f32_16x16x32_bf16 v[64:67], v[208:211], a[124:127], v[64:67]
    ds_read_b128 v[108:111], v248 offset:448
    s_waitcnt lgkmcnt(10)
    v_mfma_f32_16x16x32_bf16 v[52:55], a[120:123], v[212:215], v[52:55]
    s_mul_i32 s31, s12, 192
    v_mfma_f32_16x16x32_bf16 v[68:71], v[212:215], a[124:127], v[68:71]
    v_add_u32 v248, s31, v248
    s_waitcnt lgkmcnt(7)
    v_mfma_f32_16x16x32_bf16 v[56:59], a[120:123], v[216:219], v[56:59]
    v_add_u32 v249, s31, v249
    v_mfma_f32_16x16x32_bf16 v[72:75], v[216:219], a[124:127], v[72:75]
    s_waitcnt lgkmcnt(4)
    v_mfma_f32_16x16x32_bf16 v[60:63], a[120:123], v[220:223], v[60:63]
    v_mfma_f32_16x16x32_bf16 v[76:79], v[220:223], a[124:127], v[76:79]
    ds_read_b128 v[136:139], v248 offset:576
    ds_read_b32 v140, v249 offset:640
    s_waitcnt lgkmcnt(1)
    v_pk_fma_f32 v[48:49], v[136:137], v[128:129], v[48:49] op_sel:[0,1,0] op_sel_hi:[1,1,1] neg_lo:[1,0,0] neg_hi:[1,0,0]
    v_pk_fma_f32 v[50:51], v[138:139], v[128:129], v[50:51] op_sel:[0,1,0] op_sel_hi:[1,1,1] neg_lo:[1,0,0] neg_hi:[1,0,0]
    v_pk_fma_f32 v[52:53], v[136:137], v[130:131], v[52:53] op_sel:[0,1,0] op_sel_hi:[1,1,1] neg_lo:[1,0,0] neg_hi:[1,0,0]
    v_pk_fma_f32 v[54:55], v[138:139], v[130:131], v[54:55] op_sel:[0,1,0] op_sel_hi:[1,1,1] neg_lo:[1,0,0] neg_hi:[1,0,0]
    v_pk_fma_f32 v[56:57], v[136:137], v[132:133], v[56:57] op_sel:[0,1,0] op_sel_hi:[1,1,1] neg_lo:[1,0,0] neg_hi:[1,0,0]
    v_pk_fma_f32 v[58:59], v[138:139], v[132:133], v[58:59] op_sel:[0,1,0] op_sel_hi:[1,1,1] neg_lo:[1,0,0] neg_hi:[1,0,0]
    v_pk_fma_f32 v[60:61], v[136:137], v[134:135], v[60:61] op_sel:[0,1,0] op_sel_hi:[1,1,1] neg_lo:[1,0,0] neg_hi:[1,0,0]
    v_pk_fma_f32 v[62:63], v[138:139], v[134:135], v[62:63] op_sel:[0,1,0] op_sel_hi:[1,1,1] neg_lo:[1,0,0] neg_hi:[1,0,0]
    v_pk_mul_f32 v[48:49], v[48:49], v[128:129] op_sel_hi:[1,0]
    v_pk_mul_f32 v[50:51], v[50:51], v[128:129] op_sel_hi:[1,0]
    v_pk_mul_f32 v[52:53], v[52:53], v[130:131] op_sel_hi:[1,0]
    v_pk_mul_f32 v[54:55], v[54:55], v[130:131] op_sel_hi:[1,0]
    v_pk_mul_f32 v[56:57], v[56:57], v[132:133] op_sel_hi:[1,0]
    v_pk_mul_f32 v[58:59], v[58:59], v[132:133] op_sel_hi:[1,0]
    v_pk_mul_f32 v[60:61], v[60:61], v[134:135] op_sel_hi:[1,0]
    v_pk_mul_f32 v[62:63], v[62:63], v[134:135] op_sel_hi:[1,0]
    v_cvt_pk_bf16_f32 v240, v48, v49
    v_cvt_pk_bf16_f32 v241, v50, v51
    v_cvt_pk_bf16_f32 v242, v52, v53
    v_cvt_pk_bf16_f32 v243, v54, v55
    v_cvt_pk_bf16_f32 v244, v56, v57
    v_cvt_pk_bf16_f32 v245, v58, v59
    v_cvt_pk_bf16_f32 v246, v60, v61
    v_cvt_pk_bf16_f32 v247, v62, v63
    v_permlane16_swap_b32 v240, v242
    v_permlane16_swap_b32 v241, v243
    v_permlane16_swap_b32 v244, v246
    v_permlane16_swap_b32 v245, v247
    s_add_u32 s64, s84, 0x500000
    buffer_store_dwordx4 v[240:243], v2, s[16:19], s64 offen offset:0 sc1
    buffer_store_dwordx4 v[244:247], v2, s[16:19], s64 offen offset:1024 sc1
    s_waitcnt lgkmcnt(0)
    v_pk_fma_f32 v[64:65], v[96:97], v[140:141], v[64:65] op_sel_hi:[1,0,1] neg_lo:[1,0,0] neg_hi:[1,0,0]
    v_pk_fma_f32 v[66:67], v[98:99], v[140:141], v[66:67] op_sel_hi:[1,0,1] neg_lo:[1,0,0] neg_hi:[1,0,0]
    v_pk_fma_f32 v[68:69], v[100:101], v[140:141], v[68:69] op_sel_hi:[1,0,1] neg_lo:[1,0,0] neg_hi:[1,0,0]
    v_pk_fma_f32 v[70:71], v[102:103], v[140:141], v[70:71] op_sel_hi:[1,0,1] neg_lo:[1,0,0] neg_hi:[1,0,0]
    v_pk_fma_f32 v[72:73], v[104:105], v[140:141], v[72:73] op_sel_hi:[1,0,1] neg_lo:[1,0,0] neg_hi:[1,0,0]
    v_pk_fma_f32 v[74:75], v[106:107], v[140:141], v[74:75] op_sel_hi:[1,0,1] neg_lo:[1,0,0] neg_hi:[1,0,0]
    v_pk_fma_f32 v[76:77], v[108:109], v[140:141], v[76:77] op_sel_hi:[1,0,1] neg_lo:[1,0,0] neg_hi:[1,0,0]
    v_pk_fma_f32 v[78:79], v[110:111], v[140:141], v[78:79] op_sel_hi:[1,0,1] neg_lo:[1,0,0] neg_hi:[1,0,0]
    v_pk_mul_f32 v[64:65], v[64:65], v[112:113]
    v_pk_mul_f32 v[66:67], v[66:67], v[114:115]
    v_pk_mul_f32 v[68:69], v[68:69], v[116:117]
    v_pk_mul_f32 v[70:71], v[70:71], v[118:119]
    v_pk_mul_f32 v[72:73], v[72:73], v[120:121]
    v_pk_mul_f32 v[74:75], v[74:75], v[122:123]
    v_pk_mul_f32 v[76:77], v[76:77], v[124:125]
    v_pk_mul_f32 v[78:79], v[78:79], v[126:127]
    v_cvt_pk_bf16_f32 v232, v64, v65
    v_cvt_pk_bf16_f32 v233, v66, v67
    v_cvt_pk_bf16_f32 v234, v68, v69
    v_cvt_pk_bf16_f32 v235, v70, v71
    v_cvt_pk_bf16_f32 v236, v72, v73
    v_cvt_pk_bf16_f32 v237, v74, v75
    v_cvt_pk_bf16_f32 v238, v76, v77
    v_cvt_pk_bf16_f32 v239, v78, v79
    v_permlane16_swap_b32 v232, v234
    v_permlane16_swap_b32 v233, v235
    v_permlane16_swap_b32 v236, v238
    v_permlane16_swap_b32 v237, v239
    v_permlane32_swap_b32 v232, v234
    v_permlane32_swap_b32 v233, v235
    v_permlane32_swap_b32 v236, v238
    v_permlane32_swap_b32 v237, v239
    s_add_u32 s65, s84, 0x700000
    buffer_store_dwordx4 v[232:235], v2, s[16:19], s65 offen offset:0 sc1
    buffer_store_dwordx4 v[236:239], v2, s[16:19], s65 offen offset:1024 sc1
    s_mov_b32 s89, 0
    v_mfma_f32_16x16x32_bf16 v[80:83], a[236:239], v[144:147], 0
    ds_read_b128 v[16:19], v2 offset:0
    v_mfma_f32_16x16x32_bf16 v[84:87], a[236:239], v[148:151], 0
    ds_read_b128 v[20:23], v2 offset:16384
    v_mfma_f32_16x16x32_bf16 v[88:91], a[236:239], v[152:155], 0
    ds_read_b128 v[24:27], v2 offset:32768
    v_mfma_f32_16x16x32_bf16 v[92:95], a[236:239], v[156:159], 0
    ds_read_b128 v[28:31], v2 offset:49152
    v_mfma_f32_16x16x32_bf16 v[80:83], a[240:243], v[160:163], v[80:83]
    ds_read_b128 v[32:35], v2 offset:1024
    v_mfma_f32_16x16x32_bf16 v[84:87], a[240:243], v[164:167], v[84:87]
    ds_read_b128 v[36:39], v2 offset:17408
    v_mfma_f32_16x16x32_bf16 v[88:91], a[240:243], v[168:171], v[88:91]
    ds_read_b128 v[40:43], v2 offset:33792
    v_mfma_f32_16x16x32_bf16 v[92:95], a[240:243], v[172:175], v[92:95]
    ds_read_b128 v[44:47], v2 offset:50176
    v_mfma_f32_16x16x32_bf16 v[80:83], a[244:247], v[176:179], v[80:83]
    ds_read_b128 v[48:51], v2 offset:2048
    v_mfma_f32_16x16x32_bf16 v[84:87], a[244:247], v[180:183], v[84:87]
    ds_read_b128 v[52:55], v2 offset:18432
    v_mfma_f32_16x16x32_bf16 v[88:91], a[244:247], v[184:187], v[88:91]
    ds_read_b128 v[56:59], v2 offset:34816
    v_mfma_f32_16x16x32_bf16 v[92:95], a[244:247], v[188:191], v[92:95]
    ds_read_b128 v[60:63], v2 offset:51200
    v_mfma_f32_16x16x32_bf16 v[80:83], a[248:251], v[192:195], v[80:83]
    v_mfma_f32_16x16x32_bf16 v[84:87], a[248:251], v[196:199], v[84:87]
    v_mfma_f32_16x16x32_bf16 v[88:91], a[248:251], v[200:203], v[88:91]
    v_mfma_f32_16x16x32_bf16 v[92:95], a[248:251], v[204:207], v[92:95]
    v_mfma_f32_16x16x32_bf16 v[80:83], a[252:255], v[208:211], v[80:83]
    v_mfma_f32_16x16x32_bf16 v[84:87], a[252:255], v[212:215], v[84:87]
    v_mfma_f32_16x16x32_bf16 v[88:91], a[252:255], v[216:219], v[88:91]
    v_mfma_f32_16x16x32_bf16 v[92:95], a[252:255], v[220:223], v[92:95]
    s_waitcnt lgkmcnt(8)
    v_mfma_f32_16x16x32_bf16 v[80:83], a[192:195], v[16:19], v[80:83]
    ds_read_b128 v[16:19], v2 offset:3072
    v_mfma_f32_16x16x32_bf16 v[84:87], a[192:195], v[20:23], v[84:87]
    ds_read_b128 v[20:23], v2 offset:19456
    v_mfma_f32_16x16x32_bf16 v[88:91], a[192:195], v[24:27], v[88:91]
    ds_read_b128 v[24:27], v2 offset:35840
    v_mfma_f32_16x16x32_bf16 v[92:95], a[192:195], v[28:31], v[92:95]
    ds_read_b128 v[28:31], v2 offset:52224
    s_waitcnt lgkmcnt(8)
    v_mfma_f32_16x16x32_bf16 v[80:83], a[196:199], v[32:35], v[80:83]
    ds_read_b128 v[32:35], v2 offset:4096
    v_mfma_f32_16x16x32_bf16 v[84:87], a[196:199], v[36:39], v[84:87]
    ds_read_b128 v[36:39], v2 offset:20480
    v_mfma_f32_16x16x32_bf16 v[88:91], a[196:199], v[40:43], v[88:91]
    ds_read_b128 v[40:43], v2 offset:36864
    v_mfma_f32_16x16x32_bf16 v[92:95], a[196:199], v[44:47], v[92:95]
    ds_read_b128 v[44:47], v2 offset:53248
    s_waitcnt lgkmcnt(8)
    v_mfma_f32_16x16x32_bf16 v[80:83], a[200:203], v[48:51], v[80:83]
    ds_read_b128 v[48:51], v2 offset:5120
    v_mfma_f32_16x16x32_bf16 v[84:87], a[200:203], v[52:55], v[84:87]
    ds_read_b128 v[52:55], v2 offset:21504
    v_mfma_f32_16x16x32_bf16 v[88:91], a[200:203], v[56:59], v[88:91]
    ds_read_b128 v[56:59], v2 offset:37888
    v_mfma_f32_16x16x32_bf16 v[92:95], a[200:203], v[60:63], v[92:95]
    ds_read_b128 v[60:63], v2 offset:54272
    s_waitcnt lgkmcnt(8)
    v_mfma_f32_16x16x32_bf16 v[80:83], a[204:207], v[16:19], v[80:83]
    ds_read_b128 v[16:19], v2 offset:6144
    v_mfma_f32_16x16x32_bf16 v[84:87], a[204:207], v[20:23], v[84:87]
    ds_read_b128 v[20:23], v2 offset:22528
    v_mfma_f32_16x16x32_bf16 v[88:91], a[204:207], v[24:27], v[88:91]
    ds_read_b128 v[24:27], v2 offset:38912
    v_mfma_f32_16x16x32_bf16 v[92:95], a[204:207], v[28:31], v[92:95]
    ds_read_b128 v[28:31], v2 offset:55296
    s_waitcnt vmcnt(0)
    s_add_u32 s30, s72, 9
    v_mov_b32 v4, s30
    v_mov_b32 v5, s73
    s_mov_b64 exec, 1
    buffer_store_dwordx2 v[4:5], v1, s[16:19], s29 offen sc1
    s_mov_b64 exec, -1
    s_waitcnt lgkmcnt(8)
    v_mfma_f32_16x16x32_bf16 v[80:83], a[208:211], v[32:35], v[80:83]
    ds_read_b128 v[32:35], v2 offset:7168
    v_mfma_f32_16x16x32_bf16 v[84:87], a[208:211], v[36:39], v[84:87]
    ds_read_b128 v[36:39], v2 offset:23552
    v_mfma_f32_16x16x32_bf16 v[88:91], a[208:211], v[40:43], v[88:91]
    ds_read_b128 v[40:43], v2 offset:39936
    v_mfma_f32_16x16x32_bf16 v[92:95], a[208:211], v[44:47], v[92:95]
    ds_read_b128 v[44:47], v2 offset:56320
    s_waitcnt lgkmcnt(8)
    v_mfma_f32_16x16x32_bf16 v[80:83], a[212:215], v[48:51], v[80:83]
    ds_read_b128 v[48:51], v2 offset:8192
    v_mfma_f32_16x16x32_bf16 v[84:87], a[212:215], v[52:55], v[84:87]
    ds_read_b128 v[52:55], v2 offset:24576
    v_mfma_f32_16x16x32_bf16 v[88:91], a[212:215], v[56:59], v[88:91]
    ds_read_b128 v[56:59], v2 offset:40960
    v_mfma_f32_16x16x32_bf16 v[92:95], a[212:215], v[60:63], v[92:95]
    ds_read_b128 v[60:63], v2 offset:57344
    s_waitcnt lgkmcnt(8)
    v_mfma_f32_16x16x32_bf16 v[80:83], a[216:219], v[16:19], v[80:83]
    ds_read_b128 v[16:19], v2 offset:9216
    v_mfma_f32_16x16x32_bf16 v[84:87], a[216:219], v[20:23], v[84:87]
    ds_read_b128 v[20:23], v2 offset:25600
    v_mfma_f32_16x16x32_bf16 v[88:91], a[216:219], v[24:27], v[88:91]
    ds_read_b128 v[24:27], v2 offset:41984
    v_mfma_f32_16x16x32_bf16 v[92:95], a[216:219], v[28:31], v[92:95]
    ds_read_b128 v[28:31], v2 offset:58368
    s_waitcnt lgkmcnt(8)
    v_mfma_f32_16x16x32_bf16 v[80:83], a[220:223], v[32:35], v[80:83]
    ds_read_b128 v[32:35], v2 offset:10240
    v_mfma_f32_16x16x32_bf16 v[84:87], a[220:223], v[36:39], v[84:87]
    ds_read_b128 v[36:39], v2 offset:26624
    v_mfma_f32_16x16x32_bf16 v[88:91], a[220:223], v[40:43], v[88:91]
    ds_read_b128 v[40:43], v2 offset:43008
    v_mfma_f32_16x16x32_bf16 v[92:95], a[220:223], v[44:47], v[92:95]
    ds_read_b128 v[44:47], v2 offset:59392
    s_waitcnt lgkmcnt(8)
    v_mfma_f32_16x16x32_bf16 v[80:83], a[224:227], v[48:51], v[80:83]
    v_mfma_f32_16x16x32_bf16 v[84:87], a[224:227], v[52:55], v[84:87]
    v_mfma_f32_16x16x32_bf16 v[88:91], a[224:227], v[56:59], v[88:91]
    v_mfma_f32_16x16x32_bf16 v[92:95], a[224:227], v[60:63], v[92:95]
    s_waitcnt lgkmcnt(4)
    v_mfma_f32_16x16x32_bf16 v[80:83], a[228:231], v[16:19], v[80:83]
    v_mfma_f32_16x16x32_bf16 v[84:87], a[228:231], v[20:23], v[84:87]
    v_mfma_f32_16x16x32_bf16 v[88:91], a[228:231], v[24:27], v[88:91]
    v_mfma_f32_16x16x32_bf16 v[92:95], a[228:231], v[28:31], v[92:95]
    s_waitcnt lgkmcnt(0)
    v_mfma_f32_16x16x32_bf16 v[80:83], a[232:235], v[32:35], v[80:83]
    v_mfma_f32_16x16x32_bf16 v[84:87], a[232:235], v[36:39], v[84:87]
    v_mfma_f32_16x16x32_bf16 v[88:91], a[232:235], v[40:43], v[88:91]
    v_mfma_f32_16x16x32_bf16 v[92:95], a[232:235], v[44:47], v[92:95]
    s_mov_b64 exec, s[100:101]
    buffer_load_dwordx2 v[142:143], v6, s[16:19], 0 offen sc1
    s_mov_b64 exec, -1
    ds_read_b128 v[136:139], v248 offset:512
    s_waitcnt lgkmcnt(0)
    v_pk_fma_f32 v[80:81], v[136:137], v[128:129], v[80:81] op_sel:[0,1,0] op_sel_hi:[1,1,1] neg_lo:[1,0,0] neg_hi:[1,0,0]
    v_pk_fma_f32 v[82:83], v[138:139], v[128:129], v[82:83] op_sel:[0,1,0] op_sel_hi:[1,1,1] neg_lo:[1,0,0] neg_hi:[1,0,0]
    v_pk_fma_f32 v[84:85], v[136:137], v[130:131], v[84:85] op_sel:[0,1,0] op_sel_hi:[1,1,1] neg_lo:[1,0,0] neg_hi:[1,0,0]
    v_pk_fma_f32 v[86:87], v[138:139], v[130:131], v[86:87] op_sel:[0,1,0] op_sel_hi:[1,1,1] neg_lo:[1,0,0] neg_hi:[1,0,0]
    v_pk_fma_f32 v[88:89], v[136:137], v[132:133], v[88:89] op_sel:[0,1,0] op_sel_hi:[1,1,1] neg_lo:[1,0,0] neg_hi:[1,0,0]
    v_pk_fma_f32 v[90:91], v[138:139], v[132:133], v[90:91] op_sel:[0,1,0] op_sel_hi:[1,1,1] neg_lo:[1,0,0] neg_hi:[1,0,0]
    v_pk_fma_f32 v[92:93], v[136:137], v[134:135], v[92:93] op_sel:[0,1,0] op_sel_hi:[1,1,1] neg_lo:[1,0,0] neg_hi:[1,0,0]
    v_pk_fma_f32 v[94:95], v[138:139], v[134:135], v[94:95] op_sel:[0,1,0] op_sel_hi:[1,1,1] neg_lo:[1,0,0] neg_hi:[1,0,0]
    v_pk_mul_f32 v[80:81], v[80:81], v[128:129] op_sel_hi:[1,0]
    v_pk_mul_f32 v[82:83], v[82:83], v[128:129] op_sel_hi:[1,0]
    v_pk_mul_f32 v[84:85], v[84:85], v[130:131] op_sel_hi:[1,0]
    v_pk_mul_f32 v[86:87], v[86:87], v[130:131] op_sel_hi:[1,0]
    v_pk_mul_f32 v[88:89], v[88:89], v[132:133] op_sel_hi:[1,0]
    v_pk_mul_f32 v[90:91], v[90:91], v[132:133] op_sel_hi:[1,0]
    v_pk_mul_f32 v[92:93], v[92:93], v[134:135] op_sel_hi:[1,0]
    v_pk_mul_f32 v[94:95], v[94:95], v[134:135] op_sel_hi:[1,0]
    v_cvt_pk_bf16_f32 v248, v80, v81
    v_cvt_pk_bf16_f32 v249, v82, v83
    v_cvt_pk_bf16_f32 v250, v84, v85
    v_cvt_pk_bf16_f32 v251, v86, v87
    v_cvt_pk_bf16_f32 v252, v88, v89
    v_cvt_pk_bf16_f32 v253, v90, v91
    v_cvt_pk_bf16_f32 v254, v92, v93
    v_cvt_pk_bf16_f32 v255, v94, v95
    v_permlane16_swap_b32 v248, v250
    v_permlane16_swap_b32 v249, v251
    v_permlane16_swap_b32 v252, v254
    v_permlane16_swap_b32 v253, v255
    v_mov_b32 v16, 0x3f803f80
    v_mov_b32 v224, v16
    v_mov_b32 v225, v16
    v_mov_b32 v226, v16
    v_mov_b32 v227, v16
    v_mov_b32 v228, v16
    v_mov_b32 v229, v16
    v_mov_b32 v230, v16
    v_mov_b32 v231, v16
    v_permlane16_swap_b32 v232, v224
    v_permlane16_swap_b32 v233, v225
    v_permlane16_swap_b32 v234, v226
    v_permlane16_swap_b32 v235, v227
    v_permlane16_swap_b32 v236, v228
    v_permlane16_swap_b32 v237, v229
    v_permlane16_swap_b32 v238, v230
    v_permlane16_swap_b32 v239, v231
    s_cmp_ge_u32 s10, 4
    s_cselect_b32 s4, 0, 0xf149f2ca
    s_cselect_b32 s31, 0x3f803f80, 0
    v_mov_b32 v21, s31
    v_accvgpr_write_b32 a128, v21
    v_accvgpr_write_b32 a129, v21
    v_accvgpr_write_b32 a130, v21
    v_accvgpr_write_b32 a131, v21
    v_accvgpr_write_b32 a132, v21
    v_accvgpr_write_b32 a133, v21
    v_accvgpr_write_b32 a134, v21
    v_accvgpr_write_b32 a135, v21
    v_accvgpr_write_b32 a136, v21
    v_accvgpr_write_b32 a137, v21
    v_accvgpr_write_b32 a138, v21
    v_accvgpr_write_b32 a139, v21
    v_accvgpr_write_b32 a140, v21
    v_accvgpr_write_b32 a141, v21
    v_accvgpr_write_b32 a142, v21
    v_accvgpr_write_b32 a143, v21
    s_cmp_ge_u32 s10, 3
    s_cselect_b32 s5, 0, 0xf149f2ca
    s_cselect_b32 s31, 0x3f803f80, 0
    v_mov_b32 v21, s31
    v_accvgpr_write_b32 a144, v21
    v_accvgpr_write_b32 a145, v21
    v_accvgpr_write_b32 a146, v21
    v_accvgpr_write_b32 a147, v21
    v_accvgpr_write_b32 a148, v21
    v_accvgpr_write_b32 a149, v21
    v_accvgpr_write_b32 a150, v21
    v_accvgpr_write_b32 a151, v21
    v_accvgpr_write_b32 a152, v21
    v_accvgpr_write_b32 a153, v21
    v_accvgpr_write_b32 a154, v21
    v_accvgpr_write_b32 a155, v21
    v_accvgpr_write_b32 a156, v21
    v_accvgpr_write_b32 a157, v21
    v_accvgpr_write_b32 a158, v21
    v_accvgpr_write_b32 a159, v21
    s_cmp_ge_u32 s10, 2
    s_cselect_b32 s6, 0, 0xf149f2ca
    s_cselect_b32 s31, 0x3f803f80, 0
    v_mov_b32 v21, s31
    v_accvgpr_write_b32 a160, v21
    v_accvgpr_write_b32 a161, v21
    v_accvgpr_write_b32 a162, v21
    v_accvgpr_write_b32 a163, v21
    v_accvgpr_write_b32 a164, v21
    v_accvgpr_write_b32 a165, v21
    v_accvgpr_write_b32 a166, v21
    v_accvgpr_write_b32 a167, v21
    v_accvgpr_write_b32 a168, v21
    v_accvgpr_write_b32 a169, v21
    v_accvgpr_write_b32 a170, v21
    v_accvgpr_write_b32 a171, v21
    v_accvgpr_write_b32 a172, v21
    v_accvgpr_write_b32 a173, v21
    v_accvgpr_write_b32 a174, v21
    v_accvgpr_write_b32 a175, v21
    s_cmp_ge_u32 s10, 1
    s_cselect_b32 s7, 0, 0xf149f2ca
    s_cselect_b32 s31, 0x3f803f80, 0
    v_mov_b32 v21, s31
    v_accvgpr_write_b32 a176, v21
    v_accvgpr_write_b32 a177, v21
    v_accvgpr_write_b32 a178, v21
    v_accvgpr_write_b32 a179, v21
    v_accvgpr_write_b32 a180, v21
    v_accvgpr_write_b32 a181, v21
    v_accvgpr_write_b32 a182, v21
    v_accvgpr_write_b32 a183, v21
    v_accvgpr_write_b32 a184, v21
    v_accvgpr_write_b32 a185, v21
    v_accvgpr_write_b32 a186, v21
    v_accvgpr_write_b32 a187, v21
    v_accvgpr_write_b32 a188, v21
    v_accvgpr_write_b32 a189, v21
    v_accvgpr_write_b32 a190, v21
    v_accvgpr_write_b32 a191, v21
    s_cmp_lg_u32 s89, 0
    s_cbranch_scc1 kt20
    s_waitcnt vmcnt(0)
    s_mov_b64 exec, s[100:101]
    s_mov_b32 s30, 0
    s_branch poll21_l
poll21:
    buffer_load_dwordx2 v[142:143], v6, s[16:19], 0 offen sc1
poll21_c:
    s_waitcnt vmcnt(0)
poll21_l:
    s_add_u32 s30, s30, 1
    v_subrev_u32 v142, s72, v142
    v_cmp_eq_u32 s[74:75], s73, v143
    v_cmp_gt_u32 s[76:77], 32, v142
    v_cmp_le_u32 vcc, 9, v142
    s_and_b64 s[74:75], s[74:75], s[76:77]
    s_and_b64 vcc, vcc, s[74:75]
    s_cmp_eq_u64 vcc, exec
    s_cbranch_scc1 poll21_x
    s_cmp_gt_u32 s30, 0x8000
    s_cbranch_scc0 poll21
poll21_x:
    s_mov_b64 exec, -1
    s_mov_b32 s89, 1
    s_add_u32 s64, s84, 0x4fe000
    s_cmp_ge_u32 s10, 4
    s_cselect_b32 s64, s64, 0x7fff0000
    s_add_u32 s65, s84, 0x4fe800
    s_cmp_ge_u32 s10, 3
    s_cselect_b32 s65, s65, 0x7fff0000
    s_add_u32 s66, s84, 0x4ff000
    s_cmp_ge_u32 s10, 2
    s_cselect_b32 s66, s66, 0x7fff0000
    s_add_u32 s67, s84, 0x4ff800
    s_cmp_ge_u32 s10, 1
    s_cselect_b32 s67, s67, 0x7fff0000
    buffer_load_dwordx4 v[192:195], v2, s[16:19], s64 offen offset:0 sc1
    buffer_load_dwordx4 v[196:199], v2, s[16:19], s64 offen offset:1024 sc1
    buffer_load_dwordx4 v[200:203], v2, s[16:19], s65 offen offset:0 sc1
    buffer_load_dwordx4 v[204:207], v2, s[16:19], s65 offen offset:1024 sc1
    buffer_load_dwordx4 v[208:211], v2, s[16:19], s66 offen offset:0 sc1
    buffer_load_dwordx4 v[212:215], v2, s[16:19], s66 offen offset:1024 sc1
    buffer_load_dwordx4 v[216:219], v2, s[16:19], s67 offen offset:0 sc1
    buffer_load_dwordx4 v[220:223], v2, s[16:19], s67 offen offset:1024 sc1
kt20:
    v_mfma_f32_32x32x16_bf16 v[176:191], v[240:243], v[248:251], 0
    s_waitcnt vmcnt(7)
    v_mfma_f32_32x32x16_bf16 v[48:63], v[192:195], v[248:251], 0
    s_waitcnt vmcnt(6)
    v_mfma_f32_32x32x16_bf16 v[64:79], v[196:199], v[248:251], 0
    s_waitcnt vmcnt(5)
    v_mfma_f32_32x32x16_bf16 v[80:95], v[200:203], v[248:251], 0
    s_cmp_ge_u32 s10, 4
    s_cbranch_scc1 mg10
    s_nop 11
    v_mov_b32 v48, s4
    v_mov_b32 v49, s4
    v_mov_b32 v50, s4
    v_mov_b32 v51, s4
    v_mov_b32 v52, s4
    v_mov_b32 v53, s4
    v_mov_b32 v54, s4
    v_mov_b32 v55, s4
    v_mov_b32 v56, s4
    v_mov_b32 v57, s4
    v_mov_b32 v58, s4
    v_mov_b32 v59, s4
    v_mov_b32 v60, s4
    v_mov_b32 v61, s4
    v_mov_b32 v62, s4
    v_mov_b32 v63, s4
mg10:
    s_nop 5
    v_cndmask_b32 v48, v48, v176, s[32:33]
    v_cndmask_b32 v49, v49, v177, s[34:35]
    v_cndmask_b32 v50, v50, v178, s[36:37]
    v_cndmask_b32 v51, v51, v179, s[38:39]
    v_cndmask_b32 v52, v52, v180, s[40:41]
    v_cndmask_b32 v53, v53, v181, s[42:43]
    v_cndmask_b32 v54, v54, v182, s[44:45]
    v_cndmask_b32 v55, v55, v183, s[46:47]
    v_cndmask_b32 v56, v56, v184, s[48:49]
    v_cndmask_b32 v57, v57, v185, s[50:51]
    v_cndmask_b32 v58, v58, v186, s[52:53]
    v_cndmask_b32 v59, v59, v187, s[54:55]
    v_cndmask_b32 v60, v60, v188, s[56:57]
    v_cndmask_b32 v61, v61, v189, s[58:59]
    v_cndmask_b32 v62, v62, v190, s[60:61]
    v_cndmask_b32 v63, v63, v191, s[62:63]
    s_waitcnt vmcnt(4)
    v_mfma_f32_32x32x16_bf16 v[96:111], v[204:207], v[248:251], 0
    v_max3_f32 v32, v48, v49, v50
    v_max3_f32 v32, v32, v51, v52
    v_max3_f32 v32, v32, v53, v54
    v_max3_f32 v32, v32, v55, v56
    v_max3_f32 v32, v32, v57, v58
    v_max3_f32 v32, v32, v59, v60
    v_max3_f32 v32, v32, v61, v62
    v_max_f32 v32, v32, v63
    s_waitcnt vmcnt(3)
    v_mfma_f32_32x32x16_bf16 v[112:127], v[208:211], v[248:251], 0
    v_max3_f32 v37, v64, v65, v66
    v_max3_f32 v37, v37, v67, v68
    v_max3_f32 v37, v37, v69, v70
    v_max3_f32 v37, v37, v71, v72
    v_max3_f32 v37, v37, v73, v74
    v_max3_f32 v37, v37, v75, v76
    v_max3_f32 v37, v37, v77, v78
    v_max_f32 v37, v37, v79
    v_add_f32 v37, s4, v37
    v_max_f32 v32, v32, v37
    s_add_u32 s88, s84, 0x6fe000
    s_cmp_ge_u32 s10, 4
    s_cselect_b32 s88, s88, 0x7fff0000
    s_mov_b32 exec_lo, 0xffff
    s_mov_b32 exec_hi, 0xffff
    buffer_load_dwordx4 a[128:131], v3, s[16:19], s88 offen offset:0 sc1
    buffer_load_dwordx4 a[132:135], v3, s[16:19], s88 offen offset:256 sc1
    s_mov_b64 exec, -1
    s_waitcnt vmcnt(4)
    v_mfma_f32_32x32x16_bf16 v[128:143], v[212:215], v[248:251], 0
    v_max3_f32 v36, v80, v81, v82
    v_max3_f32 v36, v36, v83, v84
    v_max3_f32 v36, v36, v85, v86
    v_max3_f32 v36, v36, v87, v88
    v_max3_f32 v36, v36, v89, v90
    v_max3_f32 v36, v36, v91, v92
    v_max3_f32 v36, v36, v93, v94
    v_max_f32 v36, v36, v95
    v_add_f32 v36, s5, v36
    v_max_f32 v32, v32, v36
    s_mov_b32 exec_lo, 0xffff
    s_mov_b32 exec_hi, 0xffff
    buffer_load_dwordx4 a[136:139], v3, s[16:19], s88 offen offset:1024 sc1
    buffer_load_dwordx4 a[140:143], v3, s[16:19], s88 offen offset:1280 sc1
    s_mov_b64 exec, -1
    s_waitcnt vmcnt(5)
    v_mfma_f32_32x32x16_bf16 v[144:159], v[216:219], v[248:251], 0
    v_max3_f32 v37, v96, v97, v98
    v_max3_f32 v37, v37, v99, v100
    v_max3_f32 v37, v37, v101, v102
    v_max3_f32 v37, v37, v103, v104
    v_max3_f32 v37, v37, v105, v106
    v_max3_f32 v37, v37, v107, v108
    v_max3_f32 v37, v37, v109, v110
    v_max_f32 v37, v37, v111
    v_add_f32 v37, s5, v37
    v_max_f32 v32, v32, v37
    s_add_u32 s88, s84, 0x6fe800
    s_cmp_ge_u32 s10, 3
    s_cselect_b32 s88, s88, 0x7fff0000
    s_mov_b32 exec_lo, 0xffff
    s_mov_b32 exec_hi, 0xffff
    buffer_load_dwordx4 a[144:147], v3, s[16:19], s88 offen offset:0 sc1
    buffer_load_dwordx4 a[148:151], v3, s[16:19], s88 offen offset:256 sc1
    s_mov_b64 exec, -1
    s_waitcnt vmcnt(6)
    v_mfma_f32_32x32x16_bf16 v[160:175], v[220:223], v[248:251], 0
    v_max3_f32 v36, v112, v113, v114
    v_max3_f32 v36, v36, v115, v116
    v_max3_f32 v36, v36, v117, v118
    v_max3_f32 v36, v36, v119, v120
    v_max3_f32 v36, v36, v121, v122
    v_max3_f32 v36, v36, v123, v124
    v_max3_f32 v36, v36, v125, v126
    v_max_f32 v36, v36, v127
    v_add_f32 v36, s6, v36
    v_max_f32 v32, v32, v36
    s_mov_b32 exec_lo, 0xffff
    s_mov_b32 exec_hi, 0xffff
    buffer_load_dwordx4 a[152:155], v3, s[16:19], s88 offen offset:1024 sc1
    buffer_load_dwordx4 a[156:159], v3, s[16:19], s88 offen offset:1280 sc1
    s_mov_b64 exec, -1
    v_max3_f32 v37, v128, v129, v130
    v_max3_f32 v37, v37, v131, v132
    v_max3_f32 v37, v37, v133, v134
    v_max3_f32 v37, v37, v135, v136
    v_max3_f32 v37, v37, v137, v138
    v_max3_f32 v37, v37, v139, v140
    v_max3_f32 v37, v37, v141, v142
    v_max_f32 v37, v37, v143
    v_add_f32 v37, s6, v37
    v_max_f32 v32, v32, v37
    s_add_u32 s88, s84, 0x6ff000
    s_cmp_ge_u32 s10, 2
    s_cselect_b32 s88, s88, 0x7fff0000
    s_mov_b32 exec_lo, 0xffff
    s_mov_b32 exec_hi, 0xffff
    buffer_load_dwordx4 a[160:163], v3, s[16:19], s88 offen offset:0 sc1
    buffer_load_dwordx4 a[164:167], v3, s[16:19], s88 offen offset:256 sc1
    s_mov_b64 exec, -1
    v_max3_f32 v36, v144, v145, v146
    v_max3_f32 v36, v36, v147, v148
    v_max3_f32 v36, v36, v149, v150
    v_max3_f32 v36, v36, v151, v152
    v_max3_f32 v36, v36, v153, v154
    v_max3_f32 v36, v36, v155, v156
    v_max3_f32 v36, v36, v157, v158
    v_max_f32 v36, v36, v159
    v_add_f32 v36, s7, v36
    v_max_f32 v32, v32, v36
    s_mov_b32 exec_lo, 0xffff
    s_mov_b32 exec_hi, 0xffff
    buffer_load_dwordx4 a[168:171], v3, s[16:19], s88 offen offset:1024 sc1
    buffer_load_dwordx4 a[172:175], v3, s[16:19], s88 offen offset:1280 sc1
    s_mov_b64 exec, -1
    v_max3_f32 v37, v160, v161, v162
    v_max3_f32 v37, v37, v163, v164
    v_max3_f32 v37, v37, v165, v166
    v_max3_f32 v37, v37, v167, v168
    v_max3_f32 v37, v37, v169, v170
    v_max3_f32 v37, v37, v171, v172
    v_max3_f32 v37, v37, v173, v174
    v_max_f32 v37, v37, v175
    v_add_f32 v37, s7, v37
    v_max_f32 v32, v32, v37
    s_add_u32 s88, s84, 0x6ff800
    s_cmp_ge_u32 s10, 1
    s_cselect_b32 s88, s88, 0x7fff0000
    s_mov_b32 exec_lo, 0xffff
    s_mov_b32 exec_hi, 0xffff
    buffer_load_dwordx4 a[176:179], v3, s[16:19], s88 offen offset:0 sc1
    buffer_load_dwordx4 a[180:183], v3, s[16:19], s88 offen offset:256 sc1
    s_mov_b64 exec, -1
    v_mov_b32 v33, v32
    s_nop 1
    v_permlane32_swap_b32 v32, v33
    v_max_f32 v32, v32, v33
    v_mul_f32 v32, 0xbeb8aa3b, v32
    v_pk_fma_f32 v[48:49], v[48:49], s[14:15], v[32:33] op_sel_hi:[1,1,0]
    v_pk_fma_f32 v[50:51], v[50:51], s[14:15], v[32:33] op_sel_hi:[1,1,0]
    v_pk_fma_f32 v[52:53], v[52:53], s[14:15], v[32:33] op_sel_hi:[1,1,0]
    v_pk_fma_f32 v[54:55], v[54:55], s[14:15], v[32:33] op_sel_hi:[1,1,0]
    v_pk_fma_f32 v[56:57], v[56:57], s[14:15], v[32:33] op_sel_hi:[1,1,0]
    v_pk_fma_f32 v[58:59], v[58:59], s[14:15], v[32:33] op_sel_hi:[1,1,0]
    v_pk_fma_f32 v[60:61], v[60:61], s[14:15], v[32:33] op_sel_hi:[1,1,0]
    v_pk_fma_f32 v[62:63], v[62:63], s[14:15], v[32:33] op_sel_hi:[1,1,0]
    v_mfma_f32_32x32x16_bf16 v[176:191], v[244:247], v[252:255], 0
    v_exp_f32 v48, v48
    v_exp_f32 v49, v49
    v_exp_f32 v50, v50
    v_exp_f32 v51, v51
    v_exp_f32 v52, v52
    v_exp_f32 v53, v53
    v_exp_f32 v54, v54
    v_exp_f32 v55, v55
    v_exp_f32 v56, v56
    v_exp_f32 v57, v57
    v_exp_f32 v58, v58
    v_exp_f32 v59, v59
    v_exp_f32 v60, v60
    v_exp_f32 v61, v61
    s_mov_b32 exec_lo, 0xffff
    s_mov_b32 exec_hi, 0xffff
    buffer_load_dwordx4 a[184:187], v3, s[16:19], s88 offen offset:1024 sc1
    buffer_load_dwordx4 a[188:191], v3, s[16:19], s88 offen offset:1280 sc1
    s_mov_b64 exec, -1
    v_exp_f32 v62, v62
    v_exp_f32 v63, v63
    v_cvt_pk_bf16_f32 v48, v48, v49
    v_cvt_pk_bf16_f32 v49, v50, v51
    v_cvt_pk_bf16_f32 v50, v52, v53
    v_cvt_pk_bf16_f32 v51, v54, v55
    v_cvt_pk_bf16_f32 v52, v56, v57
    v_cvt_pk_bf16_f32 v53, v58, v59
    v_cvt_pk_bf16_f32 v54, v60, v61
    v_cvt_pk_bf16_f32 v55, v62, v63
    v_and_b32 v56, v48, v8
    v_and_b32 v57, v49, v9
    v_and_b32 v58, v50, v10
    s_add_u32 s87, s80, 0x180000
    buffer_load_dwordx4 a[0:3], v2, s[16:19], s87 offen offset:0 sc1
    v_and_b32 v59, v51, v11
    v_and_b32 v60, v52, v12
    v_and_b32 v61, v53, v13
    v_and_b32 v62, v54, v14
    v_and_b32 v63, v55, v15
    v_bfi_b32 v48, v8, 0, v48
    v_bfi_b32 v49, v9, 0, v49
    v_bfi_b32 v50, v10, 0, v50
    v_bfi_b32 v51, v11, 0, v51
    v_bfi_b32 v52, v12, 0, v52
    v_bfi_b32 v53, v13, 0, v53
    v_bfi_b32 v54, v14, 0, v54
    v_bfi_b32 v55, v15, 0, v55
    v_pk_fma_f32 v[64:65], v[64:65], s[14:15], v[32:33] op_sel_hi:[1,1,0]
    v_pk_fma_f32 v[66:67], v[66:67], s[14:15], v[32:33] op_sel_hi:[1,1,0]
    v_pk_fma_f32 v[68:69], v[68:69], s[14:15], v[32:33] op_sel_hi:[1,1,0]
    v_pk_fma_f32 v[70:71], v[70:71], s[14:15], v[32:33] op_sel_hi:[1,1,0]
    v_pk_fma_f32 v[72:73], v[72:73], s[14:15], v[32:33] op_sel_hi:[1,1,0]
    v_pk_fma_f32 v[74:75], v[74:75], s[14:15], v[32:33] op_sel_hi:[1,1,0]
    v_pk_fma_f32 v[76:77], v[76:77], s[14:15], v[32:33] op_sel_hi:[1,1,0]
    v_pk_fma_f32 v[78:79], v[78:79], s[14:15], v[32:33] op_sel_hi:[1,1,0]
    v_mfma_f32_32x32x16_bf16 v[16:31], v[232:235], v[56:59], 0
    v_exp_f32 v64, v64 clamp
    v_exp_f32 v65, v65 clamp
    v_exp_f32 v66, v66 clamp
    v_exp_f32 v67, v67 clamp
    v_mfma_f32_32x32x16_bf16 v[16:31], v[224:227], v[60:63], v[16:31]
    v_exp_f32 v68, v68 clamp
    v_exp_f32 v69, v69 clamp
    v_exp_f32 v70, v70 clamp
    v_exp_f32 v71, v71 clamp
    s_waitcnt vmcnt(15)
    v_mfma_f32_32x32x16_bf16 v[16:31], a[128:131], v[48:51], v[16:31]
    v_exp_f32 v72, v72 clamp
    v_exp_f32 v73, v73 clamp
    v_exp_f32 v74, v74 clamp
    v_exp_f32 v75, v75 clamp
    v_mfma_f32_32x32x16_bf16 v[16:31], a[132:135], v[52:55], v[16:31]
    v_exp_f32 v76, v76 clamp
    v_exp_f32 v77, v77 clamp
    v_exp_f32 v78, v78 clamp
    v_exp_f32 v79, v79 clamp
    v_mfma_f32_32x32x16_bf16 v[48:63], v[196:199], v[252:255], 0
    v_cvt_pk_bf16_f32 v64, v64, v65
    v_cvt_pk_bf16_f32 v65, v66, v67
    v_cvt_pk_bf16_f32 v66, v68, v69
    v_cvt_pk_bf16_f32 v67, v70, v71
    buffer_load_dwordx4 a[4:7], v2, s[16:19], s87 offen offset:1024 sc1
    v_cvt_pk_bf16_f32 v68, v72, v73
    v_cvt_pk_bf16_f32 v69, v74, v75
    buffer_load_dwordx4 a[8:11], v2, s[16:19], s87 offen offset:2048 sc1
    v_cvt_pk_bf16_f32 v70, v76, v77
    v_cvt_pk_bf16_f32 v71, v78, v79
    s_cmp_ge_u32 s10, 4
    s_cbranch_scc1 mg11
    s_nop 11
    v_mov_b32 v48, s4
    v_mov_b32 v49, s4
    v_mov_b32 v50, s4
    v_mov_b32 v51, s4
    v_mov_b32 v52, s4
    v_mov_b32 v53, s4
    v_mov_b32 v54, s4
    v_mov_b32 v55, s4
    v_mov_b32 v56, s4
    v_mov_b32 v57, s4
    v_mov_b32 v58, s4
    v_mov_b32 v59, s4
    v_mov_b32 v60, s4
    v_mov_b32 v61, s4
    v_mov_b32 v62, s4
    v_mov_b32 v63, s4
mg11:
    v_cndmask_b32 v48, v48, v176, s[32:33]
    v_cndmask_b32 v49, v49, v177, s[34:35]
    v_cndmask_b32 v50, v50, v178, s[36:37]
    v_cndmask_b32 v51, v51, v179, s[38:39]
    v_cndmask_b32 v52, v52, v180, s[40:41]
    v_cndmask_b32 v53, v53, v181, s[42:43]
    v_cndmask_b32 v54, v54, v182, s[44:45]
    v_cndmask_b32 v55, v55, v183, s[46:47]
    v_cndmask_b32 v56, v56, v184, s[48:49]
    v_cndmask_b32 v57, v57, v185, s[50:51]
    v_cndmask_b32 v58, v58, v186, s[52:53]
    v_cndmask_b32 v59, v59, v187, s[54:55]
    v_cndmask_b32 v60, v60, v188, s[56:57]
    v_cndmask_b32 v61, v61, v189, s[58:59]
    v_cndmask_b32 v62, v62, v190, s[60:61]
    v_cndmask_b32 v63, v63, v191, s[62:63]
    v_pk_fma_f32 v[80:81], v[80:81], s[14:15], v[32:33] op_sel_hi:[1,1,0]
    v_pk_fma_f32 v[82:83], v[82:83], s[14:15], v[32:33] op_sel_hi:[1,1,0]
    v_pk_fma_f32 v[84:85], v[84:85], s[14:15], v[32:33] op_sel_hi:[1,1,0]
    v_pk_fma_f32 v[86:87], v[86:87], s[14:15], v[32:33] op_sel_hi:[1,1,0]
    v_pk_fma_f32 v[88:89], v[88:89], s[14:15], v[32:33] op_sel_hi:[1,1,0]
    v_pk_fma_f32 v[90:91], v[90:91], s[14:15], v[32:33] op_sel_hi:[1,1,0]
    v_pk_fma_f32 v[92:93], v[92:93], s[14:15], v[32:33] op_sel_hi:[1,1,0]
    v_pk_fma_f32 v[94:95], v[94:95], s[14:15], v[32:33] op_sel_hi:[1,1,0]
    s_waitcnt vmcnt(15)
    v_mfma_f32_32x32x16_bf16 v[16:31], a[136:139], v[64:67], v[16:31]
    v_exp_f32 v80, v80 clamp
    v_exp_f32 v81, v81 clamp
    v_exp_f32 v82, v82 clamp
    v_exp_f32 v83, v83 clamp
    v_exp_f32 v84, v84 clamp
    v_mfma_f32_32x32x16_bf16 v[16:31], a[140:143], v[68:71], v[16:31]
    v_exp_f32 v85, v85 clamp
    v_exp_f32 v86, v86 clamp
    v_exp_f32 v87, v87 clamp
    v_exp_f32 v88, v88 clamp
    v_exp_f32 v89, v89 clamp
    v_mfma_f32_32x32x16_bf16 v[176:191], v[240:243], v[252:255], 0
    v_exp_f32 v90, v90 clamp
    v_exp_f32 v91, v91 clamp
    v_exp_f32 v92, v92 clamp
    v_exp_f32 v93, v93 clamp
    v_exp_f32 v94, v94 clamp
    v_mfma_f32_32x32x16_bf16 v[64:79], v[200:203], v[252:255], 0
    v_exp_f32 v95, v95 clamp
    v_cvt_pk_bf16_f32 v80, v80, v81
    v_cvt_pk_bf16_f32 v81, v82, v83
    v_cvt_pk_bf16_f32 v82, v84, v85
    v_cvt_pk_bf16_f32 v83, v86, v87
    buffer_load_dwordx4 a[12:15], v2, s[16:19], s87 offen offset:3072 sc1
    v_cvt_pk_bf16_f32 v84, v88, v89
    v_cvt_pk_bf16_f32 v85, v90, v91
    v_cvt_pk_bf16_f32 v86, v92, v93
    v_cvt_pk_bf16_f32 v87, v94, v95
    v_max3_f32 v34, v48, v49, v50
    v_max3_f32 v34, v34, v51, v52
    s_add_u32 s87, s80, 0x181000
    buffer_load_dwordx4 a[16:19], v2, s[16:19], s87 offen offset:0 sc1
    v_max3_f32 v34, v34, v53, v54
    v_max3_f32 v34, v34, v55, v56
    v_max3_f32 v34, v34, v57, v58
    v_max3_f32 v34, v34, v59, v60
    v_max3_f32 v34, v34, v61, v62
    v_max_f32 v34, v34, v63
    v_pk_fma_f32 v[96:97], v[96:97], s[14:15], v[32:33] op_sel_hi:[1,1,0]
    v_pk_fma_f32 v[98:99], v[98:99], s[14:15], v[32:33] op_sel_hi:[1,1,0]
    v_pk_fma_f32 v[100:101], v[100:101], s[14:15], v[32:33] op_sel_hi:[1,1,0]
    v_pk_fma_f32 v[102:103], v[102:103], s[14:15], v[32:33] op_sel_hi:[1,1,0]
    v_pk_fma_f32 v[104:105], v[104:105], s[14:15], v[32:33] op_sel_hi:[1,1,0]
    v_pk_fma_f32 v[106:107], v[106:107], s[14:15], v[32:33] op_sel_hi:[1,1,0]
    v_pk_fma_f32 v[108:109], v[108:109], s[14:15], v[32:33] op_sel_hi:[1,1,0]
    v_pk_fma_f32 v[110:111], v[110:111], s[14:15], v[32:33] op_sel_hi:[1,1,0]
    s_waitcnt vmcnt(15)
    v_mfma_f32_32x32x16_bf16 v[16:31], a[144:147], v[80:83], v[16:31]
    v_exp_f32 v96, v96 clamp
    v_exp_f32 v97, v97 clamp
    v_exp_f32 v98, v98 clamp
    v_exp_f32 v99, v99 clamp
    v_mfma_f32_32x32x16_bf16 v[16:31], a[148:151], v[84:87], v[16:31]
    v_exp_f32 v100, v100 clamp
    v_exp_f32 v101, v101 clamp
    v_exp_f32 v102, v102 clamp
    v_exp_f32 v103, v103 clamp
    v_exp_f32 v104, v104 clamp
    v_mfma_f32_32x32x16_bf16 v[80:95], v[204:207], v[252:255], 0
    v_exp_f32 v105, v105 clamp
    v_exp_f32 v106, v106 clamp
    v_exp_f32 v107, v107 clamp
    v_exp_f32 v108, v108 clamp
    v_exp_f32 v109, v109 clamp
    buffer_load_dwordx4 a[20:23], v2, s[16:19], s87 offen offset:1024 sc1
    v_exp_f32 v110, v110 clamp
    v_exp_f32 v111, v111 clamp
    v_cvt_pk_bf16_f32 v96, v96, v97
    v_cvt_pk_bf16_f32 v97, v98, v99
    v_cvt_pk_bf16_f32 v98, v100, v101
    v_cvt_pk_bf16_f32 v99, v102, v103
    v_cvt_pk_bf16_f32 v100, v104, v105
    v_cvt_pk_bf16_f32 v101, v106, v107
    v_cvt_pk_bf16_f32 v102, v108, v109
    v_cvt_pk_bf16_f32 v103, v110, v111
    v_max3_f32 v34, v34, v176, v177
    v_max3_f32 v34, v34, v178, v179
    v_max3_f32 v34, v34, v180, v181
    v_max3_f32 v34, v34, v182, v183
    buffer_load_dwordx4 a[24:27], v2, s[16:19], s87 offen offset:2048 sc1
    v_max3_f32 v34, v34, v184, v185
    v_max3_f32 v34, v34, v186, v187
    v_max3_f32 v34, v34, v188, v189
    v_max3_f32 v34, v34, v190, v191
    v_max3_f32 v37, v64, v65, v66
    v_max3_f32 v37, v37, v67, v68
    v_max3_f32 v37, v37, v69, v70
    v_max3_f32 v37, v37, v71, v72
    v_max3_f32 v37, v37, v73, v74
    v_max3_f32 v37, v37, v75, v76
    v_max3_f32 v37, v37, v77, v78
    v_max_f32 v37, v37, v79
    v_add_f32 v37, s5, v37
    v_max_f32 v34, v34, v37
    v_pk_fma_f32 v[112:113], v[112:113], s[14:15], v[32:33] op_sel_hi:[1,1,0]
    v_pk_fma_f32 v[114:115], v[114:115], s[14:15], v[32:33] op_sel_hi:[1,1,0]
    v_pk_fma_f32 v[116:117], v[116:117], s[14:15], v[32:33] op_sel_hi:[1,1,0]
    v_pk_fma_f32 v[118:119], v[118:119], s[14:15], v[32:33] op_sel_hi:[1,1,0]
    v_pk_fma_f32 v[120:121], v[120:121], s[14:15], v[32:33] op_sel_hi:[1,1,0]
    v_pk_fma_f32 v[122:123], v[122:123], s[14:15], v[32:33] op_sel_hi:[1,1,0]
    v_pk_fma_f32 v[124:125], v[124:125], s[14:15], v[32:33] op_sel_hi:[1,1,0]
    v_pk_fma_f32 v[126:127], v[126:127], s[14:15], v[32:33] op_sel_hi:[1,1,0]
    s_waitcnt vmcnt(15)
    v_mfma_f32_32x32x16_bf16 v[16:31], a[152:155], v[96:99], v[16:31]
    v_exp_f32 v112, v112 clamp
    v_exp_f32 v113, v113 clamp
    v_exp_f32 v114, v114 clamp
    v_exp_f32 v115, v115 clamp
    v_mfma_f32_32x32x16_bf16 v[16:31], a[156:159], v[100:103], v[16:31]
    v_exp_f32 v116, v116 clamp
    v_exp_f32 v117, v117 clamp
    v_exp_f32 v118, v118 clamp
    v_exp_f32 v119, v119 clamp
    v_exp_f32 v120, v120 clamp
    v_mfma_f32_32x32x16_bf16 v[96:111], v[208:211], v[252:255], 0
    v_exp_f32 v121, v121 clamp
    v_exp_f32 v122, v122 clamp
    v_exp_f32 v123, v123 clamp
    v_exp_f32 v124, v124 clamp
    v_exp_f32 v125, v125 clamp
    buffer_load_dwordx4 a[28:31], v2, s[16:19], s87 offen offset:3072 sc1
    v_exp_f32 v126, v126 clamp
    v_exp_f32 v127, v127 clamp
    v_cvt_pk_bf16_f32 v112, v112, v113
    v_cvt_pk_bf16_f32 v113, v114, v115
    v_cvt_pk_bf16_f32 v114, v116, v117
    v_cvt_pk_bf16_f32 v115, v118, v119
    v_cvt_pk_bf16_f32 v116, v120, v121
    v_cvt_pk_bf16_f32 v117, v122, v123
    v_cvt_pk_bf16_f32 v118, v124, v125
    v_cvt_pk_bf16_f32 v119, v126, v127
    s_add_u32 s87, s80, 0x182000
    buffer_load_dwordx4 a[32:35], v2, s[16:19], s87 offen offset:0 sc1
    v_max3_f32 v36, v80, v81, v82
    v_max3_f32 v36, v36, v83, v84
    v_max3_f32 v36, v36, v85, v86
    v_max3_f32 v36, v36, v87, v88
    v_max3_f32 v36, v36, v89, v90
    v_max3_f32 v36, v36, v91, v92
    v_max3_f32 v36, v36, v93, v94
    v_max_f32 v36, v36, v95
    v_add_f32 v36, s5, v36
    v_max_f32 v34, v34, v36
    v_pk_fma_f32 v[128:129], v[128:129], s[14:15], v[32:33] op_sel_hi:[1,1,0]
    v_pk_fma_f32 v[130:131], v[130:131], s[14:15], v[32:33] op_sel_hi:[1,1,0]
    v_pk_fma_f32 v[132:133], v[132:133], s[14:15], v[32:33] op_sel_hi:[1,1,0]
    v_pk_fma_f32 v[134:135], v[134:135], s[14:15], v[32:33] op_sel_hi:[1,1,0]
    v_pk_fma_f32 v[136:137], v[136:137], s[14:15], v[32:33] op_sel_hi:[1,1,0]
    v_pk_fma_f32 v[138:139], v[138:139], s[14:15], v[32:33] op_sel_hi:[1,1,0]
    v_pk_fma_f32 v[140:141], v[140:141], s[14:15], v[32:33] op_sel_hi:[1,1,0]
    v_pk_fma_f32 v[142:143], v[142:143], s[14:15], v[32:33] op_sel_hi:[1,1,0]
    s_waitcnt vmcnt(15)
    v_mfma_f32_32x32x16_bf16 v[16:31], a[160:163], v[112:115], v[16:31]
    v_exp_f32 v128, v128 clamp
    v_exp_f32 v129, v129 clamp
    v_exp_f32 v130, v130 clamp
    v_exp_f32 v131, v131 clamp
    v_mfma_f32_32x32x16_bf16 v[16:31], a[164:167], v[116:119], v[16:31]
    v_exp_f32 v132, v132 clamp
    v_exp_f32 v133, v133 clamp
    v_exp_f32 v134, v134 clamp
    v_exp_f32 v135, v135 clamp
    v_exp_f32 v136, v136 clamp
    v_mfma_f32_32x32x16_bf16 v[112:127], v[212:215], v[252:255], 0
    v_exp_f32 v137, v137 clamp
    v_exp_f32 v138, v138 clamp
    v_exp_f32 v139, v139 clamp
    v_exp_f32 v140, v140 clamp
    v_exp_f32 v141, v141 clamp
    buffer_load_dwordx4 a[36:39], v2, s[16:19], s87 offen offset:1024 sc1
    v_exp_f32 v142, v142 clamp
    v_exp_f32 v143, v143 clamp
    v_cvt_pk_bf16_f32 v128, v128, v129
    v_cvt_pk_bf16_f32 v129, v130, v131
    v_cvt_pk_bf16_f32 v130, v132, v133
    v_cvt_pk_bf16_f32 v131, v134, v135
    v_cvt_pk_bf16_f32 v132, v136, v137
    v_cvt_pk_bf16_f32 v133, v138, v139
    v_cvt_pk_bf16_f32 v134, v140, v141
    v_cvt_pk_bf16_f32 v135, v142, v143
    buffer_load_dwordx4 a[40:43], v2, s[16:19], s87 offen offset:2048 sc1
    v_max3_f32 v37, v96, v97, v98
    v_max3_f32 v37, v37, v99, v100
    v_max3_f32 v37, v37, v101, v102
    v_max3_f32 v37, v37, v103, v104
    v_max3_f32 v37, v37, v105, v106
    v_max3_f32 v37, v37, v107, v108
    v_max3_f32 v37, v37, v109, v110
    v_max_f32 v37, v37, v111
    v_add_f32 v37, s6, v37
    v_max_f32 v34, v34, v37
    v_pk_fma_f32 v[144:145], v[144:145], s[14:15], v[32:33] op_sel_hi:[1,1,0]
    v_pk_fma_f32 v[146:147], v[146:147], s[14:15], v[32:33] op_sel_hi:[1,1,0]
    v_pk_fma_f32 v[148:149], v[148:149], s[14:15], v[32:33] op_sel_hi:[1,1,0]
    v_pk_fma_f32 v[150:151], v[150:151], s[14:15], v[32:33] op_sel_hi:[1,1,0]
    v_pk_fma_f32 v[152:153], v[152:153], s[14:15], v[32:33] op_sel_hi:[1,1,0]
    v_pk_fma_f32 v[154:155], v[154:155], s[14:15], v[32:33] op_sel_hi:[1,1,0]
    v_pk_fma_f32 v[156:157], v[156:157], s[14:15], v[32:33] op_sel_hi:[1,1,0]
    v_pk_fma_f32 v[158:159], v[158:159], s[14:15], v[32:33] op_sel_hi:[1,1,0]
    s_waitcnt vmcnt(15)
    v_mfma_f32_32x32x16_bf16 v[16:31], a[168:171], v[128:131], v[16:31]
    v_exp_f32 v144, v144 clamp
    v_exp_f32 v145, v145 clamp
    v_exp_f32 v146, v146 clamp
    v_exp_f32 v147, v147 clamp
    v_mfma_f32_32x32x16_bf16 v[16:31], a[172:175], v[132:135], v[16:31]
    v_exp_f32 v148, v148 clamp
    v_exp_f32 v149, v149 clamp
    v_exp_f32 v150, v150 clamp
    v_exp_f32 v151, v151 clamp
    v_exp_f32 v152, v152 clamp
    v_mfma_f32_32x32x16_bf16 v[128:143], v[216:219], v[252:255], 0
    v_exp_f32 v153, v153 clamp
    v_exp_f32 v154, v154 clamp
    v_exp_f32 v155, v155 clamp
    v_exp_f32 v156, v156 clamp
    v_exp_f32 v157, v157 clamp
    buffer_load_dwordx4 a[44:47], v2, s[16:19], s87 offen offset:3072 sc1
    v_exp_f32 v158, v158 clamp
    v_exp_f32 v159, v159 clamp
    v_cvt_pk_bf16_f32 v144, v144, v145
    v_cvt_pk_bf16_f32 v145, v146, v147
    v_cvt_pk_bf16_f32 v146, v148, v149
    v_cvt_pk_bf16_f32 v147, v150, v151
    v_cvt_pk_bf16_f32 v148, v152, v153
    v_cvt_pk_bf16_f32 v149, v154, v155
    v_cvt_pk_bf16_f32 v150, v156, v157
    v_cvt_pk_bf16_f32 v151, v158, v159
    s_add_u32 s87, s80, 0x183000
    buffer_load_dwordx4 a[48:51], v2, s[16:19], s87 offen offset:0 sc1
    v_max3_f32 v36, v112, v113, v114
    v_max3_f32 v36, v36, v115, v116
    v_max3_f32 v36, v36, v117, v118
    v_max3_f32 v36, v36, v119, v120
    v_max3_f32 v36, v36, v121, v122
    v_max3_f32 v36, v36, v123, v124
    v_max3_f32 v36, v36, v125, v126
    v_max_f32 v36, v36, v127
    v_add_f32 v36, s6, v36
    v_max_f32 v34, v34, v36
    v_pk_fma_f32 v[160:161], v[160:161], s[14:15], v[32:33] op_sel_hi:[1,1,0]
    v_pk_fma_f32 v[162:163], v[162:163], s[14:15], v[32:33] op_sel_hi:[1,1,0]
    v_pk_fma_f32 v[164:165], v[164:165], s[14:15], v[32:33] op_sel_hi:[1,1,0]
    v_pk_fma_f32 v[166:167], v[166:167], s[14:15], v[32:33] op_sel_hi:[1,1,0]
    v_pk_fma_f32 v[168:169], v[168:169], s[14:15], v[32:33] op_sel_hi:[1,1,0]
    v_pk_fma_f32 v[170:171], v[170:171], s[14:15], v[32:33] op_sel_hi:[1,1,0]
    v_pk_fma_f32 v[172:173], v[172:173], s[14:15], v[32:33] op_sel_hi:[1,1,0]
    v_pk_fma_f32 v[174:175], v[174:175], s[14:15], v[32:33] op_sel_hi:[1,1,0]
    s_waitcnt vmcnt(15)
    v_mfma_f32_32x32x16_bf16 v[16:31], a[176:179], v[144:147], v[16:31]
    v_exp_f32 v160, v160 clamp
    v_exp_f32 v161, v161 clamp
    v_exp_f32 v162, v162 clamp
    v_exp_f32 v163, v163 clamp
    v_mfma_f32_32x32x16_bf16 v[16:31], a[180:183], v[148:151], v[16:31]
    v_exp_f32 v164, v164 clamp
    v_exp_f32 v165, v165 clamp
    v_exp_f32 v166, v166 clamp
    v_exp_f32 v167, v167 clamp
    v_exp_f32 v168, v168 clamp
    v_mfma_f32_32x32x16_bf16 v[144:159], v[220:223], v[252:255], 0
    v_exp_f32 v169, v169 clamp
    v_exp_f32 v170, v170 clamp
    v_exp_f32 v171, v171 clamp
    v_exp_f32 v172, v172 clamp
    v_exp_f32 v173, v173 clamp
    buffer_load_dwordx4 a[52:55], v2, s[16:19], s87 offen offset:1024 sc1
    v_exp_f32 v174, v174 clamp
    v_exp_f32 v175, v175 clamp
    v_cvt_pk_bf16_f32 v160, v160, v161
    v_cvt_pk_bf16_f32 v161, v162, v163
    v_cvt_pk_bf16_f32 v162, v164, v165
    v_cvt_pk_bf16_f32 v163, v166, v167
    v_cvt_pk_bf16_f32 v164, v168, v169
    v_cvt_pk_bf16_f32 v165, v170, v171
    v_cvt_pk_bf16_f32 v166, v172, v173
    v_cvt_pk_bf16_f32 v167, v174, v175
    buffer_load_dwordx4 a[56:59], v2, s[16:19], s87 offen offset:2048 sc1
    v_max3_f32 v37, v128, v129, v130
    v_max3_f32 v37, v37, v131, v132
    v_max3_f32 v37, v37, v133, v134
    v_max3_f32 v37, v37, v135, v136
    v_max3_f32 v37, v37, v137, v138
    v_max3_f32 v37, v37, v139, v140
    v_max3_f32 v37, v37, v141, v142
    v_max_f32 v37, v37, v143
    v_add_f32 v37, s7, v37
    v_max_f32 v34, v34, v37
    v_max3_f32 v36, v144, v145, v146
    v_max3_f32 v36, v36, v147, v148
    v_max3_f32 v36, v36, v149, v150
    v_max3_f32 v36, v36, v151, v152
    v_max3_f32 v36, v36, v153, v154
    v_max3_f32 v36, v36, v155, v156
    v_max3_f32 v36, v36, v157, v158
    v_max_f32 v36, v36, v159
    v_add_f32 v36, s7, v36
    v_max_f32 v34, v34, v36
    v_mov_b32 v35, v34
    s_nop 1
    v_permlane32_swap_b32 v34, v35
    v_max_f32 v34, v34, v35
    v_mul_f32 v34, 0xbeb8aa3b, v34
    v_pk_fma_f32 v[48:49], v[48:49], s[14:15], v[34:35] op_sel_hi:[1,1,0]
    v_pk_fma_f32 v[50:51], v[50:51], s[14:15], v[34:35] op_sel_hi:[1,1,0]
    v_pk_fma_f32 v[52:53], v[52:53], s[14:15], v[34:35] op_sel_hi:[1,1,0]
    v_pk_fma_f32 v[54:55], v[54:55], s[14:15], v[34:35] op_sel_hi:[1,1,0]
    v_pk_fma_f32 v[56:57], v[56:57], s[14:15], v[34:35] op_sel_hi:[1,1,0]
    v_pk_fma_f32 v[58:59], v[58:59], s[14:15], v[34:35] op_sel_hi:[1,1,0]
    v_pk_fma_f32 v[60:61], v[60:61], s[14:15], v[34:35] op_sel_hi:[1,1,0]
    v_pk_fma_f32 v[62:63], v[62:63], s[14:15], v[34:35] op_sel_hi:[1,1,0]
    s_waitcnt vmcnt(15)
    v_mfma_f32_32x32x16_bf16 v[16:31], a[184:187], v[160:163], v[16:31]
    v_exp_f32 v48, v48
    v_exp_f32 v49, v49
    v_exp_f32 v50, v50
    v_exp_f32 v51, v51
    v_exp_f32 v52, v52
    v_exp_f32 v53, v53
    v_mfma_f32_32x32x16_bf16 v[16:31], a[188:191], v[164:167], v[16:31]
    v_exp_f32 v54, v54
    v_exp_f32 v55, v55
    v_exp_f32 v56, v56
    v_exp_f32 v57, v57
    v_exp_f32 v58, v58
    v_exp_f32 v59, v59
    buffer_load_dwordx4 a[60:63], v2, s[16:19], s87 offen offset:3072 sc1
    v_exp_f32 v60, v60
    v_exp_f32 v61, v61
    v_exp_f32 v62, v62
    v_exp_f32 v63, v63
    v_cvt_pk_bf16_f32 v48, v48, v49
    v_cvt_pk_bf16_f32 v49, v50, v51
    v_cvt_pk_bf16_f32 v50, v52, v53
    v_cvt_pk_bf16_f32 v51, v54, v55
    v_cvt_pk_bf16_f32 v52, v56, v57
    v_cvt_pk_bf16_f32 v53, v58, v59
    v_cvt_pk_bf16_f32 v54, v60, v61
    v_cvt_pk_bf16_f32 v55, v62, v63
    s_add_u32 s87, s80, 0x184000
    buffer_load_dwordx4 a[64:67], v2, s[16:19], s87 offen offset:0 sc1
    v_and_b32 v56, v48, v8
    v_and_b32 v57, v49, v9
    v_and_b32 v58, v50, v10
    v_and_b32 v59, v51, v11
    v_and_b32 v60, v52, v12
    v_and_b32 v61, v53, v13
    v_and_b32 v62, v54, v14
    v_and_b32 v63, v55, v15
    v_bfi_b32 v48, v8, 0, v48
    v_bfi_b32 v49, v9, 0, v49
    v_bfi_b32 v50, v10, 0, v50
    v_bfi_b32 v51, v11, 0, v51
    v_bfi_b32 v52, v12, 0, v52
    buffer_load_dwordx4 a[68:71], v2, s[16:19], s87 offen offset:1024 sc1
    v_bfi_b32 v53, v13, 0, v53
    v_bfi_b32 v54, v14, 0, v54
    v_bfi_b32 v55, v15, 0, v55
    v_rcp_f32 v38, v24
    s_nop 0
    v_pk_mul_f32 v[16:17], v[16:17], v[38:39] op_sel_hi:[1,0]
    v_pk_mul_f32 v[18:19], v[18:19], v[38:39] op_sel_hi:[1,0]
    v_pk_mul_f32 v[20:21], v[20:21], v[38:39] op_sel_hi:[1,0]
    v_pk_mul_f32 v[22:23], v[22:23], v[38:39] op_sel_hi:[1,0]
    v_cvt_pk_bf16_f32 v40, v16, v17
    v_cvt_pk_bf16_f32 v41, v18, v19
    v_cvt_pk_bf16_f32 v42, v20, v21
    v_cvt_pk_bf16_f32 v43, v22, v23
    s_add_u32 s64, s85, 0x900000
    s_cmp_eq_u32 s97, 1
    s_cbranch_scc0 slow22
    buffer_store_dwordx4 v[40:43], v2, s[16:19], s64 offen
back22:
    v_pk_fma_f32 v[64:65], v[64:65], s[14:15], v[34:35] op_sel_hi:[1,1,0]
    v_pk_fma_f32 v[66:67], v[66:67], s[14:15], v[34:35] op_sel_hi:[1,1,0]
    v_pk_fma_f32 v[68:69], v[68:69], s[14:15], v[34:35] op_sel_hi:[1,1,0]
    v_pk_fma_f32 v[70:71], v[70:71], s[14:15], v[34:35] op_sel_hi:[1,1,0]
    v_pk_fma_f32 v[72:73], v[72:73], s[14:15], v[34:35] op_sel_hi:[1,1,0]
    v_pk_fma_f32 v[74:75], v[74:75], s[14:15], v[34:35] op_sel_hi:[1,1,0]
    v_pk_fma_f32 v[76:77], v[76:77], s[14:15], v[34:35] op_sel_hi:[1,1,0]
    v_pk_fma_f32 v[78:79], v[78:79], s[14:15], v[34:35] op_sel_hi:[1,1,0]
    v_mfma_f32_32x32x16_bf16 v[16:31], v[236:239], v[56:59], 0
    v_exp_f32 v64, v64 clamp
    v_exp_f32 v65, v65 clamp
    v_exp_f32 v66, v66 clamp
    v_exp_f32 v67, v67 clamp
    v_exp_f32 v68, v68 clamp
    v_mfma_f32_32x32x16_bf16 v[16:31], v[228:231], v[60:63], v[16:31]
    v_exp_f32 v69, v69 clamp
    v_exp_f32 v70, v70 clamp
    v_exp_f32 v71, v71 clamp
    v_exp_f32 v72, v72 clamp
    v_exp_f32 v73, v73 clamp
    v_mfma_f32_32x32x16_bf16 v[16:31], a[136:139], v[48:51], v[16:31]
    v_exp_f32 v74, v74 clamp
    v_exp_f32 v75, v75 clamp
    v_exp_f32 v76, v76 clamp
    v_exp_f32 v77, v77 clamp
    v_exp_f32 v78, v78 clamp
    v_mfma_f32_32x32x16_bf16 v[16:31], a[140:143], v[52:55], v[16:31]
    v_exp_f32 v79, v79 clamp
    v_cvt_pk_bf16_f32 v64, v64, v65
    v_cvt_pk_bf16_f32 v65, v66, v67
    v_cvt_pk_bf16_f32 v66, v68, v69
    v_cvt_pk_bf16_f32 v67, v70, v71
    buffer_load_dwordx4 a[72:75], v2, s[16:19], s87 offen offset:2048 sc1
    v_cvt_pk_bf16_f32 v68, v72, v73
    buffer_load_dwordx4 a[76:79], v2, s[16:19], s87 offen offset:3072 sc1
    v_cvt_pk_bf16_f32 v69, v74, v75
    s_add_u32 s87, s80, 0x185000
    buffer_load_dwordx4 a[80:83], v2, s[16:19], s87 offen offset:0 sc1
    v_cvt_pk_bf16_f32 v70, v76, v77
    v_cvt_pk_bf16_f32 v71, v78, v79
    v_pk_fma_f32 v[80:81], v[80:81], s[14:15], v[34:35] op_sel_hi:[1,1,0]
    v_pk_fma_f32 v[82:83], v[82:83], s[14:15], v[34:35] op_sel_hi:[1,1,0]
    v_pk_fma_f32 v[84:85], v[84:85], s[14:15], v[34:35] op_sel_hi:[1,1,0]
    v_pk_fma_f32 v[86:87], v[86:87], s[14:15], v[34:35] op_sel_hi:[1,1,0]
    v_pk_fma_f32 v[88:89], v[88:89], s[14:15], v[34:35] op_sel_hi:[1,1,0]
    v_pk_fma_f32 v[90:91], v[90:91], s[14:15], v[34:35] op_sel_hi:[1,1,0]
    v_pk_fma_f32 v[92:93], v[92:93], s[14:15], v[34:35] op_sel_hi:[1,1,0]
    v_pk_fma_f32 v[94:95], v[94:95], s[14:15], v[34:35] op_sel_hi:[1,1,0]
    v_mfma_f32_32x32x16_bf16 v[16:31], a[144:147], v[64:67], v[16:31]
    v_exp_f32 v80, v80 clamp
    v_exp_f32 v81, v81 clamp
    v_exp_f32 v82, v82 clamp
    v_exp_f32 v83, v83 clamp
    v_exp_f32 v84, v84 clamp
    v_exp_f32 v85, v85 clamp
    v_mfma_f32_32x32x16_bf16 v[16:31], a[148:151], v[68:71], v[16:31]
    v_exp_f32 v86, v86 clamp
    v_exp_f32 v87, v87 clamp
    v_exp_f32 v88, v88 clamp
    v_exp_f32 v89, v89 clamp
    v_exp_f32 v90, v90 clamp
    v_exp_f32 v91, v91 clamp
    buffer_load_dwordx4 a[84:87], v2, s[16:19], s87 offen offset:1024 sc1
    v_exp_f32 v92, v92 clamp
    v_exp_f32 v93, v93 clamp
    v_exp_f32 v94, v94 clamp
    v_exp_f32 v95, v95 clamp
    buffer_load_dwordx4 a[88:91], v2, s[16:19], s87 offen offset:2048 sc1
    v_cvt_pk_bf16_f32 v80, v80, v81
    v_cvt_pk_bf16_f32 v81, v82, v83
    v_cvt_pk_bf16_f32 v82, v84, v85
    v_cvt_pk_bf16_f32 v83, v86, v87
    buffer_load_dwordx4 a[92:95], v2, s[16:19], s87 offen offset:3072 sc1
    v_cvt_pk_bf16_f32 v84, v88, v89
    v_cvt_pk_bf16_f32 v85, v90, v91
    v_cvt_pk_bf16_f32 v86, v92, v93
    v_cvt_pk_bf16_f32 v87, v94, v95
    s_add_u32 s30, s72, 10
    v_mov_b32 v4, s30
    v_mov_b32 v5, s73
    s_waitcnt vmcnt(6)
    s_mov_b64 exec, 1
    s_cmp_eq_u32 s97, 1
    s_cbranch_scc0 slow23
    buffer_store_dwordx2 v[4:5], v1, s[16:19], s0 offen
back23:
    s_mov_b64 exec, -1
    v_pk_fma_f32 v[96:97], v[96:97], s[14:15], v[34:35] op_sel_hi:[1,1,0]
    v_pk_fma_f32 v[98:99], v[98:99], s[14:15], v[34:35] op_sel_hi:[1,1,0]
    v_pk_fma_f32 v[100:101], v[100:101], s[14:15], v[34:35] op_sel_hi:[1,1,0]
    v_pk_fma_f32 v[102:103], v[102:103], s[14:15], v[34:35] op_sel_hi:[1,1,0]
    v_pk_fma_f32 v[104:105], v[104:105], s[14:15], v[34:35] op_sel_hi:[1,1,0]
    v_pk_fma_f32 v[106:107], v[106:107], s[14:15], v[34:35] op_sel_hi:[1,1,0]
    v_pk_fma_f32 v[108:109], v[108:109], s[14:15], v[34:35] op_sel_hi:[1,1,0]
    v_pk_fma_f32 v[110:111], v[110:111], s[14:15], v[34:35] op_sel_hi:[1,1,0]
    v_mfma_f32_32x32x16_bf16 v[16:31], a[152:155], v[80:83], v[16:31]
    v_exp_f32 v96, v96 clamp
    v_exp_f32 v97, v97 clamp
    v_exp_f32 v98, v98 clamp
    v_exp_f32 v99, v99 clamp
    v_exp_f32 v100, v100 clamp
    v_exp_f32 v101, v101 clamp
    v_mfma_f32_32x32x16_bf16 v[16:31], a[156:159], v[84:87], v[16:31]
    v_exp_f32 v102, v102 clamp
    v_exp_f32 v103, v103 clamp
    v_exp_f32 v104, v104 clamp
    v_exp_f32 v105, v105 clamp
    v_exp_f32 v106, v106 clamp
    v_exp_f32 v107, v107 clamp
    s_add_u32 s87, s80, 0x186000
    buffer_load_dwordx4 a[96:99], v2, s[16:19], s87 offen offset:0 sc1
    v_exp_f32 v108, v108 clamp
    v_exp_f32 v109, v109 clamp
    v_exp_f32 v110, v110 clamp
    v_exp_f32 v111, v111 clamp
    buffer_load_dwordx4 a[100:103], v2, s[16:19], s87 offen offset:1024 sc1
    v_cvt_pk_bf16_f32 v96, v96, v97
    v_cvt_pk_bf16_f32 v97, v98, v99
    v_cvt_pk_bf16_f32 v98, v100, v101
    v_cvt_pk_bf16_f32 v99, v102, v103
    buffer_load_dwordx4 a[104:107], v2, s[16:19], s87 offen offset:2048 sc1
    v_cvt_pk_bf16_f32 v100, v104, v105
    v_cvt_pk_bf16_f32 v101, v106, v107
    v_cvt_pk_bf16_f32 v102, v108, v109
    v_cvt_pk_bf16_f32 v103, v110, v111
    v_pk_fma_f32 v[112:113], v[112:113], s[14:15], v[34:35] op_sel_hi:[1,1,0]
    v_pk_fma_f32 v[114:115], v[114:115], s[14:15], v[34:35] op_sel_hi:[1,1,0]
    v_pk_fma_f32 v[116:117], v[116:117], s[14:15], v[34:35] op_sel_hi:[1,1,0]
    v_pk_fma_f32 v[118:119], v[118:119], s[14:15], v[34:35] op_sel_hi:[1,1,0]
    v_pk_fma_f32 v[120:121], v[120:121], s[14:15], v[34:35] op_sel_hi:[1,1,0]
    v_pk_fma_f32 v[122:123], v[122:123], s[14:15], v[34:35] op_sel_hi:[1,1,0]
    v_pk_fma_f32 v[124:125], v[124:125], s[14:15], v[34:35] op_sel_hi:[1,1,0]
    v_pk_fma_f32 v[126:127], v[126:127], s[14:15], v[34:35] op_sel_hi:[1,1,0]
    v_mfma_f32_32x32x16_bf16 v[16:31], a[160:163], v[96:99], v[16:31]
    v_exp_f32 v112, v112 clamp
    v_exp_f32 v113, v113 clamp
    v_exp_f32 v114, v114 clamp
    v_exp_f32 v115, v115 clamp
    v_exp_f32 v116, v116 clamp
    v_exp_f32 v117, v117 clamp
    v_mfma_f32_32x32x16_bf16 v[16:31], a[164:167], v[100:103], v[16:31]
    v_exp_f32 v118, v118 clamp
    v_exp_f32 v119, v119 clamp
    v_exp_f32 v120, v120 clamp
    v_exp_f32 v121, v121 clamp
    v_exp_f32 v122, v122 clamp
    v_exp_f32 v123, v123 clamp
    buffer_load_dwordx4 a[108:111], v2, s[16:19], s87 offen offset:3072 sc1
    v_exp_f32 v124, v124 clamp
    v_exp_f32 v125, v125 clamp
    v_exp_f32 v126, v126 clamp
    v_exp_f32 v127, v127 clamp
    s_add_u32 s87, s80, 0x187000
    buffer_load_dwordx4 a[112:115], v2, s[16:19], s87 offen offset:0 sc1
    v_cvt_pk_bf16_f32 v112, v112, v113
    v_cvt_pk_bf16_f32 v113, v114, v115
    v_cvt_pk_bf16_f32 v114, v116, v117
    v_cvt_pk_bf16_f32 v115, v118, v119
    buffer_load_dwordx4 a[116:119], v2, s[16:19], s87 offen offset:1024 sc1
    v_cvt_pk_bf16_f32 v116, v120, v121
    v_cvt_pk_bf16_f32 v117, v122, v123
    v_cvt_pk_bf16_f32 v118, v124, v125
    v_cvt_pk_bf16_f32 v119, v126, v127
    v_pk_fma_f32 v[128:129], v[128:129], s[14:15], v[34:35] op_sel_hi:[1,1,0]
    v_pk_fma_f32 v[130:131], v[130:131], s[14:15], v[34:35] op_sel_hi:[1,1,0]
    v_pk_fma_f32 v[132:133], v[132:133], s[14:15], v[34:35] op_sel_hi:[1,1,0]
    v_pk_fma_f32 v[134:135], v[134:135], s[14:15], v[34:35] op_sel_hi:[1,1,0]
    v_pk_fma_f32 v[136:137], v[136:137], s[14:15], v[34:35] op_sel_hi:[1,1,0]
    v_pk_fma_f32 v[138:139], v[138:139], s[14:15], v[34:35] op_sel_hi:[1,1,0]
    v_pk_fma_f32 v[140:141], v[140:141], s[14:15], v[34:35] op_sel_hi:[1,1,0]
    v_pk_fma_f32 v[142:143], v[142:143], s[14:15], v[34:35] op_sel_hi:[1,1,0]
    v_mfma_f32_32x32x16_bf16 v[16:31], a[168:171], v[112:115], v[16:31]
    v_exp_f32 v128, v128 clamp
    v_exp_f32 v129, v129 clamp
    v_exp_f32 v130, v130 clamp
    v_exp_f32 v131, v131 clamp
    v_exp_f32 v132, v132 clamp
    v_exp_f32 v133, v133 clamp
    v_mfma_f32_32x32x16_bf16 v[16:31], a[172:175], v[116:119], v[16:31]
    v_exp_f32 v134, v134 clamp
    v_exp_f32 v135, v135 clamp
    v_exp_f32 v136, v136 clamp
    v_exp_f32 v137, v137 clamp
    v_exp_f32 v138, v138 clamp
    v_exp_f32 v139, v139 clamp
    buffer_load_dwordx4 a[120:123], v2, s[16:19], s87 offen offset:2048 sc1
    v_exp_f32 v140, v140 clamp
    v_exp_f32 v141, v141 clamp
    v_exp_f32 v142, v142 clamp
    v_exp_f32 v143, v143 clamp
    buffer_load_dwordx4 a[124:127], v2, s[16:19], s87 offen offset:3072 sc1
    v_cvt_pk_bf16_f32 v128, v128, v129
    v_cvt_pk_bf16_f32 v129, v130, v131
    v_cvt_pk_bf16_f32 v130, v132, v133
    v_cvt_pk_bf16_f32 v131, v134, v135
    v_cvt_pk_bf16_f32 v132, v136, v137
    v_cvt_pk_bf16_f32 v133, v138, v139
    v_cvt_pk_bf16_f32 v134, v140, v141
    v_cvt_pk_bf16_f32 v135, v142, v143
    v_pk_fma_f32 v[144:145], v[144:145], s[14:15], v[34:35] op_sel_hi:[1,1,0]
    v_pk_fma_f32 v[146:147], v[146:147], s[14:15], v[34:35] op_sel_hi:[1,1,0]
    v_pk_fma_f32 v[148:149], v[148:149], s[14:15], v[34:35] op_sel_hi:[1,1,0]
    v_pk_fma_f32 v[150:151], v[150:151], s[14:15], v[34:35] op_sel_hi:[1,1,0]
    v_pk_fma_f32 v[152:153], v[152:153], s[14:15], v[34:35] op_sel_hi:[1,1,0]
    v_pk_fma_f32 v[154:155], v[154:155], s[14:15], v[34:35] op_sel_hi:[1,1,0]
    v_pk_fma_f32 v[156:157], v[156:157], s[14:15], v[34:35] op_sel_hi:[1,1,0]
    v_pk_fma_f32 v[158:159], v[158:159], s[14:15], v[34:35] op_sel_hi:[1,1,0]
    v_mfma_f32_32x32x16_bf16 v[16:31], a[176:179], v[128:131], v[16:31]
    v_exp_f32 v144, v144 clamp
    v_exp_f32 v145, v145 clamp
    v_exp_f32 v146, v146 clamp
    v_exp_f32 v147, v147 clamp
    v_exp_f32 v148, v148 clamp
    v_exp_f32 v149, v149 clamp
    v_mfma_f32_32x32x16_bf16 v[16:31], a[180:183], v[132:135], v[16:31]
    v_exp_f32 v150, v150 clamp
    v_exp_f32 v151, v151 clamp
    v_exp_f32 v152, v152 clamp
    v_exp_f32 v153, v153 clamp
    v_exp_f32 v154, v154 clamp
    v_exp_f32 v155, v155 clamp
    v_exp_f32 v156, v156 clamp
    v_exp_f32 v157, v157 clamp
    v_exp_f32 v158, v158 clamp
    v_exp_f32 v159, v159 clamp
    v_cvt_pk_bf16_f32 v144, v144, v145
    v_cvt_pk_bf16_f32 v145, v146, v147
    v_cvt_pk_bf16_f32 v146, v148, v149
    v_cvt_pk_bf16_f32 v147, v150, v151
    v_cvt_pk_bf16_f32 v148, v152, v153
    v_cvt_pk_bf16_f32 v149, v154, v155
    v_cvt_pk_bf16_f32 v150, v156, v157
    v_cvt_pk_bf16_f32 v151, v158, v159
    s_lshl_b32 s31, s10, 8
    s_add_u32 s31, s31, 0x440000
    v_lshlrev_b32 v253, 3, v1
    v_add_u32 v253, s31, v253
    s_mov_b32 exec_lo, 0xffffffff
    s_mov_b32 exec_hi, 0x0
    buffer_load_dwordx2 v[36:37], v253, s[16:19], 0 offen sc1
    s_mov_b64 exec, -1
    v_and_b32 v240, 15, v1
    v_lshrrev_b32 v241, 5, v1
    v_bfe_u32 v242, v1, 4, 1
    v_lshl_add_u32 v243, v242, 5, v240
    v_lshlrev_b32 v243, 4, v243
    v_lshl_add_u32 v243, v241, 10, v243
    s_and_b32 s31, s12, 1
    s_lshl_b32 s31, s31, 8
    v_add_u32 v6, s31, v243
    s_lshl_b32 s3, s10, 16
    s_lshr_b32 s28, s12, 1
    s_lshl_b32 s30, s28, 15
    s_add_u32 s3, s3, s30
    s_add_u32 s28, s28, 10
    v_pk_fma_f32 v[176:177], v[176:177], s[14:15], v[34:35] op_sel_hi:[1,1,0]
    v_pk_fma_f32 v[178:179], v[178:179], s[14:15], v[34:35] op_sel_hi:[1,1,0]
    v_pk_fma_f32 v[180:181], v[180:181], s[14:15], v[34:35] op_sel_hi:[1,1,0]
    v_pk_fma_f32 v[182:183], v[182:183], s[14:15], v[34:35] op_sel_hi:[1,1,0]
    v_pk_fma_f32 v[184:185], v[184:185], s[14:15], v[34:35] op_sel_hi:[1,1,0]
    v_pk_fma_f32 v[186:187], v[186:187], s[14:15], v[34:35] op_sel_hi:[1,1,0]
    v_pk_fma_f32 v[188:189], v[188:189], s[14:15], v[34:35] op_sel_hi:[1,1,0]
    v_pk_fma_f32 v[190:191], v[190:191], s[14:15], v[34:35] op_sel_hi:[1,1,0]
    v_mfma_f32_32x32x16_bf16 v[16:31], a[184:187], v[144:147], v[16:31]
    v_exp_f32 v176, v176
    v_exp_f32 v177, v177
    v_exp_f32 v178, v178
    v_exp_f32 v179, v179
    v_exp_f32 v180, v180
    v_exp_f32 v181, v181
    v_mfma_f32_32x32x16_bf16 v[16:31], a[188:191], v[148:151], v[16:31]
    v_exp_f32 v182, v182
    v_exp_f32 v183, v183
    v_exp_f32 v184, v184
    v_exp_f32 v185, v185
    v_exp_f32 v186, v186
    v_exp_f32 v187, v187
    v_exp_f32 v188, v188
    v_exp_f32 v189, v189
    v_exp_f32 v190, v190
    v_exp_f32 v191, v191
    v_cvt_pk_bf16_f32 v176, v176, v177
    v_cvt_pk_bf16_f32 v177, v178, v179
    v_cvt_pk_bf16_f32 v178, v180, v181
    v_cvt_pk_bf16_f32 v179, v182, v183
    v_cvt_pk_bf16_f32 v180, v184, v185
    v_cvt_pk_bf16_f32 v181, v186, v187
    v_cvt_pk_bf16_f32 v182, v188, v189
    v_cvt_pk_bf16_f32 v183, v190, v191
    v_mfma_f32_32x32x16_bf16 v[16:31], v[232:235], v[176:179], v[16:31]
    s_nop 0
    v_mfma_f32_32x32x16_bf16 v[16:31], v[224:227], v[180:183], v[16:31]
    s_nop 11
    v_rcp_f32 v38, v24
    s_nop 0
    v_pk_mul_f32 v[16:17], v[16:17], v[38:39] op_sel_hi:[1,0]
    v_pk_mul_f32 v[18:19], v[18:19], v[38:39] op_sel_hi:[1,0]
    v_pk_mul_f32 v[20:21], v[20:21], v[38:39] op_sel_hi:[1,0]
    v_pk_mul_f32 v[22:23], v[22:23], v[38:39] op_sel_hi:[1,0]
    v_cvt_pk_bf16_f32 v44, v16, v17
    v_cvt_pk_bf16_f32 v45, v18, v19
    v_cvt_pk_bf16_f32 v46, v20, v21
    v_cvt_pk_bf16_f32 v47, v22, v23
    s_add_u32 s65, s85, 0x908000
    s_cmp_eq_u32 s97, 1
    s_cbranch_scc0 slow24
    buffer_store_dwordx4 v[44:47], v2, s[16:19], s65 offen
back24:
    s_waitcnt vmcnt(1)
    s_mov_b32 exec_lo, 0xffffffff
    s_mov_b32 exec_hi, 0x0
    v_subrev_u32 v36, s72, v36
    v_cmp_eq_u32 s[74:75], s73, v37
    v_cmp_gt_u32 s[76:77], 32, v36
    v_cmp_le_u32 vcc, s28, v36
    s_and_b64 s[74:75], s[74:75], s[76:77]
    s_and_b64 vcc, vcc, s[74:75]
    s_cmp_eq_u64 vcc, exec
    s_cselect_b32 s1, 1, 0
    s_mov_b64 exec, -1
    s_cbranch_scc0 oaB1
    s_add_u32 s66, s3, 0x900000
    buffer_load_dwordx4 v[16:19], v6, s[16:19], s66 offen offset:0 sc1
    buffer_load_dwordx4 v[20:23], v6, s[16:19], s66 offen offset:2048 sc1
    s_add_u32 s67, s3, 0x901000
    buffer_load_dwordx4 v[24:27], v6, s[16:19], s67 offen offset:0 sc1
    buffer_load_dwordx4 v[28:31], v6, s[16:19], s67 offen offset:2048 sc1
    s_add_u32 s68, s3, 0x902000
    buffer_load_dwordx4 v[32:35], v6, s[16:19], s68 offen offset:0 sc1
    buffer_load_dwordx4 v[36:39], v6, s[16:19], s68 offen offset:2048 sc1
    s_add_u32 s69, s3, 0x903000
    buffer_load_dwordx4 v[40:43], v6, s[16:19], s69 offen offset:0 sc1
    buffer_load_dwordx4 v[44:47], v6, s[16:19], s69 offen offset:2048 sc1
    s_add_u32 s70, s3, 0x904000
    buffer_load_dwordx4 v[48:51], v6, s[16:19], s70 offen offset:0 sc1
    buffer_load_dwordx4 v[52:55], v6, s[16:19], s70 offen offset:2048 sc1
    s_add_u32 s71, s3, 0x905000
    buffer_load_dwordx4 v[56:59], v6, s[16:19], s71 offen offset:0 sc1
    buffer_load_dwordx4 v[60:63], v6, s[16:19], s71 offen offset:2048 sc1
    s_add_u32 s64, s3, 0x906000
    buffer_load_dwordx4 v[64:67], v6, s[16:19], s64 offen offset:0 sc1
    buffer_load_dwordx4 v[68:71], v6, s[16:19], s64 offen offset:2048 sc1
    s_add_u32 s65, s3, 0x907000
    buffer_load_dwordx4 v[72:75], v6, s[16:19], s65 offen offset:0 sc1
    buffer_load_dwordx4 v[76:79], v6, s[16:19], s65 offen offset:2048 sc1
    s_add_u32 s30, s72, 11
    v_mov_b32 v4, s30
    v_mov_b32 v5, s73
    s_waitcnt vmcnt(16)
    s_mov_b64 exec, 1
    s_cmp_eq_u32 s97, 1
    s_cbranch_scc0 slow25
    buffer_store_dwordx2 v[4:5], v1, s[16:19], s0 offen
back25:
    s_mov_b64 exec, -1
    s_branch oaJ1
oaB1:
    s_add_u32 s30, s72, 11
    v_mov_b32 v4, s30
    v_mov_b32 v5, s73
    s_waitcnt vmcnt(0)
    s_mov_b64 exec, 1
    s_cmp_eq_u32 s97, 1
    s_cbranch_scc0 slow26
    buffer_store_dwordx2 v[4:5], v1, s[16:19], s0 offen
back26:
    s_mov_b64 exec, -1
oaJ1:
    v_bfe_u32 v244, v1, 2, 3
    v_lshl_add_u32 v244, v241, 4, v244
    v_lshlrev_b32 v244, 7, v244
    v_bfe_u32 v245, v1, 3, 2
    v_lshl_add_u32 v244, v245, 5, v244
    v_and_b32 v245, 3, v1
    v_lshl_add_u32 v244, v245, 3, v244
    v_add_u32 v232, 65536, v244
    v_xor_b32 v233, 32, v232
    v_xor_b32 v234, 64, v232
    v_xor_b32 v235, 96, v232
    s_lshl_b32 s31, s11, 11
    s_add_u32 s31, s31, s82
    v_lshl_add_u32 v244, v241, 4, v240
    v_lshlrev_b32 v244, 4, v244
    v_lshl_add_u32 v244, v242, 3, v244
    v_add_u32 v244, s31, v244
    ds_read_b64 v[224:225], v244 offset:0
    ds_read_b64 v[226:227], v244 offset:512
    ds_read_b64 v[228:229], v244 offset:1024
    ds_read_b64 v[230:231], v244 offset:1536
    ds_read_b64_tr_b16 v[96:97], v232 offset:0
    ds_read_b64_tr_b16 v[98:99], v232 offset:1024
    ds_read_b64_tr_b16 v[100:101], v233 offset:0
    ds_read_b64_tr_b16 v[102:103], v233 offset:1024
    ds_read_b64_tr_b16 v[104:105], v234 offset:0
    ds_read_b64_tr_b16 v[106:107], v234 offset:1024
    ds_read_b64_tr_b16 v[108:109], v235 offset:0
    ds_read_b64_tr_b16 v[110:111], v235 offset:1024
    ds_read_b64_tr_b16 v[112:113], v232 offset:4096
    ds_read_b64_tr_b16 v[114:115], v232 offset:5120
    ds_read_b64_tr_b16 v[116:117], v233 offset:4096
    ds_read_b64_tr_b16 v[118:119], v233 offset:5120
    v_lshl_add_u32 v246, v242, 1, v241
    v_lshl_add_u32 v246, v246, 4, v240
    v_lshlrev_b32 v246, 4, v246
    v_add_u32 v250, s82, v246
    s_lshl_b32 s31, s12, 10
    v_add_u32 v251, s31, v2
    s_waitcnt lgkmcnt(12)
    v_lshlrev_b32 v80, 16, v224
    v_and_b32 v81, 0xffff0000, v224
    v_lshlrev_b32 v82, 16, v225
    v_and_b32 v83, 0xffff0000, v225
    v_lshlrev_b32 v84, 16, v226
    v_and_b32 v85, 0xffff0000, v226
    v_lshlrev_b32 v86, 16, v227
    v_and_b32 v87, 0xffff0000, v227
    v_lshlrev_b32 v88, 16, v228
    v_and_b32 v89, 0xffff0000, v228
    v_lshlrev_b32 v90, 16, v229
    v_and_b32 v91, 0xffff0000, v229
    v_lshlrev_b32 v92, 16, v230
    v_and_b32 v93, 0xffff0000, v230
    v_lshlrev_b32 v94, 16, v231
    v_and_b32 v95, 0xffff0000, v231
    ds_read_b64_tr_b16 v[120:121], v234 offset:4096
    ds_read_b64_tr_b16 v[122:123], v234 offset:5120
    ds_read_b64_tr_b16 v[124:125], v235 offset:4096
    ds_read_b64_tr_b16 v[126:127], v235 offset:5120
    ds_read_b64_tr_b16 v[128:129], v232 offset:8192
    ds_read_b64_tr_b16 v[130:131], v232 offset:9216
    ds_read_b64_tr_b16 v[132:133], v233 offset:8192
    ds_read_b64_tr_b16 v[134:135], v233 offset:9216
    ds_read_b64_tr_b16 v[136:137], v234 offset:8192
    ds_read_b64_tr_b16 v[138:139], v234 offset:9216
    ds_read_b64_tr_b16 v[140:141], v235 offset:8192
    ds_read_b64_tr_b16 v[142:143], v235 offset:9216
    ds_read_b64_tr_b16 v[144:145], v232 offset:12288
    ds_read_b64_tr_b16 v[146:147], v232 offset:13312
    ds_read_b64_tr_b16 v[148:149], v233 offset:12288
    ds_read_b64_tr_b16 v[150:151], v233 offset:13312
    ds_read_b64_tr_b16 v[152:153], v234 offset:12288
    ds_read_b64_tr_b16 v[154:155], v234 offset:13312
    ds_read_b64_tr_b16 v[156:157], v235 offset:12288
    ds_read_b64_tr_b16 v[158:159], v235 offset:13312
    s_cmp_eq_u32 s1, 1
    s_cbranch_scc1 oaG1
    s_mov_b32 exec_lo, 0xffffffff
    s_mov_b32 exec_hi, 0x0
    s_mov_b32 s30, 0
poll27:
    buffer_load_dwordx2 v[4:5], v253, s[16:19], 0 offen sc1
poll27_c:
    s_waitcnt vmcnt(0)
poll27_l:
    s_add_u32 s30, s30, 1
    v_subrev_u32 v4, s72, v4
    v_cmp_eq_u32 s[74:75], s73, v5
    v_cmp_gt_u32 s[76:77], 32, v4
    v_cmp_le_u32 vcc, s28, v4
    s_and_b64 s[74:75], s[74:75], s[76:77]
    s_and_b64 vcc, vcc, s[74:75]
    s_cmp_eq_u64 vcc, exec
    s_cbranch_scc1 poll27_x
    s_cmp_gt_u32 s30, 0x8000
    s_cbranch_scc0 poll27
poll27_x:
    s_mov_b64 exec, -1
    s_add_u32 s66, s3, 0x900000
    buffer_load_dwordx4 v[16:19], v6, s[16:19], s66 offen offset:0 sc1
    buffer_load_dwordx4 v[20:23], v6, s[16:19], s66 offen offset:2048 sc1
    s_add_u32 s67, s3, 0x901000
    buffer_load_dwordx4 v[24:27], v6, s[16:19], s67 offen offset:0 sc1
    buffer_load_dwordx4 v[28:31], v6, s[16:19], s67 offen offset:2048 sc1
    s_add_u32 s68, s3, 0x902000
    buffer_load_dwordx4 v[32:35], v6, s[16:19], s68 offen offset:0 sc1
    buffer_load_dwordx4 v[36:39], v6, s[16:19], s68 offen offset:2048 sc1
    s_add_u32 s69, s3, 0x903000
    buffer_load_dwordx4 v[40:43], v6, s[16:19], s69 offen offset:0 sc1
    buffer_load_dwordx4 v[44:47], v6, s[16:19], s69 offen offset:2048 sc1
    s_add_u32 s70, s3, 0x904000
    buffer_load_dwordx4 v[48:51], v6, s[16:19], s70 offen offset:0 sc1
    buffer_load_dwordx4 v[52:55], v6, s[16:19], s70 offen offset:2048 sc1
    s_add_u32 s71, s3, 0x905000
    buffer_load_dwordx4 v[56:59], v6, s[16:19], s71 offen offset:0 sc1
    buffer_load_dwordx4 v[60:63], v6, s[16:19], s71 offen offset:2048 sc1
    s_add_u32 s64, s3, 0x906000
    buffer_load_dwordx4 v[64:67], v6, s[16:19], s64 offen offset:0 sc1
    buffer_load_dwordx4 v[68:71], v6, s[16:19], s64 offen offset:2048 sc1
    s_add_u32 s65, s3, 0x907000
    buffer_load_dwordx4 v[72:75], v6, s[16:19], s65 offen offset:0 sc1
    buffer_load_dwordx4 v[76:79], v6, s[16:19], s65 offen offset:2048 sc1
oaG1:
    s_waitcnt vmcnt(15)
    v_mfma_f32_16x16x32_bf16 v[80:83], v[96:99], v[16:19], v[80:83]
    ds_read_b64_tr_b16 v[160:161], v232 offset:16384
    ds_read_b64_tr_b16 v[162:163], v232 offset:17408
    v_mfma_f32_16x16x32_bf16 v[84:87], v[100:103], v[16:19], v[84:87]
    ds_read_b64_tr_b16 v[164:165], v233 offset:16384
    ds_read_b64_tr_b16 v[166:167], v233 offset:17408
    v_mfma_f32_16x16x32_bf16 v[88:91], v[104:107], v[16:19], v[88:91]
    ds_read_b64_tr_b16 v[168:169], v234 offset:16384
    ds_read_b64_tr_b16 v[170:171], v234 offset:17408
    v_mfma_f32_16x16x32_bf16 v[92:95], v[108:111], v[16:19], v[92:95]
    ds_read_b64_tr_b16 v[172:173], v235 offset:16384
    ds_read_b64_tr_b16 v[174:175], v235 offset:17408
    s_waitcnt vmcnt(14)
    v_mfma_f32_16x16x32_bf16 v[80:83], v[112:115], v[20:23], v[80:83]
    ds_read_b64_tr_b16 v[176:177], v232 offset:20480
    ds_read_b64_tr_b16 v[178:179], v232 offset:21504
    v_mfma_f32_16x16x32_bf16 v[84:87], v[116:119], v[20:23], v[84:87]
    ds_read_b64_tr_b16 v[180:181], v233 offset:20480
    ds_read_b64_tr_b16 v[182:183], v233 offset:21504
    v_mfma_f32_16x16x32_bf16 v[88:91], v[120:123], v[20:23], v[88:91]
    ds_read_b64_tr_b16 v[184:185], v234 offset:20480
    ds_read_b64_tr_b16 v[186:187], v234 offset:21504
    v_mfma_f32_16x16x32_bf16 v[92:95], v[124:127], v[20:23], v[92:95]
    ds_read_b64_tr_b16 v[188:189], v235 offset:20480
    ds_read_b64_tr_b16 v[190:191], v235 offset:21504
    s_waitcnt vmcnt(13)
    v_mfma_f32_16x16x32_bf16 v[80:83], v[128:131], v[24:27], v[80:83]
    ds_read_b64_tr_b16 v[192:193], v232 offset:24576
    ds_read_b64_tr_b16 v[194:195], v232 offset:25600
    v_mfma_f32_16x16x32_bf16 v[84:87], v[132:135], v[24:27], v[84:87]
    ds_read_b64_tr_b16 v[196:197], v233 offset:24576
    ds_read_b64_tr_b16 v[198:199], v233 offset:25600
    v_mfma_f32_16x16x32_bf16 v[88:91], v[136:139], v[24:27], v[88:91]
    ds_read_b64_tr_b16 v[200:201], v234 offset:24576
    ds_read_b64_tr_b16 v[202:203], v234 offset:25600
    v_mfma_f32_16x16x32_bf16 v[92:95], v[140:143], v[24:27], v[92:95]
    ds_read_b64_tr_b16 v[204:205], v235 offset:24576
    ds_read_b64_tr_b16 v[206:207], v235 offset:25600
    s_waitcnt vmcnt(12)
    v_mfma_f32_16x16x32_bf16 v[80:83], v[144:147], v[28:31], v[80:83]
    ds_read_b64_tr_b16 v[208:209], v232 offset:28672
    ds_read_b64_tr_b16 v[210:211], v232 offset:29696
    v_mfma_f32_16x16x32_bf16 v[84:87], v[148:151], v[28:31], v[84:87]
    ds_read_b64_tr_b16 v[212:213], v233 offset:28672
    ds_read_b64_tr_b16 v[214:215], v233 offset:29696
    v_mfma_f32_16x16x32_bf16 v[88:91], v[152:155], v[28:31], v[88:91]
    ds_read_b64_tr_b16 v[216:217], v234 offset:28672
    ds_read_b64_tr_b16 v[218:219], v234 offset:29696
    v_mfma_f32_16x16x32_bf16 v[92:95], v[156:159], v[28:31], v[92:95]
    ds_read_b64_tr_b16 v[220:221], v235 offset:28672
    ds_read_b64_tr_b16 v[222:223], v235 offset:29696
    s_waitcnt vmcnt(11)
    v_mfma_f32_16x16x32_bf16 v[80:83], v[160:163], v[32:35], v[80:83]
    ds_read_b64_tr_b16 v[96:97], v232 offset:32768
    ds_read_b64_tr_b16 v[98:99], v232 offset:33792
    v_mfma_f32_16x16x32_bf16 v[84:87], v[164:167], v[32:35], v[84:87]
    ds_read_b64_tr_b16 v[100:101], v233 offset:32768
    ds_read_b64_tr_b16 v[102:103], v233 offset:33792
    v_mfma_f32_16x16x32_bf16 v[88:91], v[168:171], v[32:35], v[88:91]
    ds_read_b64_tr_b16 v[104:105], v234 offset:32768
    ds_read_b64_tr_b16 v[106:107], v234 offset:33792
    v_mfma_f32_16x16x32_bf16 v[92:95], v[172:175], v[32:35], v[92:95]
    ds_read_b64_tr_b16 v[108:109], v235 offset:32768
    ds_read_b64_tr_b16 v[110:111], v235 offset:33792
    s_waitcnt vmcnt(10)
    v_mfma_f32_16x16x32_bf16 v[80:83], v[176:179], v[36:39], v[80:83]
    ds_read_b64_tr_b16 v[112:113], v232 offset:36864
    ds_read_b64_tr_b16 v[114:115], v232 offset:37888
    v_mfma_f32_16x16x32_bf16 v[84:87], v[180:183], v[36:39], v[84:87]
    ds_read_b64_tr_b16 v[116:117], v233 offset:36864
    ds_read_b64_tr_b16 v[118:119], v233 offset:37888
    v_mfma_f32_16x16x32_bf16 v[88:91], v[184:187], v[36:39], v[88:91]
    ds_read_b64_tr_b16 v[120:121], v234 offset:36864
    ds_read_b64_tr_b16 v[122:123], v234 offset:37888
    v_mfma_f32_16x16x32_bf16 v[92:95], v[188:191], v[36:39], v[92:95]
    ds_read_b64_tr_b16 v[124:125], v235 offset:36864
    ds_read_b64_tr_b16 v[126:127], v235 offset:37888
    s_waitcnt vmcnt(9)
    v_mfma_f32_16x16x32_bf16 v[80:83], v[192:195], v[40:43], v[80:83]
    ds_read_b64_tr_b16 v[128:129], v232 offset:40960
    ds_read_b64_tr_b16 v[130:131], v232 offset:41984
    v_mfma_f32_16x16x32_bf16 v[84:87], v[196:199], v[40:43], v[84:87]
    ds_read_b64_tr_b16 v[132:133], v233 offset:40960
    ds_read_b64_tr_b16 v[134:135], v233 offset:41984
    v_mfma_f32_16x16x32_bf16 v[88:91], v[200:203], v[40:43], v[88:91]
    ds_read_b64_tr_b16 v[136:137], v234 offset:40960
    ds_read_b64_tr_b16 v[138:139], v234 offset:41984
    v_mfma_f32_16x16x32_bf16 v[92:95], v[204:207], v[40:43], v[92:95]
    ds_read_b64_tr_b16 v[140:141], v235 offset:40960
    ds_read_b64_tr_b16 v[142:143], v235 offset:41984
    s_waitcnt vmcnt(8)
    v_mfma_f32_16x16x32_bf16 v[80:83], v[208:211], v[44:47], v[80:83]
    ds_read_b64_tr_b16 v[144:145], v232 offset:45056
    ds_read_b64_tr_b16 v[146:147], v232 offset:46080
    v_mfma_f32_16x16x32_bf16 v[84:87], v[212:215], v[44:47], v[84:87]
    ds_read_b64_tr_b16 v[148:149], v233 offset:45056
    ds_read_b64_tr_b16 v[150:151], v233 offset:46080
    v_mfma_f32_16x16x32_bf16 v[88:91], v[216:219], v[44:47], v[88:91]
    ds_read_b64_tr_b16 v[152:153], v234 offset:45056
    ds_read_b64_tr_b16 v[154:155], v234 offset:46080
    v_mfma_f32_16x16x32_bf16 v[92:95], v[220:223], v[44:47], v[92:95]
    ds_read_b64_tr_b16 v[156:157], v235 offset:45056
    ds_read_b64_tr_b16 v[158:159], v235 offset:46080
    s_waitcnt vmcnt(7)
    v_mfma_f32_16x16x32_bf16 v[80:83], v[96:99], v[48:51], v[80:83]
    ds_read_b64_tr_b16 v[160:161], v232 offset:49152
    ds_read_b64_tr_b16 v[162:163], v232 offset:50176
    v_mfma_f32_16x16x32_bf16 v[84:87], v[100:103], v[48:51], v[84:87]
    ds_read_b64_tr_b16 v[164:165], v233 offset:49152
    ds_read_b64_tr_b16 v[166:167], v233 offset:50176
    v_mfma_f32_16x16x32_bf16 v[88:91], v[104:107], v[48:51], v[88:91]
    ds_read_b64_tr_b16 v[168:169], v234 offset:49152
    ds_read_b64_tr_b16 v[170:171], v234 offset:50176
    v_mfma_f32_16x16x32_bf16 v[92:95], v[108:111], v[48:51], v[92:95]
    ds_read_b64_tr_b16 v[172:173], v235 offset:49152
    ds_read_b64_tr_b16 v[174:175], v235 offset:50176
    s_waitcnt vmcnt(6)
    v_mfma_f32_16x16x32_bf16 v[80:83], v[112:115], v[52:55], v[80:83]
    ds_read_b64_tr_b16 v[176:177], v232 offset:53248
    ds_read_b64_tr_b16 v[178:179], v232 offset:54272
    v_mfma_f32_16x16x32_bf16 v[84:87], v[116:119], v[52:55], v[84:87]
    ds_read_b64_tr_b16 v[180:181], v233 offset:53248
    ds_read_b64_tr_b16 v[182:183], v233 offset:54272
    v_mfma_f32_16x16x32_bf16 v[88:91], v[120:123], v[52:55], v[88:91]
    ds_read_b64_tr_b16 v[184:185], v234 offset:53248
    ds_read_b64_tr_b16 v[186:187], v234 offset:54272
    v_mfma_f32_16x16x32_bf16 v[92:95], v[124:127], v[52:55], v[92:95]
    ds_read_b64_tr_b16 v[188:189], v235 offset:53248
    ds_read_b64_tr_b16 v[190:191], v235 offset:54272
    s_waitcnt vmcnt(5)
    v_mfma_f32_16x16x32_bf16 v[80:83], v[128:131], v[56:59], v[80:83]
    ds_read_b64_tr_b16 v[192:193], v232 offset:57344
    ds_read_b64_tr_b16 v[194:195], v232 offset:58368
    v_mfma_f32_16x16x32_bf16 v[84:87], v[132:135], v[56:59], v[84:87]
    ds_read_b64_tr_b16 v[196:197], v233 offset:57344
    ds_read_b64_tr_b16 v[198:199], v233 offset:58368
    v_mfma_f32_16x16x32_bf16 v[88:91], v[136:139], v[56:59], v[88:91]
    ds_read_b64_tr_b16 v[200:201], v234 offset:57344
    ds_read_b64_tr_b16 v[202:203], v234 offset:58368
    v_mfma_f32_16x16x32_bf16 v[92:95], v[140:143], v[56:59], v[92:95]
    ds_read_b64_tr_b16 v[204:205], v235 offset:57344
    ds_read_b64_tr_b16 v[206:207], v235 offset:58368
    s_waitcnt vmcnt(4)
    v_mfma_f32_16x16x32_bf16 v[80:83], v[144:147], v[60:63], v[80:83]
    ds_read_b64_tr_b16 v[208:209], v232 offset:61440
    ds_read_b64_tr_b16 v[210:211], v232 offset:62464
    v_mfma_f32_16x16x32_bf16 v[84:87], v[148:151], v[60:63], v[84:87]
    ds_read_b64_tr_b16 v[212:213], v233 offset:61440
    ds_read_b64_tr_b16 v[214:215], v233 offset:62464
    v_mfma_f32_16x16x32_bf16 v[88:91], v[152:155], v[60:63], v[88:91]
    ds_read_b64_tr_b16 v[216:217], v234 offset:61440
    ds_read_b64_tr_b16 v[218:219], v234 offset:62464
    v_mfma_f32_16x16x32_bf16 v[92:95], v[156:159], v[60:63], v[92:95]
    ds_read_b64_tr_b16 v[220:221], v235 offset:61440
    ds_read_b64_tr_b16 v[222:223], v235 offset:62464
    s_waitcnt vmcnt(3)
    v_mfma_f32_16x16x32_bf16 v[80:83], v[160:163], v[64:67], v[80:83]
    v_mfma_f32_16x16x32_bf16 v[84:87], v[164:167], v[64:67], v[84:87]
    v_mfma_f32_16x16x32_bf16 v[88:91], v[168:171], v[64:67], v[88:91]
    v_mfma_f32_16x16x32_bf16 v[92:95], v[172:175], v[64:67], v[92:95]
    s_waitcnt vmcnt(2)
    v_mfma_f32_16x16x32_bf16 v[80:83], v[176:179], v[68:71], v[80:83]
    v_mfma_f32_16x16x32_bf16 v[84:87], v[180:183], v[68:71], v[84:87]
    v_mfma_f32_16x16x32_bf16 v[88:91], v[184:187], v[68:71], v[88:91]
    v_mfma_f32_16x16x32_bf16 v[92:95], v[188:191], v[68:71], v[92:95]
    s_waitcnt vmcnt(1) lgkmcnt(8)
    v_mfma_f32_16x16x32_bf16 v[80:83], v[192:195], v[72:75], v[80:83]
    v_mfma_f32_16x16x32_bf16 v[84:87], v[196:199], v[72:75], v[84:87]
    v_mfma_f32_16x16x32_bf16 v[88:91], v[200:203], v[72:75], v[88:91]
    v_mfma_f32_16x16x32_bf16 v[92:95], v[204:207], v[72:75], v[92:95]
    s_waitcnt vmcnt(0) lgkmcnt(0)
    v_mfma_f32_16x16x32_bf16 v[80:83], v[208:211], v[76:79], v[80:83]
    v_mfma_f32_16x16x32_bf16 v[84:87], v[212:215], v[76:79], v[84:87]
    v_mfma_f32_16x16x32_bf16 v[88:91], v[216:219], v[76:79], v[88:91]
    v_mfma_f32_16x16x32_bf16 v[92:95], v[220:223], v[76:79], v[92:95]
    s_add_u32 s66, s91, 0x0
    s_add_u32 s67, s95, 0xd00000
    s_nop 2
    v_cvt_pk_bf16_f32 v240, v80, v81
    v_cvt_pk_bf16_f32 v241, v82, v83
    v_cvt_pk_bf16_f32 v242, v84, v85
    v_cvt_pk_bf16_f32 v243, v86, v87
    v_cvt_pk_bf16_f32 v244, v88, v89
    v_cvt_pk_bf16_f32 v245, v90, v91
    v_cvt_pk_bf16_f32 v246, v92, v93
    v_cvt_pk_bf16_f32 v247, v94, v95
    v_permlane16_swap_b32 v240, v242
    v_permlane16_swap_b32 v241, v243
    v_permlane16_swap_b32 v244, v246
    v_permlane16_swap_b32 v245, v247
    s_cmp_eq_u32 s97, 1
    s_cbranch_scc0 slow28
    buffer_store_dwordx4 v[240:243], v250, s[24:27], s66 offen offset:0
    buffer_store_dwordx4 v[244:247], v250, s[24:27], s66 offen offset:1024
back28:
    v_pk_mul_f32 v[16:17], v[80:81], v[80:81]
    v_pk_add_f32 v[20:21], v[80:81], v[82:83]
    v_pk_fma_f32 v[16:17], v[82:83], v[82:83], v[16:17]
    v_pk_fma_f32 v[16:17], v[84:85], v[84:85], v[16:17]
    v_pk_add_f32 v[20:21], v[20:21], v[84:85]
    v_pk_fma_f32 v[16:17], v[86:87], v[86:87], v[16:17]
    v_pk_add_f32 v[20:21], v[20:21], v[86:87]
    v_pk_fma_f32 v[16:17], v[88:89], v[88:89], v[16:17]
    v_pk_add_f32 v[20:21], v[20:21], v[88:89]
    v_pk_fma_f32 v[16:17], v[90:91], v[90:91], v[16:17]
    v_pk_add_f32 v[20:21], v[20:21], v[90:91]
    v_pk_fma_f32 v[16:17], v[92:93], v[92:93], v[16:17]
    v_pk_add_f32 v[20:21], v[20:21], v[92:93]
    v_pk_fma_f32 v[16:17], v[94:95], v[94:95], v[16:17]
    v_pk_add_f32 v[20:21], v[20:21], v[94:95]
    v_add_f32 v18, v20, v21
    v_add_f32 v19, v16, v17
    s_cmp_eq_u32 s97, 1
    s_cbranch_scc0 slow29
    buffer_store_dwordx2 v[18:19], v251, s[16:19], s67 offen
back29:
    s_add_u32 s30, s72, 12
    v_mov_b32 v4, s30
    v_mov_b32 v5, s73
    s_waitcnt vmcnt(0)
    s_mov_b64 exec, 1
    s_cmp_eq_u32 s97, 1
    s_cbranch_scc0 slow30
    buffer_store_dwordx2 v[4:5], v1, s[16:19], s0 offen
back30:
    s_mov_b64 exec, -1
    v_lshlrev_b32 v6, 5, v1
    s_lshl_b32 s31, s10, 8
    s_add_u32 s31, s31, 0x440000
    s_cmp_ge_u32 s12, 2
    s_cbranch_scc1 qbS1
    s_lshl_b32 s30, s12, 3
    s_add_u32 s30, s30, s31
    v_add_u32 v6, s30, v6
    s_mov_b32 exec_lo, 0xff
    s_mov_b32 exec_hi, 0x0
    s_mov_b32 s30, 0
poll31:
    buffer_load_dwordx2 v[4:5], v6, s[16:19], 0 offen sc1
poll31_c:
    s_waitcnt vmcnt(0)
poll31_l:
    s_add_u32 s30, s30, 1
    v_subrev_u32 v4, s72, v4
    v_cmp_eq_u32 s[74:75], s73, v5
    v_cmp_gt_u32 s[76:77], 32, v4
    v_cmp_le_u32 vcc, 12, v4
    s_and_b64 s[74:75], s[74:75], s[76:77]
    s_and_b64 vcc, vcc, s[74:75]
    s_cmp_eq_u64 vcc, exec
    s_cbranch_scc1 poll31_x
    s_cmp_gt_u32 s30, 0x8000
    s_cbranch_scc0 poll31
poll31_x:
    s_mov_b64 exec, -1
    s_add_u32 m0, s82, 0
    s_add_u32 s86, s81, 0x0
    buffer_load_dwordx4 v2, s[24:27], s86 offen offset:0 sc1 lds
    buffer_load_dwordx4 v2, s[24:27], s86 offen offset:1024 sc1 lds
    buffer_load_dwordx4 v2, s[24:27], s86 offen offset:2048 sc1 lds
    buffer_load_dwordx4 v2, s[24:27], s86 offen offset:3072 sc1 lds
    s_add_u32 m0, s82, 4096
    s_add_u32 s86, s81, 0x1000
    buffer_load_dwordx4 v2, s[24:27], s86 offen offset:0 sc1 lds
    buffer_load_dwordx4 v2, s[24:27], s86 offen offset:1024 sc1 lds
    buffer_load_dwordx4 v2, s[24:27], s86 offen offset:2048 sc1 lds
    buffer_load_dwordx4 v2, s[24:27], s86 offen offset:3072 sc1 lds
    s_add_u32 m0, s82, 8192
    s_add_u32 s86, s81, 0x2000
    buffer_load_dwordx4 v2, s[24:27], s86 offen offset:0 sc1 lds
    buffer_load_dwordx4 v2, s[24:27], s86 offen offset:1024 sc1 lds
    buffer_load_dwordx4 v2, s[24:27], s86 offen offset:2048 sc1 lds
    buffer_load_dwordx4 v2, s[24:27], s86 offen offset:3072 sc1 lds
    s_add_u32 m0, s82, 12288
    s_add_u32 s86, s81, 0x3000
    buffer_load_dwordx4 v2, s[24:27], s86 offen offset:0 sc1 lds
    buffer_load_dwordx4 v2, s[24:27], s86 offen offset:1024 sc1 lds
    buffer_load_dwordx4 v2, s[24:27], s86 offen offset:2048 sc1 lds
    buffer_load_dwordx4 v2, s[24:27], s86 offen offset:3072 sc1 lds
    s_waitcnt vmcnt(8)
    s_branch qbT1
qbS1:
qbT1:
    s_and_b32 s30, s12, 1
    s_lshl_b32 s30, s30, 14
    s_lshr_b32 s28, s12, 1
    s_lshl_b32 s28, s28, 12
    s_add_u32 s28, s28, s30
    s_add_u32 s28, s28, 32768
    s_lshl_b32 s3, s10, 16
    s_add_u32 s3, s3, s28
    s_barrier
    ds_read_b128 v[16:19], v2 offset:0
    ds_read_b128 v[20:23], v2 offset:16384
    ds_read_b128 v[32:35], v2 offset:1024
    ds_read_b128 v[36:39], v2 offset:17408
    s_waitcnt lgkmcnt(2)
    v_mfma_f32_16x16x32_bf16 v[48:51], v[16:19], a[0:3], 0
    v_mfma_f32_16x16x32_bf16 v[64:67], v[16:19], a[4:7], 0
    ds_read_b128 v[16:19], v2 offset:2048
    v_mfma_f32_16x16x32_bf16 v[52:55], v[20:23], a[0:3], 0
    v_mfma_f32_16x16x32_bf16 v[68:71], v[20:23], a[4:7], 0
    ds_read_b128 v[20:23], v2 offset:18432
    s_mov_b32 exec_lo, 0xcccccccc
    s_mov_b32 exec_hi, 0x0
    buffer_load_dwordx2 v[4:5], v253, s[16:19], 0 offen sc1
    s_mov_b64 exec, -1
    s_waitcnt lgkmcnt(2)
    v_mfma_f32_16x16x32_bf16 v[48:51], v[32:35], a[8:11], v[48:51]
    v_mfma_f32_16x16x32_bf16 v[64:67], v[32:35], a[12:15], v[64:67]
    ds_read_b128 v[32:35], v2 offset:3072
    v_mfma_f32_16x16x32_bf16 v[52:55], v[36:39], a[8:11], v[52:55]
    v_mfma_f32_16x16x32_bf16 v[68:71], v[36:39], a[12:15], v[68:71]
    ds_read_b128 v[36:39], v2 offset:19456
    s_waitcnt lgkmcnt(2)
    v_mfma_f32_16x16x32_bf16 v[48:51], v[16:19], a[16:19], v[48:51]
    v_mfma_f32_16x16x32_bf16 v[64:67], v[16:19], a[20:23], v[64:67]
    ds_read_b128 v[16:19], v2 offset:4096
    v_mfma_f32_16x16x32_bf16 v[52:55], v[20:23], a[16:19], v[52:55]
    v_mfma_f32_16x16x32_bf16 v[68:71], v[20:23], a[20:23], v[68:71]
    ds_read_b128 v[20:23], v2 offset:20480
    s_waitcnt lgkmcnt(2)
    v_mfma_f32_16x16x32_bf16 v[48:51], v[32:35], a[24:27], v[48:51]
    v_mfma_f32_16x16x32_bf16 v[64:67], v[32:35], a[28:31], v[64:67]
    ds_read_b128 v[32:35], v2 offset:5120
    v_mfma_f32_16x16x32_bf16 v[52:55], v[36:39], a[24:27], v[52:55]
    v_mfma_f32_16x16x32_bf16 v[68:71], v[36:39], a[28:31], v[68:71]
    ds_read_b128 v[36:39], v2 offset:21504
    s_waitcnt lgkmcnt(2)
    v_mfma_f32_16x16x32_bf16 v[48:51], v[16:19], a[32:35], v[48:51]
    v_mfma_f32_16x16x32_bf16 v[64:67], v[16:19], a[36:39], v[64:67]
    ds_read_b128 v[16:19], v2 offset:6144
    v_mfma_f32_16x16x32_bf16 v[52:55], v[20:23], a[32:35], v[52:55]
    v_mfma_f32_16x16x32_bf16 v[68:71], v[20:23], a[36:39], v[68:71]
    ds_read_b128 v[20:23], v2 offset:22528
    s_waitcnt lgkmcnt(2)
    v_mfma_f32_16x16x32_bf16 v[48:51], v[32:35], a[40:43], v[48:51]
    v_mfma_f32_16x16x32_bf16 v[64:67], v[32:35], a[44:47], v[64:67]
    ds_read_b128 v[32:35], v2 offset:7168
    v_mfma_f32_16x16x32_bf16 v[52:55], v[36:39], a[40:43], v[52:55]
    v_mfma_f32_16x16x32_bf16 v[68:71], v[36:39], a[44:47], v[68:71]
    ds_read_b128 v[36:39], v2 offset:23552
    s_waitcnt vmcnt(0)
    s_barrier
    s_mov_b32 exec_lo, 0xcccccccc
    s_mov_b32 exec_hi, 0x0
    s_mov_b32 s30, 0
    s_branch poll32_l
poll32:
    buffer_load_dwordx2 v[4:5], v253, s[16:19], 0 offen sc1
poll32_c:
    s_waitcnt vmcnt(0)
poll32_l:
    s_add_u32 s30, s30, 1
    v_subrev_u32 v4, s72, v4
    v_cmp_eq_u32 s[74:75], s73, v5
    v_cmp_gt_u32 s[76:77], 32, v4
    v_cmp_le_u32 vcc, 12, v4
    s_and_b64 s[74:75], s[74:75], s[76:77]
    s_and_b64 vcc, vcc, s[74:75]
    s_cmp_eq_u64 vcc, exec
    s_cbranch_scc1 poll32_x
    s_cmp_gt_u32 s30, 0x8000
    s_cbranch_scc0 poll32
poll32_x:
    s_mov_b64 exec, -1
    s_waitcnt lgkmcnt(2)
    v_mfma_f32_16x16x32_bf16 v[48:51], v[16:19], a[48:51], v[48:51]
    s_add_u32 m0, s28, 0
    s_add_u32 s86, s3, 0x0
    buffer_load_dwordx4 v2, s[24:27], s86 offen offset:0 sc1 lds
    v_mfma_f32_16x16x32_bf16 v[64:67], v[16:19], a[52:55], v[64:67]
    ds_read_b128 v[16:19], v2 offset:8192
    v_mfma_f32_16x16x32_bf16 v[52:55], v[20:23], a[48:51], v[52:55]
    buffer_load_dwordx4 v2, s[24:27], s86 offen offset:1024 sc1 lds
    v_mfma_f32_16x16x32_bf16 v[68:71], v[20:23], a[52:55], v[68:71]
    ds_read_b128 v[20:23], v2 offset:24576
    s_waitcnt lgkmcnt(2)
    v_mfma_f32_16x16x32_bf16 v[48:51], v[32:35], a[56:59], v[48:51]
    buffer_load_dwordx4 v2, s[24:27], s86 offen offset:2048 sc1 lds
    v_mfma_f32_16x16x32_bf16 v[64:67], v[32:35], a[60:63], v[64:67]
    ds_read_b128 v[32:35], v2 offset:9216
    v_mfma_f32_16x16x32_bf16 v[52:55], v[36:39], a[56:59], v[52:55]
    buffer_load_dwordx4 v2, s[24:27], s86 offen offset:3072 sc1 lds
    v_mfma_f32_16x16x32_bf16 v[68:71], v[36:39], a[60:63], v[68:71]
    ds_read_b128 v[36:39], v2 offset:25600
    s_waitcnt lgkmcnt(2)
    v_mfma_f32_16x16x32_bf16 v[48:51], v[16:19], a[64:67], v[48:51]
    s_add_u32 m0, s28, 8192
    s_add_u32 s86, s3, 0x2000
    buffer_load_dwordx4 v2, s[24:27], s86 offen offset:0 sc1 lds
    v_mfma_f32_16x16x32_bf16 v[64:67], v[16:19], a[68:71], v[64:67]
    ds_read_b128 v[16:19], v2 offset:10240
    v_mfma_f32_16x16x32_bf16 v[52:55], v[20:23], a[64:67], v[52:55]
    v_mfma_f32_16x16x32_bf16 v[68:71], v[20:23], a[68:71], v[68:71]
    ds_read_b128 v[20:23], v2 offset:26624
    s_waitcnt lgkmcnt(2)
    v_mfma_f32_16x16x32_bf16 v[48:51], v[32:35], a[72:75], v[48:51]
    buffer_load_dwordx4 v2, s[24:27], s86 offen offset:1024 sc1 lds
    v_mfma_f32_16x16x32_bf16 v[64:67], v[32:35], a[76:79], v[64:67]
    ds_read_b128 v[144:147], v2 offset:11264
    v_mfma_f32_16x16x32_bf16 v[52:55], v[36:39], a[72:75], v[52:55]
    v_mfma_f32_16x16x32_bf16 v[68:71], v[36:39], a[76:79], v[68:71]
    ds_read_b128 v[148:151], v2 offset:27648
    s_waitcnt lgkmcnt(2)
    v_mfma_f32_16x16x32_bf16 v[48:51], v[16:19], a[80:83], v[48:51]
    buffer_load_dwordx4 v2, s[24:27], s86 offen offset:2048 sc1 lds
    v_mfma_f32_16x16x32_bf16 v[64:67], v[16:19], a[84:87], v[64:67]
    ds_read_b128 v[160:163], v2 offset:12288
    v_mfma_f32_16x16x32_bf16 v[52:55], v[20:23], a[80:83], v[52:55]
    v_mfma_f32_16x16x32_bf16 v[68:71], v[20:23], a[84:87], v[68:71]
    ds_read_b128 v[164:167], v2 offset:28672
    s_waitcnt lgkmcnt(2)
    v_mfma_f32_16x16x32_bf16 v[48:51], v[144:147], a[88:91], v[48:51]
    buffer_load_dwordx4 v2, s[24:27], s86 offen offset:3072 sc1 lds
    v_mfma_f32_16x16x32_bf16 v[64:67], v[144:147], a[92:95], v[64:67]
    ds_read_b128 v[176:179], v2 offset:13312
    v_mfma_f32_16x16x32_bf16 v[52:55], v[148:151], a[88:91], v[52:55]
    s_add_u32 s88, s83, 0xd00000
    buffer_load_dwordx4 v[96:99], v2, s[16:19], s88 offen sc1
    v_mfma_f32_16x16x32_bf16 v[68:71], v[148:151], a[92:95], v[68:71]
    ds_read_b128 v[180:183], v2 offset:29696
    s_waitcnt lgkmcnt(2)
    v_mfma_f32_16x16x32_bf16 v[48:51], v[160:163], a[96:99], v[48:51]
    s_add_u32 s88, s83, 0xd01000
    buffer_load_dwordx4 v[100:103], v2, s[16:19], s88 offen sc1
    v_mfma_f32_16x16x32_bf16 v[64:67], v[160:163], a[100:103], v[64:67]
    ds_read_b128 v[192:195], v2 offset:14336
    v_mfma_f32_16x16x32_bf16 v[52:55], v[164:167], a[96:99], v[52:55]
    s_add_u32 s88, s83, 0xd02000
    buffer_load_dwordx4 v[104:107], v2, s[16:19], s88 offen sc1
    v_mfma_f32_16x16x32_bf16 v[68:71], v[164:167], a[100:103], v[68:71]
    ds_read_b128 v[196:199], v2 offset:30720
    s_waitcnt lgkmcnt(2)
    v_mfma_f32_16x16x32_bf16 v[48:51], v[176:179], a[104:107], v[48:51]
    s_add_u32 s88, s83, 0xd03000
    buffer_load_dwordx4 v[108:111], v2, s[16:19], s88 offen sc1
    v_mfma_f32_16x16x32_bf16 v[64:67], v[176:179], a[108:111], v[64:67]
    ds_read_b128 v[208:211], v2 offset:15360
    v_mfma_f32_16x16x32_bf16 v[52:55], v[180:183], a[104:107], v[52:55]
    v_mfma_f32_16x16x32_bf16 v[68:71], v[180:183], a[108:111], v[68:71]
    ds_read_b128 v[212:215], v2 offset:31744
    s_waitcnt lgkmcnt(2)
    v_mfma_f32_16x16x32_bf16 v[48:51], v[192:195], a[112:115], v[48:51]
    s_add_u32 s87, s80, 0x188000
    buffer_load_dwordx4 a[128:131], v2, s[16:19], s87 offen offset:0 sc1
    v_mfma_f32_16x16x32_bf16 v[64:67], v[192:195], a[116:119], v[64:67]
    v_mfma_f32_16x16x32_bf16 v[52:55], v[196:199], a[112:115], v[52:55]
    v_mfma_f32_16x16x32_bf16 v[68:71], v[196:199], a[116:119], v[68:71]
    s_waitcnt lgkmcnt(0)
    v_mfma_f32_16x16x32_bf16 v[48:51], v[208:211], a[120:123], v[48:51]
    buffer_load_dwordx4 a[132:135], v2, s[16:19], s87 offen offset:1024 sc1
    v_mfma_f32_16x16x32_bf16 v[64:67], v[208:211], a[124:127], v[64:67]
    v_mfma_f32_16x16x32_bf16 v[52:55], v[212:215], a[120:123], v[52:55]
    v_mfma_f32_16x16x32_bf16 v[68:71], v[212:215], a[124:127], v[68:71]
    s_waitcnt vmcnt(10)
    s_barrier
    ds_read_b128 v[24:27], v2 offset:32768
    ds_read_b128 v[28:31], v2 offset:49152
    ds_read_b128 v[40:43], v2 offset:33792
    ds_read_b128 v[44:47], v2 offset:50176
    s_waitcnt lgkmcnt(2)
    v_mfma_f32_16x16x32_bf16 v[56:59], v[24:27], a[0:3], 0
    buffer_load_dwordx4 a[136:139], v2, s[16:19], s87 offen offset:2048 sc1
    v_mfma_f32_16x16x32_bf16 v[72:75], v[24:27], a[4:7], 0
    ds_read_b128 v[24:27], v2 offset:34816
    v_mfma_f32_16x16x32_bf16 v[60:63], v[28:31], a[0:3], 0
    v_mfma_f32_16x16x32_bf16 v[76:79], v[28:31], a[4:7], 0
    ds_read_b128 v[28:31], v2 offset:51200
    s_waitcnt lgkmcnt(2)
    v_mfma_f32_16x16x32_bf16 v[56:59], v[40:43], a[8:11], v[56:59]
    buffer_load_dwordx4 a[140:143], v2, s[16:19], s87 offen offset:3072 sc1
    v_mfma_f32_16x16x32_bf16 v[72:75], v[40:43], a[12:15], v[72:75]
    ds_read_b128 v[40:43], v2 offset:35840
    v_mfma_f32_16x16x32_bf16 v[60:63], v[44:47], a[8:11], v[60:63]
    v_mfma_f32_16x16x32_bf16 v[76:79], v[44:47], a[12:15], v[76:79]
    ds_read_b128 v[44:47], v2 offset:52224
    s_waitcnt lgkmcnt(2)
    v_mfma_f32_16x16x32_bf16 v[56:59], v[24:27], a[16:19], v[56:59]
    s_add_u32 s87, s80, 0x189000
    buffer_load_dwordx4 a[144:147], v2, s[16:19], s87 offen offset:0 sc1
    v_mfma_f32_16x16x32_bf16 v[72:75], v[24:27], a[20:23], v[72:75]
    ds_read_b128 v[24:27], v2 offset:36864
    v_mfma_f32_16x16x32_bf16 v[60:63], v[28:31], a[16:19], v[60:63]
    v_mfma_f32_16x16x32_bf16 v[76:79], v[28:31], a[20:23], v[76:79]
    ds_read_b128 v[28:31], v2 offset:53248
    s_waitcnt vmcnt(5)
    s_waitcnt lgkmcnt(2)
    v_mfma_f32_16x16x32_bf16 v[56:59], v[40:43], a[24:27], v[56:59]
    buffer_load_dwordx4 a[148:151], v2, s[16:19], s87 offen offset:1024 sc1
    v_mfma_f32_16x16x32_bf16 v[72:75], v[40:43], a[28:31], v[72:75]
    ds_read_b128 v[40:43], v2 offset:37888
    v_add_f32 v96, v96, v98
    v_mfma_f32_16x16x32_bf16 v[60:63], v[44:47], a[24:27], v[60:63]
    v_add_f32 v97, v97, v99
    v_add_f32 v96, v96, v100
    v_mfma_f32_16x16x32_bf16 v[76:79], v[44:47], a[28:31], v[76:79]
    ds_read_b128 v[44:47], v2 offset:54272
    v_add_f32 v97, v97, v101
    s_waitcnt lgkmcnt(2)
    v_mfma_f32_16x16x32_bf16 v[56:59], v[24:27], a[32:35], v[56:59]
    buffer_load_dwordx4 a[152:155], v2, s[16:19], s87 offen offset:2048 sc1
    v_mfma_f32_16x16x32_bf16 v[72:75], v[24:27], a[36:39], v[72:75]
    ds_read_b128 v[24:27], v2 offset:38912
    v_add_f32 v96, v96, v102
    v_mfma_f32_16x16x32_bf16 v[60:63], v[28:31], a[32:35], v[60:63]
    v_add_f32 v97, v97, v103
    v_add_f32 v96, v96, v104
    v_mfma_f32_16x16x32_bf16 v[76:79], v[28:31], a[36:39], v[76:79]
    ds_read_b128 v[28:31], v2 offset:55296
    v_add_f32 v97, v97, v105
    s_waitcnt lgkmcnt(2)
    v_mfma_f32_16x16x32_bf16 v[56:59], v[40:43], a[40:43], v[56:59]
    buffer_load_dwordx4 a[156:159], v2, s[16:19], s87 offen offset:3072 sc1
    v_mfma_f32_16x16x32_bf16 v[72:75], v[40:43], a[44:47], v[72:75]
    ds_read_b128 v[40:43], v2 offset:39936
    v_add_f32 v96, v96, v106
    v_mfma_f32_16x16x32_bf16 v[60:63], v[44:47], a[40:43], v[60:63]
    v_add_f32 v97, v97, v107
    v_add_f32 v96, v96, v108
    v_mfma_f32_16x16x32_bf16 v[76:79], v[44:47], a[44:47], v[76:79]
    ds_read_b128 v[44:47], v2 offset:56320
    v_add_f32 v97, v97, v109
    s_barrier
    s_waitcnt lgkmcnt(2)
    v_mfma_f32_16x16x32_bf16 v[56:59], v[24:27], a[48:51], v[56:59]
    s_add_u32 s87, s80, 0x18a000
    buffer_load_dwordx4 a[160:163], v2, s[16:19], s87 offen offset:0 sc1
    v_mfma_f32_16x16x32_bf16 v[72:75], v[24:27], a[52:55], v[72:75]
    ds_read_b128 v[24:27], v2 offset:40960
    v_add_f32 v96, v96, v110
    v_mfma_f32_16x16x32_bf16 v[60:63], v[28:31], a[48:51], v[60:63]
    v_add_f32 v97, v97, v111
    v_mov_b32 v98, v96
    v_mfma_f32_16x16x32_bf16 v[76:79], v[28:31], a[52:55], v[76:79]
    ds_read_b128 v[28:31], v2 offset:57344
    v_mov_b32 v99, v97
    s_waitcnt lgkmcnt(2)
    v_mfma_f32_16x16x32_bf16 v[56:59], v[40:43], a[56:59], v[56:59]
    buffer_load_dwordx4 a[164:167], v2, s[16:19], s87 offen offset:1024 sc1
    v_mfma_f32_16x16x32_bf16 v[72:75], v[40:43], a[60:63], v[72:75]
    ds_read_b128 v[40:43], v2 offset:41984
    v_permlane16_swap_b32 v96, v98
    v_mfma_f32_16x16x32_bf16 v[60:63], v[44:47], a[56:59], v[60:63]
    v_permlane16_swap_b32 v97, v99
    v_add_f32 v96, v96, v98
    v_mfma_f32_16x16x32_bf16 v[76:79], v[44:47], a[60:63], v[76:79]
    ds_read_b128 v[44:47], v2 offset:58368
    v_add_f32 v97, v97, v99
    s_waitcnt lgkmcnt(2)
    v_mfma_f32_16x16x32_bf16 v[56:59], v[24:27], a[64:67], v[56:59]
    buffer_load_dwordx4 a[168:171], v2, s[16:19], s87 offen offset:2048 sc1
    v_mfma_f32_16x16x32_bf16 v[72:75], v[24:27], a[68:71], v[72:75]
    ds_read_b128 v[24:27], v2 offset:43008
    v_mov_b32 v98, v96
    v_mfma_f32_16x16x32_bf16 v[60:63], v[28:31], a[64:67], v[60:63]
    v_mov_b32 v99, v97
    v_permlane32_swap_b32 v96, v98
    v_mfma_f32_16x16x32_bf16 v[76:79], v[28:31], a[68:71], v[76:79]
    ds_read_b128 v[28:31], v2 offset:59392
    v_permlane32_swap_b32 v97, v99
    s_waitcnt lgkmcnt(2)
    v_mfma_f32_16x16x32_bf16 v[56:59], v[40:43], a[72:75], v[56:59]
    buffer_load_dwordx4 a[172:175], v2, s[16:19], s87 offen offset:3072 sc1
    v_mfma_f32_16x16x32_bf16 v[72:75], v[40:43], a[76:79], v[72:75]
    ds_read_b128 v[152:155], v2 offset:44032
    v_add_f32 v96, v96, v98
    v_mfma_f32_16x16x32_bf16 v[60:63], v[44:47], a[72:75], v[60:63]
    v_add_f32 v97, v97, v99
    v_mul_f32 v96, 0x3b000000, v96
    v_mfma_f32_16x16x32_bf16 v[76:79], v[44:47], a[76:79], v[76:79]
    ds_read_b128 v[156:159], v2 offset:60416
    v_mul_f32 v97, 0x3b000000, v97
    s_waitcnt lgkmcnt(2)
    v_mfma_f32_16x16x32_bf16 v[56:59], v[24:27], a[80:83], v[56:59]
    s_add_u32 s87, s80, 0x18b000
    buffer_load_dwordx4 a[176:179], v2, s[16:19], s87 offen offset:0 sc1
    v_mfma_f32_16x16x32_bf16 v[72:75], v[24:27], a[84:87], v[72:75]
    ds_read_b128 v[168:171], v2 offset:45056
    v_fma_f32 v97, -v96, v96, v97
    v_mfma_f32_16x16x32_bf16 v[60:63], v[28:31], a[80:83], v[60:63]
    v_max_f32 v97, 0, v97
    v_add_f32 v97, 0x3727c5ac, v97
    v_mfma_f32_16x16x32_bf16 v[76:79], v[28:31], a[84:87], v[76:79]
    ds_read_b128 v[172:175], v2 offset:61440
    v_rsq_f32 v97, v97
    v_lshrrev_b32 v98, 6, v0
    v_and_b32 v99, 15, v1
    v_lshl_add_u32 v98, v98, 4, v99
    v_lshlrev_b32 v98, 2, v98
    v_add_u32 v98, 161792, v98
    ds_write2_b32 v98, v97, v96 offset1:64
    s_waitcnt lgkmcnt(3)
    v_mfma_f32_16x16x32_bf16 v[56:59], v[152:155], a[88:91], v[56:59]
    buffer_load_dwordx4 a[180:183], v2, s[16:19], s87 offen offset:1024 sc1
    v_mfma_f32_16x16x32_bf16 v[72:75], v[152:155], a[92:95], v[72:75]
    ds_read_b128 v[184:187], v2 offset:46080
    v_mfma_f32_16x16x32_bf16 v[60:63], v[156:159], a[88:91], v[60:63]
    v_mfma_f32_16x16x32_bf16 v[76:79], v[156:159], a[92:95], v[76:79]
    ds_read_b128 v[188:191], v2 offset:62464
    s_waitcnt lgkmcnt(2)
    s_barrier
    v_mfma_f32_16x16x32_bf16 v[56:59], v[168:171], a[96:99], v[56:59]
    buffer_load_dwordx4 a[184:187], v2, s[16:19], s87 offen offset:2048 sc1
    v_mfma_f32_16x16x32_bf16 v[72:75], v[168:171], a[100:103], v[72:75]
    ds_read_b128 v[200:203], v2 offset:47104
    v_lshrrev_b32 v248, 4, v1
    v_mfma_f32_16x16x32_bf16 v[60:63], v[172:175], a[96:99], v[60:63]
    v_lshlrev_b32 v248, 4, v248
    v_add_u32 v248, 161792, v248
    v_mfma_f32_16x16x32_bf16 v[76:79], v[172:175], a[100:103], v[76:79]
    ds_read_b128 v[204:207], v2 offset:63488
    v_and_b32 v249, 15, v1
    s_waitcnt lgkmcnt(2)
    v_mfma_f32_16x16x32_bf16 v[56:59], v[184:187], a[104:107], v[56:59]
    buffer_load_dwordx4 a[188:191], v2, s[16:19], s87 offen offset:3072 sc1
    v_mfma_f32_16x16x32_bf16 v[72:75], v[184:187], a[108:111], v[72:75]
    ds_read_b128 v[216:219], v2 offset:48128
    v_lshlrev_b32 v249, 2, v249
    v_mfma_f32_16x16x32_bf16 v[60:63], v[188:191], a[104:107], v[60:63]
    v_add_u32 v249, 161792, v249
    ds_read2_b32 v[128:129], v249 offset0:0 offset1:64
    v_mfma_f32_16x16x32_bf16 v[76:79], v[188:191], a[108:111], v[76:79]
    ds_read_b128 v[220:223], v2 offset:64512
    ds_read2_b32 v[130:131], v249 offset0:16 offset1:80
    s_waitcnt lgkmcnt(4)
    v_mfma_f32_16x16x32_bf16 v[56:59], v[200:203], a[112:115], v[56:59]
    ds_read2_b32 v[132:133], v249 offset0:32 offset1:96
    ds_read2_b32 v[134:135], v249 offset0:48 offset1:112
    v_mfma_f32_16x16x32_bf16 v[72:75], v[200:203], a[116:119], v[72:75]
    ds_read_b128 v[112:115], v248 offset:0
    v_mfma_f32_16x16x32_bf16 v[60:63], v[204:207], a[112:115], v[60:63]
    ds_read_b128 v[116:119], v248 offset:64
    ds_read_b128 v[120:123], v248 offset:128
    v_mfma_f32_16x16x32_bf16 v[76:79], v[204:207], a[116:119], v[76:79]
    ds_read_b128 v[124:127], v248 offset:192
    s_waitcnt lgkmcnt(7)
    v_mfma_f32_16x16x32_bf16 v[56:59], v[216:219], a[120:123], v[56:59]
    ds_read_b128 v[96:99], v248 offset:256
    ds_read_b128 v[100:103], v248 offset:320
    v_mfma_f32_16x16x32_bf16 v[72:75], v[216:219], a[124:127], v[72:75]
    ds_read_b128 v[104:107], v248 offset:384
    v_mfma_f32_16x16x32_bf16 v[60:63], v[220:223], a[120:123], v[60:63]
    ds_read_b128 v[108:111], v248 offset:448
    s_mul_i32 s31, s12, 192
    v_mfma_f32_16x16x32_bf16 v[76:79], v[220:223], a[124:127], v[76:79]
    v_add_u32 v248, s31, v248
    v_add_u32 v249, s31, v249
    ds_read_b32 v224, v249 offset:1344
    ds_read_b32 v228, v249 offset:1408
    ds_read_b128 v[244:247], v248 offset:1280
    v_mov_b32 v136, 0x3f803f80
    v_mov_b32 v137, v136
    v_mov_b32 v138, v136
    v_mov_b32 v139, v136
    s_waitcnt lgkmcnt(0)
    ds_read_b128 v[16:19], v2 offset:0
    ds_read_b128 v[20:23], v2 offset:16384
    ds_read_b128 v[24:27], v2 offset:32768
    ds_read_b128 v[28:31], v2 offset:49152
    ds_read_b128 v[32:35], v2 offset:1024
    ds_read_b128 v[36:39], v2 offset:17408
    ds_read_b128 v[40:43], v2 offset:33792
    ds_read_b128 v[44:47], v2 offset:50176
    v_pk_fma_f32 v[48:49], v[96:97], v[224:225], v[48:49] op_sel_hi:[1,0,1] neg_lo:[1,0,0] neg_hi:[1,0,0]
    v_pk_fma_f32 v[50:51], v[98:99], v[224:225], v[50:51] op_sel_hi:[1,0,1] neg_lo:[1,0,0] neg_hi:[1,0,0]
    v_pk_fma_f32 v[52:53], v[100:101], v[224:225], v[52:53] op_sel_hi:[1,0,1] neg_lo:[1,0,0] neg_hi:[1,0,0]
    v_pk_fma_f32 v[54:55], v[102:103], v[224:225], v[54:55] op_sel_hi:[1,0,1] neg_lo:[1,0,0] neg_hi:[1,0,0]
    v_pk_fma_f32 v[56:57], v[104:105], v[224:225], v[56:57] op_sel_hi:[1,0,1] neg_lo:[1,0,0] neg_hi:[1,0,0]
    v_pk_fma_f32 v[58:59], v[106:107], v[224:225], v[58:59] op_sel_hi:[1,0,1] neg_lo:[1,0,0] neg_hi:[1,0,0]
    v_pk_fma_f32 v[60:61], v[108:109], v[224:225], v[60:61] op_sel_hi:[1,0,1] neg_lo:[1,0,0] neg_hi:[1,0,0]
    v_pk_fma_f32 v[62:63], v[110:111], v[224:225], v[62:63] op_sel_hi:[1,0,1] neg_lo:[1,0,0] neg_hi:[1,0,0]
    v_pk_fma_f32 v[64:65], v[96:97], v[228:229], v[64:65] op_sel_hi:[1,0,1] neg_lo:[1,0,0] neg_hi:[1,0,0]
    v_pk_fma_f32 v[66:67], v[98:99], v[228:229], v[66:67] op_sel_hi:[1,0,1] neg_lo:[1,0,0] neg_hi:[1,0,0]
    v_pk_fma_f32 v[68:69], v[100:101], v[228:229], v[68:69] op_sel_hi:[1,0,1] neg_lo:[1,0,0] neg_hi:[1,0,0]
    v_pk_fma_f32 v[70:71], v[102:103], v[228:229], v[70:71] op_sel_hi:[1,0,1] neg_lo:[1,0,0] neg_hi:[1,0,0]
    v_pk_fma_f32 v[72:73], v[104:105], v[228:229], v[72:73] op_sel_hi:[1,0,1] neg_lo:[1,0,0] neg_hi:[1,0,0]
    v_pk_fma_f32 v[74:75], v[106:107], v[228:229], v[74:75] op_sel_hi:[1,0,1] neg_lo:[1,0,0] neg_hi:[1,0,0]
    v_pk_fma_f32 v[76:77], v[108:109], v[228:229], v[76:77] op_sel_hi:[1,0,1] neg_lo:[1,0,0] neg_hi:[1,0,0]
    v_pk_fma_f32 v[78:79], v[110:111], v[228:229], v[78:79] op_sel_hi:[1,0,1] neg_lo:[1,0,0] neg_hi:[1,0,0]
    v_pk_mul_f32 v[48:49], v[48:49], v[112:113]
    v_pk_mul_f32 v[50:51], v[50:51], v[114:115]
    v_pk_mul_f32 v[52:53], v[52:53], v[116:117]
    v_pk_mul_f32 v[54:55], v[54:55], v[118:119]
    v_pk_mul_f32 v[56:57], v[56:57], v[120:121]
    v_pk_mul_f32 v[58:59], v[58:59], v[122:123]
    v_pk_mul_f32 v[60:61], v[60:61], v[124:125]
    v_pk_mul_f32 v[62:63], v[62:63], v[126:127]
    v_pk_mul_f32 v[96:97], v[48:49], s[92:93]
    v_pk_mul_f32 v[98:99], v[50:51], s[92:93]
    v_pk_mul_f32 v[100:101], v[52:53], s[92:93]
    v_pk_mul_f32 v[102:103], v[54:55], s[92:93]
    v_pk_mul_f32 v[104:105], v[56:57], s[92:93]
    v_pk_mul_f32 v[106:107], v[58:59], s[92:93]
    v_pk_mul_f32 v[108:109], v[60:61], s[92:93]
    v_pk_mul_f32 v[110:111], v[62:63], s[92:93]
    v_pk_mul_f32 v[64:65], v[64:65], v[112:113]
    v_pk_mul_f32 v[66:67], v[66:67], v[114:115]
    v_pk_mul_f32 v[68:69], v[68:69], v[116:117]
    v_pk_mul_f32 v[70:71], v[70:71], v[118:119]
    v_pk_mul_f32 v[72:73], v[72:73], v[120:121]
    v_pk_mul_f32 v[74:75], v[74:75], v[122:123]
    v_pk_mul_f32 v[76:77], v[76:77], v[124:125]
    v_pk_mul_f32 v[78:79], v[78:79], v[126:127]
    v_exp_f32 v96, v96 clamp
    v_exp_f32 v97, v97 clamp
    v_exp_f32 v98, v98 clamp
    v_exp_f32 v99, v99 clamp
    v_exp_f32 v100, v100 clamp
    v_exp_f32 v101, v101 clamp
    v_exp_f32 v102, v102 clamp
    v_exp_f32 v103, v103 clamp
    v_exp_f32 v104, v104 clamp
    v_exp_f32 v105, v105 clamp
    v_exp_f32 v106, v106 clamp
    v_exp_f32 v107, v107 clamp
    v_exp_f32 v108, v108 clamp
    v_exp_f32 v109, v109 clamp
    v_exp_f32 v110, v110 clamp
    v_exp_f32 v111, v111 clamp
    v_max_f32 v48, s94, v48
    v_max_f32 v49, s94, v49
    v_max_f32 v50, s94, v50
    v_max_f32 v51, s94, v51
    v_max_f32 v52, s94, v52
    v_max_f32 v53, s94, v53
    v_max_f32 v54, s94, v54
    v_max_f32 v55, s94, v55
    v_max_f32 v56, s94, v56
    v_max_f32 v57, s94, v57
    v_max_f32 v58, s94, v58
    v_max_f32 v59, s94, v59
    v_max_f32 v60, s94, v60
    v_max_f32 v61, s94, v61
    v_max_f32 v62, s94, v62
    v_max_f32 v63, s94, v63
    v_cvt_pk_bf16_f32 v232, v64, v65
    v_cvt_pk_bf16_f32 v233, v66, v67
    v_cvt_pk_bf16_f32 v234, v68, v69
    v_cvt_pk_bf16_f32 v235, v70, v71
    v_cvt_pk_bf16_f32 v236, v72, v73
    v_cvt_pk_bf16_f32 v237, v74, v75
    v_cvt_pk_bf16_f32 v238, v76, v77
    v_cvt_pk_bf16_f32 v239, v78, v79
    v_pk_add_f32 v[48:49], v[48:49], v[96:97]
    v_pk_add_f32 v[50:51], v[50:51], v[98:99]
    v_pk_add_f32 v[52:53], v[52:53], v[100:101]
    v_pk_add_f32 v[54:55], v[54:55], v[102:103]
    v_pk_add_f32 v[56:57], v[56:57], v[104:105]
    v_pk_add_f32 v[58:59], v[58:59], v[106:107]
    v_pk_add_f32 v[60:61], v[60:61], v[108:109]
    v_pk_add_f32 v[62:63], v[62:63], v[110:111]
    v_cvt_pk_bf16_f32 v224, v48, v49
    v_cvt_pk_bf16_f32 v225, v50, v51
    v_cvt_pk_bf16_f32 v226, v52, v53
    v_cvt_pk_bf16_f32 v227, v54, v55
    v_cvt_pk_bf16_f32 v228, v56, v57
    v_cvt_pk_bf16_f32 v229, v58, v59
    v_cvt_pk_bf16_f32 v230, v60, v61
    v_cvt_pk_bf16_f32 v231, v62, v63
    v_mfma_f32_16x16x32_bf16 v[96:99], v[232:235], v[224:227], 0
    v_mfma_f32_16x16x32_bf16 v[100:103], v[136:139], v[224:227], 0
    v_mfma_f32_16x16x32_bf16 v[96:99], v[236:239], v[228:231], v[96:99]
    v_mfma_f32_16x16x32_bf16 v[100:103], v[136:139], v[228:231], v[100:103]
    s_mul_i32 s31, s13, 1152
    v_lshlrev_b32 v6, 2, v1
    s_add_u32 s3, s31, 0x429000
    s_nop 3
    buffer_atomic_add_f32 v96, v6, s[16:19], s3 offen offset:0
    buffer_atomic_add_f32 v97, v6, s[16:19], s3 offen offset:256
    buffer_atomic_add_f32 v98, v6, s[16:19], s3 offen offset:512
    buffer_atomic_add_f32 v99, v6, s[16:19], s3 offen offset:768
    s_mov_b64 exec, 0xffff
    buffer_atomic_add_f32 v100, v6, s[16:19], s3 offen offset:1024
    s_mov_b64 exec, -1
    v_mov_b32 v140, 1
    v_lshlrev_b32 v141, 7, v1
    s_lshl_b32 s86, s13, 10
    s_add_u32 s86, s86, 0x458000
    v_and_b32 v104, 15, v1
    v_lshrrev_b32 v105, 5, v1
    v_bfe_u32 v106, v1, 4, 1
    s_lshl_b32 s31, s11, 11
    s_add_u32 s31, s31, s82
    v_lshl_add_u32 v107, v105, 4, v104
    v_lshlrev_b32 v107, 4, v107
    v_lshl_add_u32 v107, v106, 3, v107
    v_add_u32 v107, s31, v107
    ds_read_b64 v[224:225], v107 offset:0
    ds_read_b64 v[226:227], v107 offset:512
    ds_read_b64 v[228:229], v107 offset:1024
    ds_read_b64 v[230:231], v107 offset:1536
    v_lshrrev_b32 v108, 3, v1
    v_lshlrev_b32 v108, 10, v108
    v_bfe_u32 v109, v1, 4, 2
    v_lshlrev_b32 v109, 1, v109
    v_and_b32 v110, 7, v1
    v_xor_b32 v109, v109, v110
    v_lshl_add_u32 v6, v109, 4, v108
    s_lshl_b32 s89, s12, 17
    s_lshl_b32 s31, s11, 7
    s_add_u32 s89, s89, s31
    s_mov_b32 s20, s78
    s_mov_b32 s21, s79
    s_waitcnt lgkmcnt(0)
    s_waitcnt vmcnt(20)
    s_waitcnt lgkmcnt(7)
    v_mfma_f32_16x16x32_bf16 v[80:83], a[128:131], v[16:19], 0
    ds_read_b128 v[16:19], v2 offset:2048
    s_waitcnt lgkmcnt(7)
    v_mfma_f32_16x16x32_bf16 v[84:87], a[128:131], v[20:23], 0
    ds_read_b128 v[20:23], v2 offset:18432
    s_waitcnt lgkmcnt(7)
    v_mfma_f32_16x16x32_bf16 v[88:91], a[128:131], v[24:27], 0
    ds_read_b128 v[24:27], v2 offset:34816
    s_waitcnt lgkmcnt(7)
    v_mfma_f32_16x16x32_bf16 v[92:95], a[128:131], v[28:31], 0
    ds_read_b128 v[28:31], v2 offset:51200
    s_waitcnt vmcnt(19)
    s_waitcnt lgkmcnt(7)
    v_mfma_f32_16x16x32_bf16 v[80:83], a[132:135], v[32:35], v[80:83]
    ds_read_b128 v[32:35], v2 offset:3072
    s_waitcnt lgkmcnt(7)
    v_mfma_f32_16x16x32_bf16 v[84:87], a[132:135], v[36:39], v[84:87]
    ds_read_b128 v[36:39], v2 offset:19456
    s_waitcnt lgkmcnt(7)
    v_mfma_f32_16x16x32_bf16 v[88:91], a[132:135], v[40:43], v[88:91]
    ds_read_b128 v[40:43], v2 offset:35840
    s_waitcnt lgkmcnt(7)
    v_mfma_f32_16x16x32_bf16 v[92:95], a[132:135], v[44:47], v[92:95]
    ds_read_b128 v[44:47], v2 offset:52224
    s_waitcnt vmcnt(18)
    s_waitcnt lgkmcnt(7)
    v_mfma_f32_16x16x32_bf16 v[80:83], a[136:139], v[16:19], v[80:83]
    ds_read_b128 v[16:19], v2 offset:4096
    s_waitcnt lgkmcnt(7)
    v_mfma_f32_16x16x32_bf16 v[84:87], a[136:139], v[20:23], v[84:87]
    ds_read_b128 v[20:23], v2 offset:20480
    s_waitcnt lgkmcnt(7)
    v_mfma_f32_16x16x32_bf16 v[88:91], a[136:139], v[24:27], v[88:91]
    ds_read_b128 v[24:27], v2 offset:36864
    s_waitcnt lgkmcnt(7)
    v_mfma_f32_16x16x32_bf16 v[92:95], a[136:139], v[28:31], v[92:95]
    ds_read_b128 v[28:31], v2 offset:53248
    s_waitcnt vmcnt(17)
    s_waitcnt lgkmcnt(7)
    v_mfma_f32_16x16x32_bf16 v[80:83], a[140:143], v[32:35], v[80:83]
    ds_read_b128 v[32:35], v2 offset:5120
    s_waitcnt lgkmcnt(7)
    v_mfma_f32_16x16x32_bf16 v[84:87], a[140:143], v[36:39], v[84:87]
    ds_read_b128 v[36:39], v2 offset:21504
    s_waitcnt lgkmcnt(7)
    v_mfma_f32_16x16x32_bf16 v[88:91], a[140:143], v[40:43], v[88:91]
    ds_read_b128 v[40:43], v2 offset:37888
    s_waitcnt lgkmcnt(7)
    v_mfma_f32_16x16x32_bf16 v[92:95], a[140:143], v[44:47], v[92:95]
    ds_read_b128 v[44:47], v2 offset:54272
    s_waitcnt vmcnt(16)
    s_waitcnt lgkmcnt(7)
    v_mfma_f32_16x16x32_bf16 v[80:83], a[144:147], v[16:19], v[80:83]
    ds_read_b128 v[16:19], v2 offset:6144
    s_waitcnt lgkmcnt(7)
    v_mfma_f32_16x16x32_bf16 v[84:87], a[144:147], v[20:23], v[84:87]
    ds_read_b128 v[20:23], v2 offset:22528
    s_waitcnt lgkmcnt(7)
    v_mfma_f32_16x16x32_bf16 v[88:91], a[144:147], v[24:27], v[88:91]
    ds_read_b128 v[24:27], v2 offset:38912
    s_waitcnt lgkmcnt(7)
    v_mfma_f32_16x16x32_bf16 v[92:95], a[144:147], v[28:31], v[92:95]
    ds_read_b128 v[28:31], v2 offset:55296
    s_waitcnt vmcnt(15)
    s_waitcnt lgkmcnt(7)
    v_mfma_f32_16x16x32_bf16 v[80:83], a[148:151], v[32:35], v[80:83]
    ds_read_b128 v[32:35], v2 offset:7168
    s_waitcnt lgkmcnt(7)
    v_mfma_f32_16x16x32_bf16 v[84:87], a[148:151], v[36:39], v[84:87]
    ds_read_b128 v[36:39], v2 offset:23552
    s_waitcnt lgkmcnt(7)
    v_mfma_f32_16x16x32_bf16 v[88:91], a[148:151], v[40:43], v[88:91]
    ds_read_b128 v[40:43], v2 offset:39936
    s_waitcnt lgkmcnt(7)
    v_mfma_f32_16x16x32_bf16 v[92:95], a[148:151], v[44:47], v[92:95]
    ds_read_b128 v[44:47], v2 offset:56320
    s_waitcnt vmcnt(14)
    s_waitcnt lgkmcnt(7)
    v_mfma_f32_16x16x32_bf16 v[80:83], a[152:155], v[16:19], v[80:83]
    ds_read_b128 v[16:19], v2 offset:8192
    s_waitcnt lgkmcnt(7)
    v_mfma_f32_16x16x32_bf16 v[84:87], a[152:155], v[20:23], v[84:87]
    ds_read_b128 v[20:23], v2 offset:24576
    s_waitcnt lgkmcnt(7)
    v_mfma_f32_16x16x32_bf16 v[88:91], a[152:155], v[24:27], v[88:91]
    ds_read_b128 v[24:27], v2 offset:40960
    s_waitcnt lgkmcnt(7)
    v_mfma_f32_16x16x32_bf16 v[92:95], a[152:155], v[28:31], v[92:95]
    ds_read_b128 v[28:31], v2 offset:57344
    s_waitcnt vmcnt(13)
    s_waitcnt lgkmcnt(7)
    v_mfma_f32_16x16x32_bf16 v[80:83], a[156:159], v[32:35], v[80:83]
    ds_read_b128 v[32:35], v2 offset:9216
    s_waitcnt lgkmcnt(7)
    v_mfma_f32_16x16x32_bf16 v[84:87], a[156:159], v[36:39], v[84:87]
    ds_read_b128 v[36:39], v2 offset:25600
    s_waitcnt lgkmcnt(7)
    v_mfma_f32_16x16x32_bf16 v[88:91], a[156:159], v[40:43], v[88:91]
    ds_read_b128 v[40:43], v2 offset:41984
    s_waitcnt lgkmcnt(7)
    v_mfma_f32_16x16x32_bf16 v[92:95], a[156:159], v[44:47], v[92:95]
    ds_read_b128 v[44:47], v2 offset:58368
    s_waitcnt vmcnt(12)
    s_waitcnt lgkmcnt(7)
    v_mfma_f32_16x16x32_bf16 v[80:83], a[160:163], v[16:19], v[80:83]
    ds_read_b128 v[16:19], v2 offset:10240
    s_waitcnt lgkmcnt(7)
    v_mfma_f32_16x16x32_bf16 v[84:87], a[160:163], v[20:23], v[84:87]
    ds_read_b128 v[20:23], v2 offset:26624
    s_waitcnt lgkmcnt(7)
    v_mfma_f32_16x16x32_bf16 v[88:91], a[160:163], v[24:27], v[88:91]
    ds_read_b128 v[24:27], v2 offset:43008
    s_waitcnt lgkmcnt(7)
    v_mfma_f32_16x16x32_bf16 v[92:95], a[160:163], v[28:31], v[92:95]
    ds_read_b128 v[28:31], v2 offset:59392
    s_waitcnt vmcnt(11)
    s_waitcnt lgkmcnt(7)
    v_mfma_f32_16x16x32_bf16 v[80:83], a[164:167], v[32:35], v[80:83]
    s_waitcnt lgkmcnt(6)
    v_mfma_f32_16x16x32_bf16 v[84:87], a[164:167], v[36:39], v[84:87]
    s_waitcnt lgkmcnt(5)
    v_mfma_f32_16x16x32_bf16 v[88:91], a[164:167], v[40:43], v[88:91]
    s_waitcnt lgkmcnt(4)
    v_mfma_f32_16x16x32_bf16 v[92:95], a[164:167], v[44:47], v[92:95]
    s_waitcnt vmcnt(10)
    s_waitcnt lgkmcnt(3)
    v_mfma_f32_16x16x32_bf16 v[80:83], a[168:171], v[16:19], v[80:83]
    s_waitcnt lgkmcnt(2)
    v_mfma_f32_16x16x32_bf16 v[84:87], a[168:171], v[20:23], v[84:87]
    s_waitcnt lgkmcnt(1)
    v_mfma_f32_16x16x32_bf16 v[88:91], a[168:171], v[24:27], v[88:91]
    s_waitcnt lgkmcnt(0)
    v_mfma_f32_16x16x32_bf16 v[92:95], a[168:171], v[28:31], v[92:95]
    s_barrier
    s_waitcnt vmcnt(5)
    s_waitcnt vmcnt(0)
    s_mov_b64 exec, 0xff
    buffer_atomic_add v140, v141, s[16:19], s86 offen sc1
    s_mov_b64 exec, -1
    v_mfma_f32_16x16x32_bf16 v[80:83], a[172:175], v[144:147], v[80:83]
    s_add_u32 m0, s82, 0
    s_add_u32 s90, s89, 0
    buffer_load_dwordx4 v6, s[20:23], s90 offen lds
    v_mfma_f32_16x16x32_bf16 v[84:87], a[172:175], v[148:151], v[84:87]
    v_mfma_f32_16x16x32_bf16 v[88:91], a[172:175], v[152:155], v[88:91]
    v_mfma_f32_16x16x32_bf16 v[92:95], a[172:175], v[156:159], v[92:95]
    s_add_u32 m0, s82, 1024
    s_add_u32 s90, s89, 8192
    buffer_load_dwordx4 v6, s[20:23], s90 offen lds
    v_mfma_f32_16x16x32_bf16 v[80:83], a[176:179], v[160:163], v[80:83]
    v_mfma_f32_16x16x32_bf16 v[84:87], a[176:179], v[164:167], v[84:87]
    v_mfma_f32_16x16x32_bf16 v[88:91], a[176:179], v[168:171], v[88:91]
    s_add_u32 m0, s82, 2048
    s_add_u32 s90, s89, 16384
    buffer_load_dwordx4 v6, s[20:23], s90 offen lds
    v_mfma_f32_16x16x32_bf16 v[92:95], a[176:179], v[172:175], v[92:95]
    v_mfma_f32_16x16x32_bf16 v[80:83], a[180:183], v[176:179], v[80:83]
    v_mfma_f32_16x16x32_bf16 v[84:87], a[180:183], v[180:183], v[84:87]
    v_mfma_f32_16x16x32_bf16 v[88:91], a[180:183], v[184:187], v[88:91]
    s_add_u32 m0, s82, 3072
    s_add_u32 s90, s89, 24576
    buffer_load_dwordx4 v6, s[20:23], s90 offen lds
    v_mfma_f32_16x16x32_bf16 v[92:95], a[180:183], v[188:191], v[92:95]
    v_mfma_f32_16x16x32_bf16 v[80:83], a[184:187], v[192:195], v[80:83]
    v_mfma_f32_16x16x32_bf16 v[84:87], a[184:187], v[196:199], v[84:87]
    s_add_u32 m0, s82, 4096
    s_add_u32 s90, s89, 32768
    buffer_load_dwordx4 v6, s[20:23], s90 offen lds
    v_mfma_f32_16x16x32_bf16 v[88:91], a[184:187], v[200:203], v[88:91]
    v_mfma_f32_16x16x32_bf16 v[92:95], a[184:187], v[204:207], v[92:95]
    v_mfma_f32_16x16x32_bf16 v[80:83], a[188:191], v[208:211], v[80:83]
    s_add_u32 m0, s82, 5120
    s_add_u32 s90, s89, 40960
    buffer_load_dwordx4 v6, s[20:23], s90 offen lds
    v_mfma_f32_16x16x32_bf16 v[84:87], a[188:191], v[212:215], v[84:87]
    v_mfma_f32_16x16x32_bf16 v[88:91], a[188:191], v[216:219], v[88:91]
    v_mfma_f32_16x16x32_bf16 v[92:95], a[188:191], v[220:223], v[92:95]
    s_and_b32 s30, s2, 7
    s_lshl_b32 s30, s30, 7
    s_add_u32 s86, s86, s30
    s_mov_b64 exec, 1
    buffer_load_dword v24, v1, s[16:19], s86 offen sc1
    s_mov_b64 exec, -1
    v_and_b32 v16, 15, v1
    v_lshrrev_b32 v17, 5, v1
    v_bfe_u32 v18, v1, 4, 1
    v_and_b32 v19, 3, v1
    v_bfe_u32 v20, v1, 2, 2
    v_lshl_add_u32 v19, v19, 2, v20
    v_lshlrev_b32 v19, 6, v19
    v_mov_b32 v20, 0x400
    s_mov_b32 s100, 0xffff
    s_mov_b32 s101, 0xffff
    v_cndmask_b32 v19, v20, v19, s[100:101]
    v_lshl_add_u32 v249, v17, 5, v19
    s_add_u32 m0, s82, 6144
    s_add_u32 s90, s89, 49152
    buffer_load_dwordx4 v6, s[20:23], s90 offen lds
    v_pk_fma_f32 v[80:81], v[244:245], v[128:129], v[80:81] op_sel:[0,1,0] op_sel_hi:[1,1,1] neg_lo:[1,0,0] neg_hi:[1,0,0]
    v_pk_fma_f32 v[82:83], v[246:247], v[128:129], v[82:83] op_sel:[0,1,0] op_sel_hi:[1,1,1] neg_lo:[1,0,0] neg_hi:[1,0,0]
    v_pk_fma_f32 v[84:85], v[244:245], v[130:131], v[84:85] op_sel:[0,1,0] op_sel_hi:[1,1,1] neg_lo:[1,0,0] neg_hi:[1,0,0]
    v_pk_fma_f32 v[86:87], v[246:247], v[130:131], v[86:87] op_sel:[0,1,0] op_sel_hi:[1,1,1] neg_lo:[1,0,0] neg_hi:[1,0,0]
    s_add_u32 m0, s82, 7168
    s_add_u32 s90, s89, 57344
    buffer_load_dwordx4 v6, s[20:23], s90 offen lds
    v_pk_fma_f32 v[88:89], v[244:245], v[132:133], v[88:89] op_sel:[0,1,0] op_sel_hi:[1,1,1] neg_lo:[1,0,0] neg_hi:[1,0,0]
    v_pk_fma_f32 v[90:91], v[246:247], v[132:133], v[90:91] op_sel:[0,1,0] op_sel_hi:[1,1,1] neg_lo:[1,0,0] neg_hi:[1,0,0]
    v_pk_fma_f32 v[92:93], v[244:245], v[134:135], v[92:93] op_sel:[0,1,0] op_sel_hi:[1,1,1] neg_lo:[1,0,0] neg_hi:[1,0,0]
    v_pk_fma_f32 v[94:95], v[246:247], v[134:135], v[94:95] op_sel:[0,1,0] op_sel_hi:[1,1,1] neg_lo:[1,0,0] neg_hi:[1,0,0]
    s_add_u32 m0, s82, 8192
    s_add_u32 s90, s89, 65536
    buffer_load_dwordx4 v6, s[20:23], s90 offen lds
    v_pk_mul_f32 v[80:81], v[80:81], v[128:129] op_sel_hi:[1,0]
    v_pk_mul_f32 v[82:83], v[82:83], v[128:129] op_sel_hi:[1,0]
    v_pk_mul_f32 v[84:85], v[84:85], v[130:131] op_sel_hi:[1,0]
    v_pk_mul_f32 v[86:87], v[86:87], v[130:131] op_sel_hi:[1,0]
    s_add_u32 m0, s82, 9216
    s_add_u32 s90, s89, 73728
    buffer_load_dwordx4 v6, s[20:23], s90 offen lds
    v_pk_mul_f32 v[88:89], v[88:89], v[132:133] op_sel_hi:[1,0]
    v_pk_mul_f32 v[90:91], v[90:91], v[132:133] op_sel_hi:[1,0]
    v_pk_mul_f32 v[92:93], v[92:93], v[134:135] op_sel_hi:[1,0]
    v_pk_mul_f32 v[94:95], v[94:95], v[134:135] op_sel_hi:[1,0]
    s_add_u32 m0, s82, 10240
    s_add_u32 s90, s89, 81920
    buffer_load_dwordx4 v6, s[20:23], s90 offen lds
    v_pk_mul_f32 v[96:97], v[80:81], s[92:93]
    v_pk_mul_f32 v[98:99], v[82:83], s[92:93]
    v_pk_mul_f32 v[100:101], v[84:85], s[92:93]
    v_pk_mul_f32 v[102:103], v[86:87], s[92:93]
    s_add_u32 m0, s82, 11264
    s_add_u32 s90, s89, 90112
    buffer_load_dwordx4 v6, s[20:23], s90 offen lds
    v_pk_mul_f32 v[104:105], v[88:89], s[92:93]
    v_pk_mul_f32 v[106:107], v[90:91], s[92:93]
    v_pk_mul_f32 v[108:109], v[92:93], s[92:93]
    v_pk_mul_f32 v[110:111], v[94:95], s[92:93]
    s_add_u32 m0, s82, 12288
    s_add_u32 s90, s89, 98304
    buffer_load_dwordx4 v6, s[20:23], s90 offen lds
    v_exp_f32 v96, v96 clamp
    v_exp_f32 v97, v97 clamp
    v_exp_f32 v98, v98 clamp
    v_exp_f32 v99, v99 clamp
    s_add_u32 m0, s82, 13312
    s_add_u32 s90, s89, 106496
    buffer_load_dwordx4 v6, s[20:23], s90 offen lds
    v_exp_f32 v100, v100 clamp
    v_exp_f32 v101, v101 clamp
    v_exp_f32 v102, v102 clamp
    v_exp_f32 v103, v103 clamp
    s_add_u32 m0, s82, 14336
    s_add_u32 s90, s89, 114688
    buffer_load_dwordx4 v6, s[20:23], s90 offen lds
    v_exp_f32 v104, v104 clamp
    v_exp_f32 v105, v105 clamp
    v_exp_f32 v106, v106 clamp
    v_exp_f32 v107, v107 clamp
    s_add_u32 m0, s82, 15360
    s_add_u32 s90, s89, 122880
    buffer_load_dwordx4 v6, s[20:23], s90 offen lds
    v_exp_f32 v108, v108 clamp
    v_exp_f32 v109, v109 clamp
    v_exp_f32 v110, v110 clamp
    v_exp_f32 v111, v111 clamp
    s_waitcnt vmcnt(10)
    v_readfirstlane_b32 s1, v24
    s_nop 0
    s_cmp_lg_u32 s1, 32
    s_cbranch_scc1 obn1
    buffer_load_dwordx4 v[48:51], v249, s[16:19], s3 offen offset:0 sc1
    buffer_load_dwordx4 v[52:55], v249, s[16:19], s3 offen offset:16 sc1
    s_branch obm1
obn1:
    s_mov_b64 exec, 1
    buffer_load_dword v24, v1, s[16:19], s86 offen sc1
    s_mov_b64 exec, -1
obm1:
    v_max_f32 v80, s94, v80
    v_max_f32 v81, s94, v81
    v_max_f32 v82, s94, v82
    v_max_f32 v83, s94, v83
    v_max_f32 v84, s94, v84
    v_max_f32 v85, s94, v85
    v_max_f32 v86, s94, v86
    v_max_f32 v87, s94, v87
    v_max_f32 v88, s94, v88
    v_max_f32 v89, s94, v89
    v_max_f32 v90, s94, v90
    v_max_f32 v91, s94, v91
    v_max_f32 v92, s94, v92
    v_max_f32 v93, s94, v93
    v_max_f32 v94, s94, v94
    v_max_f32 v95, s94, v95
    v_pk_add_f32 v[80:81], v[80:81], v[96:97]
    v_pk_add_f32 v[82:83], v[82:83], v[98:99]
    v_pk_add_f32 v[84:85], v[84:85], v[100:101]
    v_pk_add_f32 v[86:87], v[86:87], v[102:103]
    v_pk_add_f32 v[88:89], v[88:89], v[104:105]
    v_pk_add_f32 v[90:91], v[90:91], v[106:107]
    v_pk_add_f32 v[92:93], v[92:93], v[108:109]
    v_pk_add_f32 v[94:95], v[94:95], v[110:111]
    v_cvt_pk_bf16_f32 v240, v80, v81
    v_cvt_pk_bf16_f32 v241, v82, v83
    v_cvt_pk_bf16_f32 v242, v84, v85
    v_cvt_pk_bf16_f32 v243, v86, v87
    v_cvt_pk_bf16_f32 v244, v88, v89
    v_cvt_pk_bf16_f32 v245, v90, v91
    v_cvt_pk_bf16_f32 v246, v92, v93
    v_cvt_pk_bf16_f32 v247, v94, v95
    v_permlane16_swap_b32 v240, v242
    v_permlane16_swap_b32 v241, v243
    v_permlane16_swap_b32 v244, v246
    v_permlane16_swap_b32 v245, v247
    v_lshlrev_b32 v80, 16, v224
    v_and_b32 v81, 0xffff0000, v224
    v_lshlrev_b32 v82, 16, v225
    v_and_b32 v83, 0xffff0000, v225
    v_lshlrev_b32 v84, 16, v226
    v_and_b32 v85, 0xffff0000, v226
    v_lshlrev_b32 v86, 16, v227
    v_and_b32 v87, 0xffff0000, v227
    v_lshlrev_b32 v88, 16, v228
    v_and_b32 v89, 0xffff0000, v228
    v_lshlrev_b32 v90, 16, v229
    v_and_b32 v91, 0xffff0000, v229
    v_lshlrev_b32 v92, 16, v230
    v_and_b32 v93, 0xffff0000, v230
    v_lshlrev_b32 v94, 16, v231
    v_and_b32 v95, 0xffff0000, v231
    v_lshl_add_u32 v23, v18, 5, v16
    v_lshlrev_b32 v23, 4, v23
    v_lshl_add_u32 v23, v17, 10, v23
    s_and_b32 s31, s12, 1
    s_lshl_b32 s31, s31, 8
    v_add_u32 v6, s31, v23
    v_lshlrev_b32 v250, 10, v16
    v_lshl_add_u32 v250, v18, 5, v250
    v_lshl_add_u32 v250, v17, 4, v250
    s_lshl_b32 s31, s11, 7
    s_add_u32 s31, s31, s81
    v_add_u32 v250, s31, v250
    v_bfe_u32 v19, v1, 2, 3
    v_lshl_add_u32 v19, v17, 4, v19
    v_lshlrev_b32 v19, 7, v19
    v_bfe_u32 v20, v1, 3, 2
    v_lshl_add_u32 v19, v20, 5, v19
    v_and_b32 v20, 3, v1
    v_lshl_add_u32 v232, v20, 3, v19
    v_xor_b32 v233, 32, v232
    v_xor_b32 v234, 64, v232
    v_xor_b32 v235, 96, v232
    s_cmp_eq_u32 s1, 32
    s_cbranch_scc1 obk1
    s_mov_b32 s89, 0
    s_branch obq1_c
obq1:
    s_mov_b64 exec, 1
    buffer_load_dword v24, v1, s[16:19], s86 offen sc1
    s_mov_b64 exec, -1
obq1_c:
    s_waitcnt vmcnt(0)
    v_readfirstlane_b32 s30, v24
    s_add_u32 s89, s89, 1
    s_cmp_gt_u32 s89, 0x8000
    s_cselect_b32 s30, 32, s30
    s_cmp_lg_u32 s30, 32
    s_cbranch_scc1 obq1
    buffer_load_dwordx4 v[48:51], v249, s[16:19], s3 offen offset:0 sc1
    buffer_load_dwordx4 v[52:55], v249, s[16:19], s3 offen offset:16 sc1
obk1:
    s_lshl_b32 s3, s10, 16
    s_lshr_b32 s30, s12, 1
    s_lshl_b32 s30, s30, 15
    s_add_u32 s3, s3, s30
    s_add_u32 s68, s85, 0x900000
    s_add_u32 s69, s85, 0x908000
    s_waitcnt vmcnt(0)
    v_cvt_pk_bf16_f32 v56, v48, v49
    v_cvt_pk_bf16_f32 v57, v50, v51
    v_cvt_pk_bf16_f32 v58, v52, v53
    v_cvt_pk_bf16_f32 v59, v54, v55
    s_nop 1
    v_mfma_f32_32x32x16_bf16 v[16:31], v[56:59], v[240:243], 0
    v_mfma_f32_32x32x16_bf16 v[32:47], v[56:59], v[244:247], 0
    s_nop 10
    v_add_f32 v24, s94, v24
    v_rcp_f32 v24, v24
    s_nop 0
    v_pk_mul_f32 v[16:17], v[16:17], v[24:25] op_sel_hi:[1,0]
    v_pk_mul_f32 v[18:19], v[18:19], v[24:25] op_sel_hi:[1,0]
    v_pk_mul_f32 v[20:21], v[20:21], v[24:25] op_sel_hi:[1,0]
    v_pk_mul_f32 v[22:23], v[22:23], v[24:25] op_sel_hi:[1,0]
    v_cvt_pk_bf16_f32 v60, v16, v17
    v_cvt_pk_bf16_f32 v61, v18, v19
    v_cvt_pk_bf16_f32 v62, v20, v21
    v_cvt_pk_bf16_f32 v63, v22, v23
    v_add_f32 v40, s94, v40
    v_rcp_f32 v40, v40
    s_nop 0
    v_pk_mul_f32 v[32:33], v[32:33], v[40:41] op_sel_hi:[1,0]
    v_pk_mul_f32 v[34:35], v[34:35], v[40:41] op_sel_hi:[1,0]
    v_pk_mul_f32 v[36:37], v[36:37], v[40:41] op_sel_hi:[1,0]
    v_pk_mul_f32 v[38:39], v[38:39], v[40:41] op_sel_hi:[1,0]
    v_cvt_pk_bf16_f32 v64, v32, v33
    v_cvt_pk_bf16_f32 v65, v34, v35
    v_cvt_pk_bf16_f32 v66, v36, v37
    v_cvt_pk_bf16_f32 v67, v38, v39
    s_cmp_eq_u32 s97, 1
    s_cbranch_scc0 slow33
    buffer_store_dwordx4 v[60:63], v2, s[16:19], s68 offen
    buffer_store_dwordx4 v[64:67], v2, s[16:19], s69 offen
back33:
    s_add_u32 s30, s72, 13
    v_mov_b32 v4, s30
    v_mov_b32 v5, s73
    s_waitcnt vmcnt(0)
    s_mov_b64 exec, 1
    s_cmp_eq_u32 s97, 1
    s_cbranch_scc0 slow34
    buffer_store_dwordx2 v[4:5], v1, s[16:19], s0 offen
back34:
    s_mov_b64 exec, -1
    s_barrier
    s_mov_b32 exec_lo, 0xffffffff
    s_mov_b32 exec_hi, 0x0
    buffer_load_dwordx2 v[4:5], v253, s[16:19], 0 offen sc1
    s_mov_b64 exec, -1
    ds_read_b64_tr_b16 v[96:97], v232 offset:0
    ds_read_b64_tr_b16 v[98:99], v232 offset:1024
    ds_read_b64_tr_b16 v[100:101], v233 offset:0
    ds_read_b64_tr_b16 v[102:103], v233 offset:1024
    ds_read_b64_tr_b16 v[104:105], v234 offset:0
    ds_read_b64_tr_b16 v[106:107], v234 offset:1024
    ds_read_b64_tr_b16 v[108:109], v235 offset:0
    ds_read_b64_tr_b16 v[110:111], v235 offset:1024
    ds_read_b64_tr_b16 v[112:113], v232 offset:4096
    ds_read_b64_tr_b16 v[114:115], v232 offset:5120
    ds_read_b64_tr_b16 v[116:117], v233 offset:4096
    ds_read_b64_tr_b16 v[118:119], v233 offset:5120
    ds_read_b64_tr_b16 v[120:121], v234 offset:4096
    ds_read_b64_tr_b16 v[122:123], v234 offset:5120
    ds_read_b64_tr_b16 v[124:125], v235 offset:4096
    ds_read_b64_tr_b16 v[126:127], v235 offset:5120
    ds_read_b64_tr_b16 v[128:129], v232 offset:8192
    ds_read_b64_tr_b16 v[130:131], v232 offset:9216
    ds_read_b64_tr_b16 v[132:133], v233 offset:8192
    ds_read_b64_tr_b16 v[134:135], v233 offset:9216
    ds_read_b64_tr_b16 v[136:137], v234 offset:8192
    ds_read_b64_tr_b16 v[138:139], v234 offset:9216
    ds_read_b64_tr_b16 v[140:141], v235 offset:8192
    ds_read_b64_tr_b16 v[142:143], v235 offset:9216
    ds_read_b64_tr_b16 v[144:145], v232 offset:12288
    ds_read_b64_tr_b16 v[146:147], v232 offset:13312
    ds_read_b64_tr_b16 v[148:149], v233 offset:12288
    ds_read_b64_tr_b16 v[150:151], v233 offset:13312
    ds_read_b64_tr_b16 v[152:153], v234 offset:12288
    ds_read_b64_tr_b16 v[154:155], v234 offset:13312
    ds_read_b64_tr_b16 v[156:157], v235 offset:12288
    ds_read_b64_tr_b16 v[158:159], v235 offset:13312
    ds_read_b64_tr_b16 v[160:161], v232 offset:16384
    ds_read_b64_tr_b16 v[162:163], v232 offset:17408
    ds_read_b64_tr_b16 v[164:165], v233 offset:16384
    ds_read_b64_tr_b16 v[166:167], v233 offset:17408
    ds_read_b64_tr_b16 v[168:169], v234 offset:16384
    ds_read_b64_tr_b16 v[170:171], v234 offset:17408
    ds_read_b64_tr_b16 v[172:173], v235 offset:16384
    ds_read_b64_tr_b16 v[174:175], v235 offset:17408
    ds_read_b64_tr_b16 v[176:177], v232 offset:20480
    ds_read_b64_tr_b16 v[178:179], v232 offset:21504
    ds_read_b64_tr_b16 v[180:181], v233 offset:20480
    ds_read_b64_tr_b16 v[182:183], v233 offset:21504
    ds_read_b64_tr_b16 v[184:185], v234 offset:20480
    ds_read_b64_tr_b16 v[186:187], v234 offset:21504
    ds_read_b64_tr_b16 v[188:189], v235 offset:20480
    ds_read_b64_tr_b16 v[190:191], v235 offset:21504
    ds_read_b64_tr_b16 v[192:193], v232 offset:24576
    ds_read_b64_tr_b16 v[194:195], v232 offset:25600
    ds_read_b64_tr_b16 v[196:197], v233 offset:24576
    ds_read_b64_tr_b16 v[198:199], v233 offset:25600
    ds_read_b64_tr_b16 v[200:201], v234 offset:24576
    ds_read_b64_tr_b16 v[202:203], v234 offset:25600
    ds_read_b64_tr_b16 v[204:205], v235 offset:24576
    ds_read_b64_tr_b16 v[206:207], v235 offset:25600
    ds_read_b64_tr_b16 v[208:209], v232 offset:28672
    ds_read_b64_tr_b16 v[210:211], v232 offset:29696
    ds_read_b64_tr_b16 v[212:213], v233 offset:28672
    ds_read_b64_tr_b16 v[214:215], v233 offset:29696
    ds_read_b64_tr_b16 v[216:217], v234 offset:28672
    ds_read_b64_tr_b16 v[218:219], v234 offset:29696
    ds_read_b64_tr_b16 v[220:221], v235 offset:28672
    ds_read_b64_tr_b16 v[222:223], v235 offset:29696
    ds_read_b64_tr_b16 a[128:129], v232 offset:32768
    ds_read_b64_tr_b16 a[130:131], v232 offset:33792
    ds_read_b64_tr_b16 a[132:133], v233 offset:32768
    ds_read_b64_tr_b16 a[134:135], v233 offset:33792
    ds_read_b64_tr_b16 a[136:137], v234 offset:32768
    ds_read_b64_tr_b16 a[138:139], v234 offset:33792
    ds_read_b64_tr_b16 a[140:141], v235 offset:32768
    ds_read_b64_tr_b16 a[142:143], v235 offset:33792
    ds_read_b64_tr_b16 a[144:145], v232 offset:36864
    ds_read_b64_tr_b16 a[146:147], v232 offset:37888
    ds_read_b64_tr_b16 a[148:149], v233 offset:36864
    ds_read_b64_tr_b16 a[150:151], v233 offset:37888
    ds_read_b64_tr_b16 a[152:153], v234 offset:36864
    ds_read_b64_tr_b16 a[154:155], v234 offset:37888
    ds_read_b64_tr_b16 a[156:157], v235 offset:36864
    ds_read_b64_tr_b16 a[158:159], v235 offset:37888
    ds_read_b64_tr_b16 a[160:161], v232 offset:40960
    ds_read_b64_tr_b16 a[162:163], v232 offset:41984
    ds_read_b64_tr_b16 a[164:165], v233 offset:40960
    ds_read_b64_tr_b16 a[166:167], v233 offset:41984
    ds_read_b64_tr_b16 a[168:169], v234 offset:40960
    ds_read_b64_tr_b16 a[170:171], v234 offset:41984
    ds_read_b64_tr_b16 a[172:173], v235 offset:40960
    ds_read_b64_tr_b16 a[174:175], v235 offset:41984
    ds_read_b64_tr_b16 a[176:177], v232 offset:45056
    ds_read_b64_tr_b16 a[178:179], v232 offset:46080
    ds_read_b64_tr_b16 a[180:181], v233 offset:45056
    ds_read_b64_tr_b16 a[182:183], v233 offset:46080
    ds_read_b64_tr_b16 a[184:185], v234 offset:45056
    ds_read_b64_tr_b16 a[186:187], v234 offset:46080
    ds_read_b64_tr_b16 a[188:189], v235 offset:45056
    ds_read_b64_tr_b16 a[190:191], v235 offset:46080
    s_mov_b32 exec_lo, 0xffffffff
    s_mov_b32 exec_hi, 0x0
    s_mov_b32 s30, 0
    s_branch poll35_c
poll35:
    buffer_load_dwordx2 v[4:5], v253, s[16:19], 0 offen sc1
poll35_c:
    s_waitcnt vmcnt(0)
poll35_l:
    s_add_u32 s30, s30, 1
    v_subrev_u32 v4, s72, v4
    v_cmp_eq_u32 s[74:75], s73, v5
    v_cmp_gt_u32 s[76:77], 32, v4
    v_cmp_le_u32 vcc, 13, v4
    s_and_b64 s[74:75], s[74:75], s[76:77]
    s_and_b64 vcc, vcc, s[74:75]
    s_cmp_eq_u64 vcc, exec
    s_cbranch_scc1 poll35_x
    s_cmp_gt_u32 s30, 0x8000
    s_cbranch_scc0 poll35
poll35_x:
    s_mov_b64 exec, -1
    s_add_u32 s88, s3, 0x900000
    buffer_load_dwordx4 v[16:19], v6, s[16:19], s88 offen offset:0 sc1
    buffer_load_dwordx4 v[20:23], v6, s[16:19], s88 offen offset:2048 sc1
    s_add_u32 s88, s3, 0x901000
    buffer_load_dwordx4 v[24:27], v6, s[16:19], s88 offen offset:0 sc1
    buffer_load_dwordx4 v[28:31], v6, s[16:19], s88 offen offset:2048 sc1
    s_waitcnt vmcnt(3) lgkmcnt(0)
    v_mfma_f32_16x16x32_bf16 v[80:83], v[96:99], v[16:19], v[80:83]
    s_add_u32 s88, s3, 0x902000
    buffer_load_dwordx4 v[32:35], v6, s[16:19], s88 offen offset:0 sc1
    v_mfma_f32_16x16x32_bf16 v[84:87], v[100:103], v[16:19], v[84:87]
    v_mfma_f32_16x16x32_bf16 v[88:91], v[104:107], v[16:19], v[88:91]
    buffer_load_dwordx4 v[36:39], v6, s[16:19], s88 offen offset:2048 sc1
    v_mfma_f32_16x16x32_bf16 v[92:95], v[108:111], v[16:19], v[92:95]
    s_waitcnt vmcnt(4)
    v_mfma_f32_16x16x32_bf16 v[80:83], v[112:115], v[20:23], v[80:83]
    s_add_u32 s88, s3, 0x903000
    buffer_load_dwordx4 v[40:43], v6, s[16:19], s88 offen offset:0 sc1
    v_mfma_f32_16x16x32_bf16 v[84:87], v[116:119], v[20:23], v[84:87]
    v_mfma_f32_16x16x32_bf16 v[88:91], v[120:123], v[20:23], v[88:91]
    buffer_load_dwordx4 v[44:47], v6, s[16:19], s88 offen offset:2048 sc1
    v_mfma_f32_16x16x32_bf16 v[92:95], v[124:127], v[20:23], v[92:95]
    s_waitcnt vmcnt(5)
    v_mfma_f32_16x16x32_bf16 v[80:83], v[128:131], v[24:27], v[80:83]
    s_add_u32 s88, s3, 0x904000
    buffer_load_dwordx4 v[48:51], v6, s[16:19], s88 offen offset:0 sc1
    v_mfma_f32_16x16x32_bf16 v[84:87], v[132:135], v[24:27], v[84:87]
    v_mfma_f32_16x16x32_bf16 v[88:91], v[136:139], v[24:27], v[88:91]
    buffer_load_dwordx4 v[52:55], v6, s[16:19], s88 offen offset:2048 sc1
    v_mfma_f32_16x16x32_bf16 v[92:95], v[140:143], v[24:27], v[92:95]
    s_waitcnt vmcnt(6)
    v_mfma_f32_16x16x32_bf16 v[80:83], v[144:147], v[28:31], v[80:83]
    s_add_u32 s88, s3, 0x905000
    buffer_load_dwordx4 v[56:59], v6, s[16:19], s88 offen offset:0 sc1
    v_mfma_f32_16x16x32_bf16 v[84:87], v[148:151], v[28:31], v[84:87]
    v_mfma_f32_16x16x32_bf16 v[88:91], v[152:155], v[28:31], v[88:91]
    buffer_load_dwordx4 v[60:63], v6, s[16:19], s88 offen offset:2048 sc1
    v_mfma_f32_16x16x32_bf16 v[92:95], v[156:159], v[28:31], v[92:95]
    s_waitcnt vmcnt(7)
    v_mfma_f32_16x16x32_bf16 v[80:83], v[160:163], v[32:35], v[80:83]
    s_add_u32 s88, s3, 0x906000
    buffer_load_dwordx4 v[64:67], v6, s[16:19], s88 offen offset:0 sc1
    ds_read_b64_tr_b16 v[96:97], v232 offset:49152
    v_mfma_f32_16x16x32_bf16 v[84:87], v[164:167], v[32:35], v[84:87]
    ds_read_b64_tr_b16 v[98:99], v232 offset:50176
    v_mfma_f32_16x16x32_bf16 v[88:91], v[168:171], v[32:35], v[88:91]
    buffer_load_dwordx4 v[68:71], v6, s[16:19], s88 offen offset:2048 sc1
    ds_read_b64_tr_b16 v[100:101], v233 offset:49152
    v_mfma_f32_16x16x32_bf16 v[92:95], v[172:175], v[32:35], v[92:95]
    ds_read_b64_tr_b16 v[102:103], v233 offset:50176
    s_waitcnt vmcnt(8)
    v_mfma_f32_16x16x32_bf16 v[80:83], v[176:179], v[36:39], v[80:83]
    s_add_u32 s88, s3, 0x907000
    buffer_load_dwordx4 v[72:75], v6, s[16:19], s88 offen offset:0 sc1
    ds_read_b64_tr_b16 v[104:105], v234 offset:49152
    v_mfma_f32_16x16x32_bf16 v[84:87], v[180:183], v[36:39], v[84:87]
    ds_read_b64_tr_b16 v[106:107], v234 offset:50176
    v_mfma_f32_16x16x32_bf16 v[88:91], v[184:187], v[36:39], v[88:91]
    buffer_load_dwordx4 v[76:79], v6, s[16:19], s88 offen offset:2048 sc1
    ds_read_b64_tr_b16 v[108:109], v235 offset:49152
    v_mfma_f32_16x16x32_bf16 v[92:95], v[188:191], v[36:39], v[92:95]
    ds_read_b64_tr_b16 v[110:111], v235 offset:50176
    s_waitcnt vmcnt(9)
    v_mfma_f32_16x16x32_bf16 v[80:83], v[192:195], v[40:43], v[80:83]
    ds_read_b64_tr_b16 v[112:113], v232 offset:53248
    v_mfma_f32_16x16x32_bf16 v[84:87], v[196:199], v[40:43], v[84:87]
    ds_read_b64_tr_b16 v[114:115], v232 offset:54272
    ds_read_b64_tr_b16 v[116:117], v233 offset:53248
    v_mfma_f32_16x16x32_bf16 v[88:91], v[200:203], v[40:43], v[88:91]
    ds_read_b64_tr_b16 v[118:119], v233 offset:54272
    v_mfma_f32_16x16x32_bf16 v[92:95], v[204:207], v[40:43], v[92:95]
    ds_read_b64_tr_b16 v[120:121], v234 offset:53248
    ds_read_b64_tr_b16 v[122:123], v234 offset:54272
    s_waitcnt vmcnt(8)
    v_mfma_f32_16x16x32_bf16 v[80:83], v[208:211], v[44:47], v[80:83]
    ds_read_b64_tr_b16 v[124:125], v235 offset:53248
    v_mfma_f32_16x16x32_bf16 v[84:87], v[212:215], v[44:47], v[84:87]
    ds_read_b64_tr_b16 v[126:127], v235 offset:54272
    ds_read_b64_tr_b16 v[128:129], v232 offset:57344
    v_mfma_f32_16x16x32_bf16 v[88:91], v[216:219], v[44:47], v[88:91]
    ds_read_b64_tr_b16 v[130:131], v232 offset:58368
    v_mfma_f32_16x16x32_bf16 v[92:95], v[220:223], v[44:47], v[92:95]
    ds_read_b64_tr_b16 v[132:133], v233 offset:57344
    ds_read_b64_tr_b16 v[134:135], v233 offset:58368
    s_waitcnt vmcnt(7)
    v_mfma_f32_16x16x32_bf16 v[80:83], a[128:131], v[48:51], v[80:83]
    ds_read_b64_tr_b16 v[136:137], v234 offset:57344
    v_mfma_f32_16x16x32_bf16 v[84:87], a[132:135], v[48:51], v[84:87]
    ds_read_b64_tr_b16 v[138:139], v234 offset:58368
    ds_read_b64_tr_b16 v[140:141], v235 offset:57344
    v_mfma_f32_16x16x32_bf16 v[88:91], a[136:139], v[48:51], v[88:91]
    ds_read_b64_tr_b16 v[142:143], v235 offset:58368
    v_mfma_f32_16x16x32_bf16 v[92:95], a[140:143], v[48:51], v[92:95]
    ds_read_b64_tr_b16 v[144:145], v232 offset:61440
    ds_read_b64_tr_b16 v[146:147], v232 offset:62464
    s_waitcnt vmcnt(6)
    v_mfma_f32_16x16x32_bf16 v[80:83], a[144:147], v[52:55], v[80:83]
    ds_read_b64_tr_b16 v[148:149], v233 offset:61440
    v_mfma_f32_16x16x32_bf16 v[84:87], a[148:151], v[52:55], v[84:87]
    ds_read_b64_tr_b16 v[150:151], v233 offset:62464
    ds_read_b64_tr_b16 v[152:153], v234 offset:61440
    v_mfma_f32_16x16x32_bf16 v[88:91], a[152:155], v[52:55], v[88:91]
    ds_read_b64_tr_b16 v[154:155], v234 offset:62464
    v_mfma_f32_16x16x32_bf16 v[92:95], a[156:159], v[52:55], v[92:95]
    ds_read_b64_tr_b16 v[156:157], v235 offset:61440
    ds_read_b64_tr_b16 v[158:159], v235 offset:62464
    s_waitcnt vmcnt(5)
    v_mfma_f32_16x16x32_bf16 v[80:83], a[160:163], v[56:59], v[80:83]
    v_mfma_f32_16x16x32_bf16 v[84:87], a[164:167], v[56:59], v[84:87]
    v_mfma_f32_16x16x32_bf16 v[88:91], a[168:171], v[56:59], v[88:91]
    v_mfma_f32_16x16x32_bf16 v[92:95], a[172:175], v[56:59], v[92:95]
    s_waitcnt vmcnt(4)
    v_mfma_f32_16x16x32_bf16 v[80:83], a[176:179], v[60:63], v[80:83]
    v_mfma_f32_16x16x32_bf16 v[84:87], a[180:183], v[60:63], v[84:87]
    v_mfma_f32_16x16x32_bf16 v[88:91], a[184:187], v[60:63], v[88:91]
    v_mfma_f32_16x16x32_bf16 v[92:95], a[188:191], v[60:63], v[92:95]
    s_waitcnt vmcnt(3) lgkmcnt(0)
    v_mfma_f32_16x16x32_bf16 v[80:83], v[96:99], v[64:67], v[80:83]
    v_mfma_f32_16x16x32_bf16 v[84:87], v[100:103], v[64:67], v[84:87]
    v_mfma_f32_16x16x32_bf16 v[88:91], v[104:107], v[64:67], v[88:91]
    v_mfma_f32_16x16x32_bf16 v[92:95], v[108:111], v[64:67], v[92:95]
    s_waitcnt vmcnt(2)
    v_mfma_f32_16x16x32_bf16 v[80:83], v[112:115], v[68:71], v[80:83]
    v_mfma_f32_16x16x32_bf16 v[84:87], v[116:119], v[68:71], v[84:87]
    v_mfma_f32_16x16x32_bf16 v[88:91], v[120:123], v[68:71], v[88:91]
    v_mfma_f32_16x16x32_bf16 v[92:95], v[124:127], v[68:71], v[92:95]
    s_waitcnt vmcnt(1)
    v_mfma_f32_16x16x32_bf16 v[80:83], v[128:131], v[72:75], v[80:83]
    v_mfma_f32_16x16x32_bf16 v[84:87], v[132:135], v[72:75], v[84:87]
    v_mfma_f32_16x16x32_bf16 v[88:91], v[136:139], v[72:75], v[88:91]
    v_mfma_f32_16x16x32_bf16 v[92:95], v[140:143], v[72:75], v[92:95]
    s_waitcnt vmcnt(0)
    v_mfma_f32_16x16x32_bf16 v[80:83], v[144:147], v[76:79], v[80:83]
    v_mfma_f32_16x16x32_bf16 v[84:87], v[148:151], v[76:79], v[84:87]
    v_mfma_f32_16x16x32_bf16 v[88:91], v[152:155], v[76:79], v[88:91]
    v_mfma_f32_16x16x32_bf16 v[92:95], v[156:159], v[76:79], v[92:95]
    s_nop 4
    v_cvt_pk_bf16_f32 v240, v80, v81
    v_cvt_pk_bf16_f32 v241, v82, v83
    v_cvt_pk_bf16_f32 v242, v84, v85
    v_cvt_pk_bf16_f32 v243, v86, v87
    v_cvt_pk_bf16_f32 v244, v88, v89
    v_cvt_pk_bf16_f32 v245, v90, v91
    v_cvt_pk_bf16_f32 v246, v92, v93
    v_cvt_pk_bf16_f32 v247, v94, v95
    v_permlane16_swap_b32 v240, v242
    v_permlane16_swap_b32 v241, v243
    v_permlane16_swap_b32 v244, v246
    v_permlane16_swap_b32 v245, v247
    buffer_store_dwordx4 v[240:243], v250, s[24:27], 0 offen offset:0
    buffer_store_dwordx4 v[244:247], v250, s[24:27], 0 offen offset:64
    s_endpgm
slow4:
    buffer_store_dwordx2 v[4:5], v1, s[16:19], s0 offen sc1
    s_nop 0
    s_branch back4
slow5:
    buffer_store_dwordx2 v[4:5], v1, s[16:19], s0 offen sc1
    s_nop 0
    s_branch back5
slow6:
    buffer_store_dwordx2 v[4:5], v1, s[16:19], s0 offen sc1
    s_nop 0
    s_branch back6
slow8:
    buffer_store_dwordx2 v[18:19], v251, s[16:19], s67 offen sc1
    s_nop 0
    s_branch back8
slow9:
    buffer_store_dwordx2 v[4:5], v1, s[16:19], s0 offen sc1
    s_nop 0
    s_branch back9
slow13:
    buffer_store_dwordx4 v[60:63], v2, s[16:19], s68 offen sc1
    buffer_store_dwordx4 v[64:67], v2, s[16:19], s69 offen sc1
    s_nop 0
    s_branch back13
slow14:
    buffer_store_dwordx2 v[4:5], v1, s[16:19], s0 offen sc1
    s_nop 0
    s_branch back14
slow16:
    buffer_store_dwordx4 v[240:243], v250, s[24:27], s70 offen offset:0 sc1
    buffer_store_dwordx4 v[244:247], v250, s[24:27], s70 offen offset:1024 sc1
    s_nop 0
    s_branch back16
slow17:
    buffer_store_dwordx2 v[18:19], v251, s[16:19], s71 offen sc1
    s_nop 0
    s_branch back17
slow18:
    buffer_store_dwordx2 v[4:5], v1, s[16:19], s0 offen sc1
    s_nop 0
    s_branch back18
slow22:
    buffer_store_dwordx4 v[40:43], v2, s[16:19], s64 offen sc1
    s_nop 0
    s_branch back22
slow23:
    buffer_store_dwordx2 v[4:5], v1, s[16:19], s0 offen sc1
    s_nop 0
    s_branch back23
slow24:
    buffer_store_dwordx4 v[44:47], v2, s[16:19], s65 offen sc1
    s_nop 0
    s_branch back24
slow25:
    buffer_store_dwordx2 v[4:5], v1, s[16:19], s0 offen sc1
    s_nop 0
    s_branch back25
slow26:
    buffer_store_dwordx2 v[4:5], v1, s[16:19], s0 offen sc1
    s_nop 0
    s_branch back26
slow28:
    buffer_store_dwordx4 v[240:243], v250, s[24:27], s66 offen offset:0 sc1
    buffer_store_dwordx4 v[244:247], v250, s[24:27], s66 offen offset:1024 sc1
    s_nop 0
    s_branch back28
slow29:
    buffer_store_dwordx2 v[18:19], v251, s[16:19], s67 offen sc1
    s_nop 0
    s_branch back29
slow30:
    buffer_store_dwordx2 v[4:5], v1, s[16:19], s0 offen sc1
    s_nop 0
    s_branch back30
slow33:
    buffer_store_dwordx4 v[60:63], v2, s[16:19], s68 offen sc1
    buffer_store_dwordx4 v[64:67], v2, s[16:19], s69 offen sc1
    s_nop 0
    s_branch back33
slow34:
    buffer_store_dwordx2 v[4:5], v1, s[16:19], s0 offen sc1
    s_nop 0
    s_branch back34
main_done:
    s_endpgm
.section .rodata,"a"
.p2align 6
.amdhsa_kernel interleave_layers__sliding_block__linear_attn_block__prompt_kernel
  .amdhsa_next_free_vgpr 512
  .amdhsa_next_free_sgpr 102
  .amdhsa_accum_offset 256
  .amdhsa_group_segment_fixed_size 0
  .amdhsa_kernarg_size 72
  .amdhsa_user_sgpr_count 2
  .amdhsa_user_sgpr_kernarg_segment_ptr 1
  .amdhsa_system_sgpr_workgroup_id_x 1
  .amdhsa_float_denorm_mode_32 3
.end_amdhsa_kernel
```
